```python
import torch

def _softmax(x, axis=-1):
    return torch.softmax(x, dim=axis)

def _gelu(x):
    return torch.nn.functional.gelu(x, approximate='tanh')

def _silu(x):
    return torch.nn.functional.silu(x)

def _sigmoid(x):
    return torch.sigmoid(x)

def _layernorm(x, axis=-1, eps=1e-05):
    m = x.mean(dim=axis, keepdim=True)
    v = x.var(dim=axis, keepdim=True, unbiased=False)
    return (x - m) / torch.sqrt(v + eps)

def _scatter_add(tgt, idx, src, axis=0):
    return tgt.clone().index_add_(axis, idx, src)

def _segment_sum(src, seg, n):
    out = torch.zeros((n,) + src.shape[1:], dtype=src.dtype)
    return out.index_add_(0, seg, src)

def _pad(x, pw):
    flat = tuple((v for pair in reversed(pw) for v in pair))
    return torch.nn.functional.pad(x, flat)
kernel_name = 'parallel_sum__ssm_conv_s4__mixer_gmlp__prompt'

def setup_inputs():

    _w = lambda a: (lambda t: t.to(torch.bfloat16) if t.is_floating_point() else t)(torch.as_tensor(a))

    def _A_setup():
        B, L, D, N = (1, 2048, 512, 128)
        A_re = -(lambda _x: torch.exp(torch.as_tensor(_x)))((lambda *s: torch.randn(*s, dtype=torch.bfloat16) * 3.2)(D, N))
        A_im = torch.pi * (lambda *s: torch.randn(*s, dtype=torch.bfloat16) * 0.1)(D, N)
        B_re = (lambda *s: torch.randn(*s, dtype=torch.bfloat16) * 0.8)(D, N)
        B_im = (lambda *s: torch.randn(*s, dtype=torch.bfloat16) * 0.8)(D, N)
        C_re = (lambda *s: torch.randn(*s, dtype=torch.bfloat16) * 0.8)(D, N)
        C_im = (lambda *s: torch.randn(*s, dtype=torch.bfloat16) * 0.8)(D, N)
        log_dt = (lambda *s: torch.randn(*s, dtype=torch.bfloat16) * 0.1)(D) * 0.5 - 4.0
        Dskip = (lambda *s: torch.randn(*s, dtype=torch.bfloat16) * 0.8)(D)
        return {'u': _w((lambda *s: torch.randn(*s, dtype=torch.bfloat16) * 0.05)(B, L, D)), 'A_re': _w(A_re), 'A_im': _w(A_im), 'B_re': _w(B_re), 'B_im': _w(B_im), 'C_re': _w(C_re), 'C_im': _w(C_im), 'log_dt': _w(log_dt), 'Dskip': _w(Dskip)}
    _A_in = _A_setup()

    def _B_setup():
        B, S, D, F = (1, 2048, 512, 1792)
        Fh = F // 2
        return {'x': _w((lambda *s: torch.randn(*s, dtype=torch.bfloat16) * 0.05)(B, S, D)), 'w_in': _w((lambda *s: torch.randn(*s, dtype=torch.bfloat16) * 0.4)(D, 2 * Fh)), 'w_sp': _w(0.01 * (lambda *s: torch.randn(*s, dtype=torch.bfloat16) * 0.4)(S, S)), 'b_sp': _w(1.0 + 0.01 * (lambda *s: torch.randn(*s, dtype=torch.bfloat16) * 0.05)(S)), 'w_out': _w((lambda *s: torch.randn(*s, dtype=torch.bfloat16) * 0.05)(Fh, D))}
    _B_in = _B_setup()
    return {'A_u': _A_in['u'], 'A_A_re': _A_in['A_re'], 'A_A_im': _A_in['A_im'], 'A_B_re': _A_in['B_re'], 'A_B_im': _A_in['B_im'], 'A_C_re': _A_in['C_re'], 'A_C_im': _A_in['C_im'], 'A_log_dt': _A_in['log_dt'], 'A_Dskip': _A_in['Dskip'], 'B_x': _B_in['x'], 'B_w_in': _B_in['w_in'], 'B_w_sp': _B_in['w_sp'], 'B_b_sp': _B_in['b_sp'], 'B_w_out': _B_in['w_out']}

def reference(A_u, A_A_re, A_A_im, A_B_re, A_B_im, A_C_re, A_C_im, A_log_dt, A_Dskip, B_x, B_w_in, B_w_sp, B_b_sp, B_w_out):

    def _A_ref(u, A_re, A_im, B_re, B_im, C_re, C_im, log_dt, Dskip):
        Bsz, L, D = u.shape
        dt = torch.exp(log_dt)[:, None]
        A = A_re + 1j * A_im
        Bc = B_re + 1j * B_im
        Cc = C_re + 1j * C_im
        logdA = dt * A
        dB = dt * Bc
        l = (lambda x, dt: x.to(dt))(torch.arange(L), A_re.dtype)
        P = torch.exp(logdA[:, :, None] * l[None, None, :])
        K = torch.einsum('dn,dnl,dn->dl', Cc, P, dB).real
        L2 = 2 * L
        Kp = _pad(K, ((0, 0), (0, L)))
        up = (lambda x, *d: x.permute(*d))(u, 0, 2, 1)
        up = _pad(up, ((0, 0), (0, 0), (0, L)))
        Kf = (lambda x, axes=(-2, -1): torch.fft.rfft2(x.float(), dim=axes))(Kp[:, None, :], axes=(-2, -1))
        Uf = (lambda x, axes=(-2, -1): torch.fft.rfft2(x.float(), dim=axes))(up[:, :, None, :], axes=(-2, -1))
        Yf = Uf * Kf[None, :, :, :]
        y = (lambda x, s, axes=(-2, -1): torch.fft.irfft2(x, s=s, dim=axes).to(torch.bfloat16))(Yf, (1, L2), axes=(-2, -1))[:, :, 0, :L]
        y = (lambda x, *d: x.permute(*d))(y, 0, 2, 1) + u * Dskip[None, None, :]
        return y

    def _B_ref(x, w_in, w_sp, b_sp, w_out):
        B, S, D = x.shape
        F = w_in.shape[-1]
        Fh = F // 2
        z = _gelu(torch.einsum('bsd,df->bsf', x, w_in))
        z1 = z[..., :Fh].clone()
        z2 = _layernorm(z[..., Fh:], axis=-1)
        g = torch.einsum('ts,bsf->btf', w_sp, z2) + b_sp[None, :, None]
        return torch.einsum('bsf,fd->bsd', z1 * g, w_out)
    x = A_u
    xn = _layernorm(x, axis=-1)
    return x + _A_ref(xn, A_A_re, A_A_im, A_B_re, A_B_im, A_C_re, A_C_im, A_log_dt, A_Dskip) + _B_ref(xn, B_w_in, B_w_sp, B_b_sp, B_w_out)
```

```asm
; @launch kernel=kf_kernel grid=(256,1,1) block=(512,1,1) lds=163072
.amdgcn_target "amdgcn-amd-amdhsa--gfx950"
.text
.globl kf_kernel
.p2align 8
.type kf_kernel,@function
kf_kernel:
    s_cmp_ge_u32 s2, 256
    s_cbranch_scc1 K2_END
    s_load_dwordx2 s[4:5], s[0:1], 128
    s_load_dwordx4 s[8:11], s[0:1], 88
    s_load_dwordx2 s[100:101], s[0:1], 120
    v_lshrrev_b32 v6, 6, v0
    v_and_b32 v1, 63, v0
    v_readfirstlane_b32 s22, v6
    v_and_b32 v2, 15, v1
    v_lshrrev_b32 v3, 4, v1
    v_lshlrev_b32 v4, 2, v6
    v_mov_b32 v6, 0
    ds_write_b32 v4, v6
    s_and_b32 s23, s2, 7
    s_lshr_b32 s24, s2, 3
    s_lshr_b32 s20, s23, 1
    s_lshl_b32 s20, s20, 3
    s_and_b32 s25, s24, 7
    s_add_u32 s20, s20, s25
    s_and_b32 s21, s23, 1
    s_lshl_b32 s21, s21, 2
    s_lshr_b32 s25, s24, 3
    s_add_u32 s21, s21, s25
    s_load_dwordx2 s[28:29], s[0:1], 0
    s_load_dwordx2 s[32:33], s[0:1], 80
    s_load_dwordx2 s[6:7], s[0:1], 104
    s_lshr_b32 s36, s22, 2
    s_and_b32 s37, s22, 3
    s_and_b32 s38, s21, 1
    s_lshr_b32 s23, s21, 1
    s_mul_i32 s25, s23, 14
    s_bitcmp1_b32 s23, 0
    s_cselect_b32 s23, 6, 0
    s_cselect_b32 s24, 0, 8
    s_add_u32 s23, s23, s25
    s_add_u32 s24, s24, s25
    s_cmp_eq_u32 s38, 0
    s_cselect_b32 s44, s23, s24
    s_cselect_b32 s45, s24, s23
    s_and_b32 s23, s21, 3
    s_cmp_eq_u32 s23, 3
    s_cselect_b32 s47, 2, 0
    s_cmp_eq_u32 s23, 2
    s_cselect_b32 s48, 2, 0
    s_sub_u32 s40, s45, s48
    s_sub_u32 s39, s44, s47
    s_lshl_b32 s40, s40, 5
    s_lshl_b32 s39, s39, 5
    s_add_u32 s39, s39, 1792
    s_and_b32 s23, s22, 1
    s_lshl_b32 s24, s23, 3
    v_add_u32 v16, 0, v3
    v_or_b32 v17, s24, v16
    v_xor_b32 v17, v17, v2
    v_lshlrev_b32 v35, 10, v16
    v_lshl_add_u32 v35, v17, 4, v35
    v_add_u32 v16, 4, v3
    v_or_b32 v17, s24, v16
    v_xor_b32 v17, v17, v2
    v_lshlrev_b32 v36, 10, v16
    v_lshl_add_u32 v36, v17, 4, v36
    v_subrev_u32 v36, 1024, v36
    s_lshl_b32 s49, s20, 16
    s_lshl_b32 s25, s22, 13
    s_add_u32 s49, s49, s25
    s_lshl_b32 s50, s22, 11
    s_add_u32 s50, s50, 94208
    s_lshl_b32 s25, s23, 2
    v_or_b32 v16, s25, v3
    v_lshrrev_b32 v17, 1, v2
    v_xor_b32 v17, v17, v16
    s_and_b32 s23, s22, 2
    s_lshl_b32 s23, s23, 1
    s_or_b32 s23, s23, s24
    s_and_b32 s24, s22, 4
    s_lshl_b32 s24, s24, 2
    s_or_b32 s23, s23, s24
    v_or_b32 v16, s23, v3
    v_mul_u32_u24 v34, 3584, v16
    v_lshl_add_u32 v34, v17, 5, v34
    v_and_b32 v18, 1, v2
    v_lshl_add_u32 v34, v18, 4, v34
    s_lshl_b32 s41, s22, 10
    s_add_u32 s41, s41, 4096
    s_waitcnt lgkmcnt(0)
    s_and_b32 s29, s29, 0xffff
    s_mov_b32 s30, 0x00200000
    s_mov_b32 s31, 0x00020000
    s_and_b32 s33, s33, 0xffff
    s_mov_b32 s34, 0x001c0000
    s_mov_b32 s35, 0x00020000
    s_mov_b32 s12, s4
    s_and_b32 s13, s5, 0xffff
    s_mov_b32 s14, 0x00ee0000
    s_mov_b32 s15, 0x00020000
    s_mov_b32 s16, s8
    s_and_b32 s17, s9, 0xffff
    s_mov_b32 s18, 0x00800000
    s_mov_b32 s19, 0x00020000
    s_add_u32 m0, s50, 0
    s_add_u32 s25, s49, 0
    buffer_load_dwordx4 v35, s[28:31], s25 offen offset:0 lds
    buffer_load_dwordx4 v36, s[28:31], s25 offen offset:1024 lds
    s_add_u32 s25, s39, 0
    s_add_u32 m0, s41, 0
    s_nop 0
    buffer_load_dwordx4 v34, s[32:35], s25 offen lds
    s_add_u32 s25, s39, 114688
    s_add_u32 m0, s41, 8192
    s_nop 0
    buffer_load_dwordx4 v34, s[32:35], s25 offen lds
    s_add_u32 s25, s39, 229376
    s_add_u32 m0, s41, 16384
    s_nop 0
    buffer_load_dwordx4 v34, s[32:35], s25 offen lds
    s_add_u32 s25, s39, 344064
    s_add_u32 m0, s41, 24576
    s_nop 0
    buffer_load_dwordx4 v34, s[32:35], s25 offen lds
    v_lshlrev_b32 v253, 2, v1
    v_mov_b32 v240, 0
    s_add_u32 s23, s2, s22
    s_cmp_lg_u32 s23, 0
    s_cbranch_scc1 KF_N0
    s_memrealtime s[24:25]
    s_mov_b32 s60, s100
    s_and_b32 s61, s101, 0xffff
    s_mov_b32 s62, 0x00000100
    s_mov_b32 s63, 0x00020000
    s_waitcnt lgkmcnt(0)
    s_or_b32 s24, s24, 1
    v_mov_b32 v6, s24
    s_mov_b64 exec, 1
    buffer_store_dword v6, v253, s[60:63], 0 offen sc1
    s_mov_b64 exec, -1
KF_N0:
    s_lshl_b32 s52, s20, 13
    s_add_u32 s52, s52, 15269888
    s_add_u32 s53, s52, 4096
    v_lshlrev_b32 v22, 3, v1
    v_lshlrev_b32 v23, 4, v1
    s_lshl_b32 s23, s36, 1
    s_xor_b32 s23, s23, s37
    s_lshl_b32 s24, s23, 1
    s_min_u32 s24, s24, 5
    s_cmp_lt_u32 s23, 2
    s_cselect_b32 s46, 1, 0
    s_lshl_b32 s23, s37, 1
    s_cmp_eq_u32 s38, 0
    s_cselect_b32 s42, s23, s24
    s_cselect_b32 s43, s24, s23
    s_add_u32 s47, s47, s42
    s_add_u32 s48, s48, s43
    v_lshrrev_b32 v16, 2, v2
    v_and_b32 v17, 1, v3
    v_lshl_add_u32 v29, v17, 2, v16
    v_lshrrev_b32 v17, 1, v3
    v_lshl_add_u32 v16, v17, 4, v29
    v_lshlrev_b32 v16, 8, v16
    v_and_b32 v17, 3, v2
    v_lshl_add_u32 v28, v17, 3, v16
    v_add_u32 v28, 4096, v28
    s_mov_b32 s54, 0xbdd2d3e8
    s_mov_b32 s55, 0xbdd2d3e8
    v_mov_b32 v12, 0xc0135761
    v_mov_b32 v13, 0xc0135761
    v_mov_b32 v14, 1.0
    v_mov_b32 v15, 1.0
    v_mov_b32 v8, 0x3f803f80
    v_mov_b32 v9, 0x3f803f80
    v_mov_b32 v10, 0x3f803f80
    v_mov_b32 v11, 0x3f803f80
    s_lshl_b32 s23, s36, 13
    s_add_u32 s23, s23, 94208
    s_lshl_b32 s24, s37, 12
    s_add_u32 s24, s24, 94208
    v_lshlrev_b32 v16, 8, v2
    v_add_u32 v17, 0, v3
    v_xor_b32 v17, v17, v2
    v_lshl_add_u32 v17, v17, 4, v16
    v_add_u32 v30, s23, v17
    v_add_u32 v39, s24, v17
    v_add_u32 v17, 4, v3
    v_xor_b32 v17, v17, v2
    v_lshl_add_u32 v17, v17, 4, v16
    v_add_u32 v31, s23, v17
    v_add_u32 v40, s24, v17
    v_add_u32 v17, 8, v3
    v_xor_b32 v17, v17, v2
    v_lshl_add_u32 v17, v17, 4, v16
    v_add_u32 v32, s23, v17
    v_add_u32 v41, s24, v17
    v_add_u32 v17, 12, v3
    v_xor_b32 v17, v17, v2
    v_lshl_add_u32 v17, v17, 4, v16
    v_add_u32 v33, s23, v17
    v_add_u32 v42, s24, v17
    v_lshl_add_u32 v37, v1, 4, s41
    v_add_u32 v38, 0x10000, v37
    v_lshrrev_b32 v92, 2, v2
    v_lshl_add_u32 v92, v3, 3, v92
    s_lshl_b32 s24, s21, 3
    s_lshl_b32 s25, s37, 1
    s_add_u32 s24, s24, s25
    s_lshr_b32 s25, s24, 4
    s_lshl_b32 s25, s25, 14
    s_add_u32 s25, s25, s23
    s_and_b32 s24, s24, 15
    v_bfe_u32 v93, v2, 1, 1
    v_add_u32 v93, s24, v93
    v_and_b32 v94, 1, v2
    v_lshlrev_b32 v94, 3, v94
    v_add_u32 v94, s25, v94
    v_and_b32 v95, 15, v92
    v_xor_b32 v95, v95, v93
    v_lshl_add_u32 v44, v95, 4, v94
    v_lshl_add_u32 v44, v92, 8, v44
    v_add_u32 v92, 4, v92
    v_and_b32 v95, 15, v92
    v_xor_b32 v95, v95, v93
    v_lshl_add_u32 v45, v95, 4, v94
    v_lshl_add_u32 v45, v92, 8, v45
    v_lshrrev_b32 v92, 2, v1
    v_and_b32 v93, 3, v1
    v_lshl_add_u32 v46, v93, 4, v92
    v_lshlrev_b32 v46, 2, v46
    v_mul_u32_u24 v47, 4224, v92
    v_lshl_add_u32 v47, v93, 4, v47
    v_lshlrev_b32 v48, 5, v93
    v_lshl_add_u32 v48, s36, 7, v48
    v_add_u32 v48, 161536, v48
    s_lshl_b32 s23, s21, 6
    s_lshl_b32 s24, s37, 4
    s_add_u32 s23, s23, s24
    s_mul_i32 s23, s23, 4224
    s_lshl_b32 s24, s20, 7
    s_add_u32 s23, s23, s24
    s_lshl_b32 s24, s36, 6
    s_add_u32 s23, s23, s24
    s_add_u32 s51, s23, 128
    v_lshrrev_b32 v49, 5, v1
    v_lshlrev_b32 v49, 10, v49
    v_and_b32 v92, 1, v3
    v_lshl_add_u32 v49, v92, 7, v49
    v_lshl_add_u32 v49, v2, 2, v49
    s_mov_b32 s58, 0
    s_add_u32 m0, s50, 16384
    s_add_u32 s25, s49, 256
    buffer_load_dwordx4 v35, s[28:31], s25 offen offset:0 lds
    buffer_load_dwordx4 v36, s[28:31], s25 offen offset:1024 lds
    s_add_u32 s25, s39, 458752
    s_add_u32 m0, s41, 32768
    s_nop 0
    buffer_load_dwordx4 v34, s[32:35], s25 offen lds
    s_add_u32 s25, s39, 573440
    s_add_u32 m0, s41, 40960
    s_nop 0
    buffer_load_dwordx4 v34, s[32:35], s25 offen lds
    s_cmp_eq_u32 s36, 0
    s_cbranch_scc1 P1_PL
    s_lshl_b32 s23, s2, 9
    s_and_b32 s24, s22, 3
    s_lshl_b32 s24, s24, 7
    s_add_u32 s23, s23, s24
    v_lshl_add_u32 v6, v1, 1, s23
    s_lshr_b32 s23, s23, 8
    s_lshl_b32 s23, s23, 1
    v_mov_b32 v5, s23
    s_load_dwordx4 s[60:63], s[0:1], 8
    s_waitcnt lgkmcnt(0)
    global_load_ushort v244, v6, s[60:61]
    global_load_ushort v245, v6, s[62:63]
    s_load_dwordx4 s[60:63], s[0:1], 24
    s_waitcnt lgkmcnt(0)
    global_load_ushort v246, v6, s[60:61]
    global_load_ushort v247, v6, s[62:63]
    s_load_dwordx4 s[60:63], s[0:1], 40
    s_waitcnt lgkmcnt(0)
    global_load_ushort v248, v6, s[60:61]
    global_load_ushort v249, v6, s[62:63]
    s_load_dwordx4 s[60:63], s[0:1], 56
    s_waitcnt lgkmcnt(0)
    global_load_ushort v254, v5, s[60:61]
    global_load_ushort v255, v5, s[62:63]
    s_waitcnt vmcnt(12)
    s_branch P1_PL2
P1_PL:
    s_waitcnt vmcnt(4)
P1_PL2:
    s_cmp_eq_u32 s46, 1
    s_cbranch_scc1 P1_P22
    s_cmp_eq_u32 s38, 0
    s_cbranch_scc1 P1_P21
    v_xor_b32 v16, s47, v29
    v_lshl_add_u32 v24, v16, 5, v28
    v_add_u32 v25, 0x10000, v24
    s_cmp_eq_u32 s36, 0
    s_cbranch_scc1 P1_S1
    s_setprio 1
P1_S1:
    s_barrier
    ds_read_b128 v[108:111], v30 offset:0
    ds_read_b128 v[112:115], v30 offset:4096
    ds_read_b64_tr_b16 v[132:133], v24 offset:0
    ds_read_b64_tr_b16 v[134:135], v24 offset:2048
    ds_read_b128 v[116:119], v31 offset:0
    ds_read_b128 v[120:123], v31 offset:4096
    ds_read_b64_tr_b16 v[140:141], v24 offset:8192
    ds_read_b64_tr_b16 v[142:143], v24 offset:10240
    s_cmp_lg_u32 s36, 0
    s_cbranch_scc1 P1_S2
    ds_read_b128 v[92:95], v39 offset:0
    ds_read_b128 v[96:99], v40 offset:0
    ds_read_b128 v[100:103], v41 offset:0
    ds_read_b128 v[104:107], v42 offset:0
P1_S2:
    ds_read_b128 v[124:127], v32 offset:0
    ds_read_b128 v[128:131], v32 offset:4096
    ds_read_b64_tr_b16 v[148:149], v24 offset:16384
    ds_read_b64_tr_b16 v[150:151], v24 offset:18432
    s_waitcnt lgkmcnt(8)
    v_mfma_f32_16x16x32_bf16 v[156:159], v[108:111], v[132:135], 0
    s_add_u32 s25, s39, 688128
    s_add_u32 m0, s41, 49152
    s_nop 0
    buffer_load_dwordx4 v34, s[32:35], s25 offen lds
    v_mfma_f32_16x16x32_bf16 v[160:163], v[112:115], v[132:135], 0
    s_add_u32 s25, s39, 802816
    s_add_u32 m0, s41, 57344
    s_nop 0
    buffer_load_dwordx4 v34, s[32:35], s25 offen lds
    v_mfma_f32_16x16x32_bf16 v[68:71], v[8:11], v[132:135], 0
    s_add_u32 m0, s50, 32768
    s_add_u32 s25, s49, 512
    buffer_load_dwordx4 v35, s[28:31], s25 offen offset:0 lds
    buffer_load_dwordx4 v36, s[28:31], s25 offen offset:1024 lds
    ds_read_b128 v[108:111], v33 offset:0
    ds_read_b128 v[112:115], v33 offset:4096
    ds_read_b64_tr_b16 v[132:133], v24 offset:24576
    ds_read_b64_tr_b16 v[134:135], v24 offset:26624
    s_waitcnt lgkmcnt(8)
    v_mfma_f32_16x16x32_bf16 v[156:159], v[116:119], v[140:143], v[156:159]
    s_add_u32 s25, s39, 917504
    s_add_u32 m0, s41, 65536
    s_nop 0
    buffer_load_dwordx4 v34, s[32:35], s25 offen lds
    v_mfma_f32_16x16x32_bf16 v[160:163], v[120:123], v[140:143], v[160:163]
    v_mfma_f32_16x16x32_bf16 v[68:71], v[8:11], v[140:143], v[68:71]
    s_waitcnt vmcnt(5)
    s_barrier
    s_cmp_lg_u32 s36, 0
    s_cbranch_scc1 P1_S3
    s_waitcnt lgkmcnt(8)
    v_mfma_f32_16x16x32_bf16 v[172:175], v[92:95], v[8:11], 0
    v_mfma_f32_16x16x32_bf16 v[176:179], v[92:95], v[92:95], 0
    v_mfma_f32_16x16x32_bf16 v[172:175], v[96:99], v[8:11], v[172:175]
    v_mfma_f32_16x16x32_bf16 v[176:179], v[96:99], v[96:99], v[176:179]
    v_mfma_f32_16x16x32_bf16 v[172:175], v[100:103], v[8:11], v[172:175]
    v_mfma_f32_16x16x32_bf16 v[176:179], v[100:103], v[100:103], v[176:179]
    v_mfma_f32_16x16x32_bf16 v[172:175], v[104:107], v[8:11], v[172:175]
    v_mfma_f32_16x16x32_bf16 v[176:179], v[104:107], v[104:107], v[176:179]
    ds_read_b128 v[92:95], v39 offset:16384
    ds_read_b128 v[96:99], v40 offset:16384
    ds_read_b128 v[100:103], v41 offset:16384
    ds_read_b128 v[104:107], v42 offset:16384
P1_S3:
    ds_read_b128 v[116:119], v30 offset:16384
    ds_read_b128 v[120:123], v30 offset:20480
    ds_read_b64_tr_b16 v[140:141], v24 offset:32768
    ds_read_b64_tr_b16 v[142:143], v24 offset:34816
    s_waitcnt lgkmcnt(8)
    v_mfma_f32_16x16x32_bf16 v[156:159], v[124:127], v[148:151], v[156:159]
    s_add_u32 s25, s39, 1032192
    s_add_u32 m0, s41, 73728
    s_nop 0
    buffer_load_dwordx4 v34, s[32:35], s25 offen lds
    v_mfma_f32_16x16x32_bf16 v[160:163], v[128:131], v[148:151], v[160:163]
    s_add_u32 s25, s39, 1146880
    s_add_u32 m0, s41, 81920
    s_nop 0
    buffer_load_dwordx4 v34, s[32:35], s25 offen lds
    v_mfma_f32_16x16x32_bf16 v[68:71], v[8:11], v[148:151], v[68:71]
    s_add_u32 s25, s39, 1261568
    s_add_u32 m0, s41, 0
    s_nop 0
    buffer_load_dwordx4 v34, s[32:35], s25 offen lds
    ds_read_b128 v[124:127], v31 offset:16384
    ds_read_b128 v[128:131], v31 offset:20480
    ds_read_b64_tr_b16 v[148:149], v24 offset:40960
    ds_read_b64_tr_b16 v[150:151], v24 offset:43008
    s_waitcnt lgkmcnt(8)
    v_mfma_f32_16x16x32_bf16 v[156:159], v[108:111], v[132:135], v[156:159]
    s_add_u32 m0, s50, 49152
    s_add_u32 s25, s49, 768
    buffer_load_dwordx4 v35, s[28:31], s25 offen offset:0 lds
    v_mfma_f32_16x16x32_bf16 v[160:163], v[112:115], v[132:135], v[160:163]
    v_mfma_f32_16x16x32_bf16 v[68:71], v[8:11], v[132:135], v[68:71]
    s_waitcnt vmcnt(7)
    s_barrier
    s_cmp_lg_u32 s36, 0
    s_cbranch_scc1 P1_S4
    s_waitcnt lgkmcnt(8)
    v_mfma_f32_16x16x32_bf16 v[172:175], v[92:95], v[8:11], v[172:175]
    v_mfma_f32_16x16x32_bf16 v[176:179], v[92:95], v[92:95], v[176:179]
    v_mfma_f32_16x16x32_bf16 v[172:175], v[96:99], v[8:11], v[172:175]
    v_mfma_f32_16x16x32_bf16 v[176:179], v[96:99], v[96:99], v[176:179]
    v_mfma_f32_16x16x32_bf16 v[172:175], v[100:103], v[8:11], v[172:175]
    v_mfma_f32_16x16x32_bf16 v[176:179], v[100:103], v[100:103], v[176:179]
    v_mfma_f32_16x16x32_bf16 v[172:175], v[104:107], v[8:11], v[172:175]
    v_mfma_f32_16x16x32_bf16 v[176:179], v[104:107], v[104:107], v[176:179]
P1_S4:
    ds_read_b128 v[108:111], v32 offset:16384
    ds_read_b128 v[112:115], v32 offset:20480
    ds_read_b64_tr_b16 v[132:133], v24 offset:49152
    ds_read_b64_tr_b16 v[134:135], v24 offset:51200
    s_waitcnt lgkmcnt(8)
    v_mfma_f32_16x16x32_bf16 v[156:159], v[116:119], v[140:143], v[156:159]
    s_add_u32 m0, s50, 49152
    s_add_u32 s25, s49, 768
    buffer_load_dwordx4 v36, s[28:31], s25 offen offset:1024 lds
    v_mfma_f32_16x16x32_bf16 v[160:163], v[120:123], v[140:143], v[160:163]
    s_add_u32 s25, s39, 1376256
    s_add_u32 m0, s41, 8192
    s_nop 0
    buffer_load_dwordx4 v34, s[32:35], s25 offen lds
    v_mfma_f32_16x16x32_bf16 v[68:71], v[8:11], v[140:143], v[68:71]
    s_add_u32 s25, s39, 1490944
    s_add_u32 m0, s41, 16384
    s_nop 0
    buffer_load_dwordx4 v34, s[32:35], s25 offen lds
    ds_read_b128 v[116:119], v33 offset:16384
    ds_read_b128 v[120:123], v33 offset:20480
    ds_read_b64_tr_b16 v[140:141], v24 offset:57344
    ds_read_b64_tr_b16 v[142:143], v24 offset:59392
    s_waitcnt lgkmcnt(8)
    v_mfma_f32_16x16x32_bf16 v[156:159], v[124:127], v[148:151], v[156:159]
    s_add_u32 s25, s39, 1605632
    s_add_u32 m0, s41, 24576
    s_nop 0
    buffer_load_dwordx4 v34, s[32:35], s25 offen lds
    v_mfma_f32_16x16x32_bf16 v[160:163], v[128:131], v[148:151], v[160:163]
    v_mfma_f32_16x16x32_bf16 v[68:71], v[8:11], v[148:151], v[68:71]
    s_waitcnt vmcnt(7)
    s_barrier
    s_cmp_lg_u32 s36, 0
    s_cbranch_scc1 P1_S5
    ds_read_b128 v[92:95], v39 offset:32768
    ds_read_b128 v[96:99], v40 offset:32768
    ds_read_b128 v[100:103], v41 offset:32768
    ds_read_b128 v[104:107], v42 offset:32768
P1_S5:
    s_cmp_lg_u32 s22, 7
    s_cbranch_scc1 P1_S6
    s_mov_b32 s60, s100
    s_and_b32 s61, s101, 0xffff
    s_mov_b32 s62, 0x00000100
    s_mov_b32 s63, 0x00020000
    v_mov_b32 v251, 0
    buffer_load_dword v250, v251, s[60:63], 0 offen sc1
P1_S6:
    ds_read_b128 v[124:127], v30 offset:32768
    ds_read_b128 v[128:131], v30 offset:36864
    ds_read_b64_tr_b16 v[148:149], v25 offset:0
    ds_read_b64_tr_b16 v[150:151], v25 offset:2048
    s_waitcnt lgkmcnt(8)
    v_mfma_f32_16x16x32_bf16 v[156:159], v[108:111], v[132:135], v[156:159]
    s_add_u32 s25, s39, 1720320
    s_add_u32 m0, s41, 32768
    s_nop 0
    buffer_load_dwordx4 v34, s[32:35], s25 offen lds
    v_mfma_f32_16x16x32_bf16 v[160:163], v[112:115], v[132:135], v[160:163]
    s_add_u32 s25, s40, 0
    s_add_u32 m0, s41, 40960
    s_nop 0
    buffer_load_dwordx4 v34, s[32:35], s25 offen lds
    v_mfma_f32_16x16x32_bf16 v[68:71], v[8:11], v[132:135], v[68:71]
    ds_read_b128 v[108:111], v31 offset:32768
    ds_read_b128 v[112:115], v31 offset:36864
    ds_read_b64_tr_b16 v[132:133], v25 offset:8192
    ds_read_b64_tr_b16 v[134:135], v25 offset:10240
    s_waitcnt lgkmcnt(8)
    v_mfma_f32_16x16x32_bf16 v[156:159], v[116:119], v[140:143], v[156:159]
    v_mfma_f32_16x16x32_bf16 v[160:163], v[120:123], v[140:143], v[160:163]
    v_mfma_f32_16x16x32_bf16 v[68:71], v[8:11], v[140:143], v[68:71]
    s_waitcnt vmcnt(7)
    s_barrier
    s_cmp_lg_u32 s36, 0
    s_cbranch_scc1 P1_S7
    s_waitcnt lgkmcnt(8)
    v_mfma_f32_16x16x32_bf16 v[172:175], v[92:95], v[8:11], v[172:175]
    v_mfma_f32_16x16x32_bf16 v[176:179], v[92:95], v[92:95], v[176:179]
    v_mfma_f32_16x16x32_bf16 v[172:175], v[96:99], v[8:11], v[172:175]
    v_mfma_f32_16x16x32_bf16 v[176:179], v[96:99], v[96:99], v[176:179]
    v_mfma_f32_16x16x32_bf16 v[172:175], v[100:103], v[8:11], v[172:175]
    v_mfma_f32_16x16x32_bf16 v[176:179], v[100:103], v[100:103], v[176:179]
    v_mfma_f32_16x16x32_bf16 v[172:175], v[104:107], v[8:11], v[172:175]
    v_mfma_f32_16x16x32_bf16 v[176:179], v[104:107], v[104:107], v[176:179]
P1_S7:
    ds_read_b128 v[116:119], v32 offset:32768
    ds_read_b128 v[120:123], v32 offset:36864
    ds_read_b64_tr_b16 v[140:141], v25 offset:16384
    ds_read_b64_tr_b16 v[142:143], v25 offset:18432
    s_waitcnt lgkmcnt(8)
    v_mfma_f32_16x16x32_bf16 v[156:159], v[124:127], v[148:151], v[156:159]
    s_add_u32 s25, s40, 114688
    s_add_u32 m0, s41, 49152
    s_nop 0
    buffer_load_dwordx4 v34, s[32:35], s25 offen lds
    v_mfma_f32_16x16x32_bf16 v[160:163], v[128:131], v[148:151], v[160:163]
    s_add_u32 s25, s40, 229376
    s_add_u32 m0, s41, 57344
    s_nop 0
    buffer_load_dwordx4 v34, s[32:35], s25 offen lds
    v_mfma_f32_16x16x32_bf16 v[68:71], v[8:11], v[148:151], v[68:71]
    ds_read_b128 v[124:127], v33 offset:32768
    ds_read_b128 v[128:131], v33 offset:36864
    ds_read_b64_tr_b16 v[148:149], v24 offset:0
    ds_read_b64_tr_b16 v[150:151], v24 offset:2048
    s_waitcnt lgkmcnt(8)
    v_mfma_f32_16x16x32_bf16 v[156:159], v[108:111], v[132:135], v[156:159]
    v_mfma_f32_16x16x32_bf16 v[160:163], v[112:115], v[132:135], v[160:163]
    v_mfma_f32_16x16x32_bf16 v[68:71], v[8:11], v[132:135], v[68:71]
    s_waitcnt vmcnt(5)
    s_barrier
    s_cmp_lg_u32 s36, 0
    s_cbranch_scc1 P1_S8
    ds_read_b128 v[92:95], v39 offset:49152
    ds_read_b128 v[96:99], v40 offset:49152
    ds_read_b128 v[100:103], v41 offset:49152
    ds_read_b128 v[104:107], v42 offset:49152
P1_S8:
    ds_read_b128 v[108:111], v30 offset:49152
    ds_read_b128 v[112:115], v30 offset:53248
    ds_read_b64_tr_b16 v[132:133], v24 offset:8192
    ds_read_b64_tr_b16 v[134:135], v24 offset:10240
    s_waitcnt lgkmcnt(8)
    v_mfma_f32_16x16x32_bf16 v[156:159], v[116:119], v[140:143], v[156:159]
    s_add_u32 s25, s40, 344064
    s_add_u32 m0, s41, 65536
    s_nop 0
    buffer_load_dwordx4 v34, s[32:35], s25 offen lds
    v_mfma_f32_16x16x32_bf16 v[160:163], v[120:123], v[140:143], v[160:163]
    s_add_u32 s25, s40, 458752
    s_add_u32 m0, s41, 73728
    s_nop 0
    buffer_load_dwordx4 v34, s[32:35], s25 offen lds
    v_mfma_f32_16x16x32_bf16 v[68:71], v[8:11], v[140:143], v[68:71]
    ds_read_b128 v[116:119], v31 offset:49152
    ds_read_b128 v[120:123], v31 offset:53248
    ds_read_b64_tr_b16 v[140:141], v24 offset:16384
    ds_read_b64_tr_b16 v[142:143], v24 offset:18432
    s_waitcnt lgkmcnt(8)
    v_mfma_f32_16x16x32_bf16 v[156:159], v[124:127], v[148:151], v[156:159]
    v_mfma_f32_16x16x32_bf16 v[160:163], v[128:131], v[148:151], v[160:163]
    v_mfma_f32_16x16x32_bf16 v[68:71], v[8:11], v[148:151], v[68:71]
    s_waitcnt vmcnt(5)
    s_barrier
    s_cmp_lg_u32 s36, 0
    s_cbranch_scc1 P1_S9
    s_waitcnt lgkmcnt(8)
    v_mfma_f32_16x16x32_bf16 v[172:175], v[92:95], v[8:11], v[172:175]
    v_mfma_f32_16x16x32_bf16 v[176:179], v[92:95], v[92:95], v[176:179]
    v_mfma_f32_16x16x32_bf16 v[172:175], v[96:99], v[8:11], v[172:175]
    v_mfma_f32_16x16x32_bf16 v[176:179], v[96:99], v[96:99], v[176:179]
    v_mfma_f32_16x16x32_bf16 v[172:175], v[100:103], v[8:11], v[172:175]
    v_mfma_f32_16x16x32_bf16 v[176:179], v[100:103], v[100:103], v[176:179]
    v_mfma_f32_16x16x32_bf16 v[172:175], v[104:107], v[8:11], v[172:175]
    v_mfma_f32_16x16x32_bf16 v[176:179], v[104:107], v[104:107], v[176:179]
P1_S9:
    s_cmp_lg_u32 s22, 7
    s_cbranch_scc1 P1_S10
    s_mov_b32 s25, 0
KF_NL1:
    v_readfirstlane_b32 s26, v250
    s_cmp_lg_u32 s26, 0
    s_cbranch_scc1 KF_NG1
    s_mov_b32 s60, s100
    s_and_b32 s61, s101, 0xffff
    s_mov_b32 s62, 0x00000100
    s_mov_b32 s63, 0x00020000
    v_mov_b32 v251, 0
    buffer_load_dword v250, v251, s[60:63], 0 offen sc1
    s_waitcnt vmcnt(0)
    s_add_u32 s25, s25, 1
    s_cmp_lt_u32 s25, 0x40000
    s_cbranch_scc1 KF_NL1
KF_NG1:
    ds_write_b32 v251, v250 offset:32
P1_S10:
    ds_read_b128 v[124:127], v32 offset:49152
    ds_read_b128 v[128:131], v32 offset:53248
    ds_read_b64_tr_b16 v[148:149], v24 offset:24576
    ds_read_b64_tr_b16 v[150:151], v24 offset:26624
    s_waitcnt lgkmcnt(8)
    v_mfma_f32_16x16x32_bf16 v[156:159], v[108:111], v[132:135], v[156:159]
    s_add_u32 s25, s40, 573440
    s_add_u32 m0, s41, 81920
    s_nop 0
    buffer_load_dwordx4 v34, s[32:35], s25 offen lds
    s_add_u32 s25, s40, 688128
    s_add_u32 m0, s41, 0
    s_nop 0
    buffer_load_dwordx4 v34, s[32:35], s25 offen lds
    v_and_b32 v92, 3, v2
    v_mov_b32 v76, v172
    v_mov_b32 v77, v176
    v_mfma_f32_16x16x32_bf16 v[160:163], v[112:115], v[132:135], v[160:163]
    v_cmp_eq_u32 vcc, 1, v92
    s_nop 1
    v_cndmask_b32 v76, v76, v173, vcc
    v_cndmask_b32 v77, v77, v177, vcc
    v_cmp_eq_u32 vcc, 2, v92
    s_nop 1
    v_cndmask_b32 v76, v76, v174, vcc
    v_cndmask_b32 v77, v77, v178, vcc
    v_cmp_eq_u32 vcc, 3, v92
    s_nop 1
    v_cndmask_b32 v76, v76, v175, vcc
    v_cndmask_b32 v77, v77, v179, vcc
    v_mul_f32 v76, 0x3b000000, v76
    v_mul_f32 v77, 0x3b000000, v77
    v_mfma_f32_16x16x32_bf16 v[68:71], v[8:11], v[132:135], v[68:71]
    v_fma_f32 v77, -v76, v76, v77
    v_max_f32 v77, 0, v77
    v_cvt_pk_bf16_f32 v92, v76, v77
    v_lshlrev_b32 v78, 16, v92
    v_xor_b32 v78, 0x80000000, v78
    ds_read_b128 v[108:111], v33 offset:49152
    ds_read_b128 v[112:115], v33 offset:53248
    ds_read_b64_tr_b16 v[132:133], v24 offset:32768
    ds_read_b64_tr_b16 v[134:135], v24 offset:34816
    s_waitcnt lgkmcnt(8)
    v_mfma_f32_16x16x32_bf16 v[156:159], v[116:119], v[140:143], v[156:159]
    v_and_b32 v92, 0xffff0000, v92
    v_add_f32 v92, 0x3727c5ac, v92
    v_cvt_pk_bf16_f32 v92, v92, v92
    v_and_b32 v92, 0xffff0000, v92
    v_sqrt_f32 v92, v92
    v_mfma_f32_16x16x32_bf16 v[160:163], v[120:123], v[140:143], v[160:163]
    s_nop 0
    v_cvt_pk_bf16_f32 v92, v92, v92
    v_and_b32 v92, 0xffff0000, v92
    v_rcp_f32 v79, v92
    v_lshlrev_b32 v18, 2, v2
    v_lshl_add_u32 v18, s37, 6, v18
    v_mfma_f32_16x16x32_bf16 v[68:71], v[8:11], v[140:143], v[68:71]
    v_add_u32 v18, 161536, v18
    s_cmp_lg_u32 s36, 0
    s_cbranch_scc1 P1_S11
    s_mov_b32 exec_lo, 0x00f0000f
    s_mov_b32 exec_hi, 0xf0000f00
    ds_write_b32 v18, v78
    ds_write_b32 v18, v79 offset:256
    s_mov_b64 exec, -1
P1_S11:
    s_waitcnt vmcnt(5)
    s_waitcnt lgkmcnt(0)
    s_barrier
    s_xor_b32 s23, s36, 0
    s_add_u32 s23, s23, s48
    v_xor_b32 v16, s23, v29
    v_lshl_add_u32 v24, v16, 5, v28
    v_add_u32 v25, 0x10000, v24
    s_xor_b32 s23, s36, 1
    s_add_u32 s23, s23, s48
    v_xor_b32 v16, s23, v29
    v_lshl_add_u32 v26, v16, 5, v28
    v_add_u32 v27, 0x10000, v26
    ds_read_b128 v[116:119], v30 offset:0
    ds_read_b128 v[120:123], v30 offset:4096
    ds_read_b64_tr_b16 v[140:141], v24 offset:40960
    ds_read_b64_tr_b16 v[142:143], v24 offset:43008
    ds_read_b64_tr_b16 v[144:145], v26 offset:40960
    ds_read_b64_tr_b16 v[146:147], v26 offset:43008
    s_waitcnt lgkmcnt(10)
    v_mfma_f32_16x16x32_bf16 v[156:159], v[124:127], v[148:151], v[156:159]
    s_add_u32 s25, s40, 802816
    s_add_u32 m0, s41, 8192
    s_nop 0
    buffer_load_dwordx4 v34, s[32:35], s25 offen lds
    s_add_u32 s25, s40, 917504
    s_add_u32 m0, s41, 16384
    s_nop 0
    buffer_load_dwordx4 v34, s[32:35], s25 offen lds
    v_mfma_f32_16x16x32_bf16 v[160:163], v[128:131], v[148:151], v[160:163]
    v_lshlrev_b32 v18, 4, v3
    v_lshl_add_u32 v18, s36, 7, v18
    v_mfma_f32_16x16x32_bf16 v[68:71], v[8:11], v[148:151], v[68:71]
    v_add_u32 v18, 161536, v18
    ds_read_b128 v[76:79], v18 offset:0
    ds_read_b128 v[124:127], v31 offset:0
    ds_read_b128 v[128:131], v31 offset:4096
    ds_read_b64_tr_b16 v[148:149], v24 offset:49152
    ds_read_b64_tr_b16 v[150:151], v24 offset:51200
    ds_read_b64_tr_b16 v[152:153], v26 offset:49152
    ds_read_b64_tr_b16 v[154:155], v26 offset:51200
    s_waitcnt lgkmcnt(12)
    v_mfma_f32_16x16x32_bf16 v[156:159], v[108:111], v[132:135], v[156:159]
    ds_read_b128 v[84:87], v18 offset:256
    ds_read_b128 v[80:83], v18 offset:64
    v_mfma_f32_16x16x32_bf16 v[160:163], v[112:115], v[132:135], v[160:163]
    ds_read_b128 v[88:91], v18 offset:320
    v_mfma_f32_16x16x32_bf16 v[68:71], v[8:11], v[132:135], v[68:71]
    s_lshl_b32 s23, s47, 6
    s_add_u32 s23, s23, 162048
    v_lshl_add_u32 v19, v2, 2, s23
    s_nop 4
    ds_write_b32 v19, v68
    s_waitcnt lgkmcnt(0)
    s_barrier
    s_waitcnt lgkmcnt(0)
    v_pk_fma_f32 v[156:157], v[76:77], v[68:69], v[156:157] op_sel_hi:[1,0,1]
    v_pk_fma_f32 v[158:159], v[78:79], v[68:69], v[158:159] op_sel_hi:[1,0,1]
    v_pk_fma_f32 v[160:161], v[80:81], v[68:69], v[160:161] op_sel_hi:[1,0,1]
    v_pk_fma_f32 v[162:163], v[82:83], v[68:69], v[162:163] op_sel_hi:[1,0,1]
    s_add_u32 s25, s40, 1032192
    s_add_u32 m0, s41, 24576
    s_nop 0
    buffer_load_dwordx4 v34, s[32:35], s25 offen lds
    v_pk_mul_f32 v[156:157], v[156:157], v[84:85]
    v_pk_mul_f32 v[158:159], v[158:159], v[86:87]
    v_pk_mul_f32 v[160:161], v[160:161], v[88:89]
    v_pk_mul_f32 v[162:163], v[162:163], v[90:91]
    s_add_u32 s25, s40, 1146880
    s_add_u32 m0, s41, 32768
    s_nop 0
    buffer_load_dwordx4 v34, s[32:35], s25 offen lds
    v_pk_mul_f32 v[76:77], v[156:157], v[156:157]
    v_pk_mul_f32 v[78:79], v[158:159], v[158:159]
    v_pk_mul_f32 v[80:81], v[160:161], v[160:161]
    v_pk_mul_f32 v[82:83], v[162:163], v[162:163]
    s_add_u32 s25, s40, 1261568
    buffer_load_dwordx4 v[180:183], v34, s[32:35], s25 offen
    v_pk_fma_f32 v[76:77], v[76:77], s[54:55], v[12:13]
    v_pk_fma_f32 v[78:79], v[78:79], s[54:55], v[12:13]
    v_pk_fma_f32 v[80:81], v[80:81], s[54:55], v[12:13]
    v_pk_fma_f32 v[82:83], v[82:83], s[54:55], v[12:13]
    s_add_u32 s25, s40, 1376256
    buffer_load_dwordx4 v[184:187], v34, s[32:35], s25 offen
    v_pk_mul_f32 v[76:77], v[76:77], v[156:157]
    v_pk_mul_f32 v[78:79], v[78:79], v[158:159]
    v_pk_mul_f32 v[80:81], v[80:81], v[160:161]
    v_pk_mul_f32 v[82:83], v[82:83], v[162:163]
    s_add_u32 s25, s40, 1490944
    buffer_load_dwordx4 v[188:191], v34, s[32:35], s25 offen
    v_exp_f32 v76, v76
    v_exp_f32 v77, v77
    v_exp_f32 v78, v78
    v_exp_f32 v79, v79
    s_add_u32 s25, s40, 1605632
    buffer_load_dwordx4 v[192:195], v34, s[32:35], s25 offen
    v_exp_f32 v80, v80
    v_exp_f32 v81, v81
    v_exp_f32 v82, v82
    v_exp_f32 v83, v83
    s_add_u32 s25, s40, 1720320
    buffer_load_dwordx4 v[196:199], v34, s[32:35], s25 offen
    v_pk_add_f32 v[76:77], v[76:77], v[14:15]
    v_pk_add_f32 v[78:79], v[78:79], v[14:15]
    v_pk_add_f32 v[80:81], v[80:81], v[14:15]
    v_pk_add_f32 v[82:83], v[82:83], v[14:15]
    v_rcp_f32 v76, v76
    v_rcp_f32 v77, v77
    v_rcp_f32 v78, v78
    v_rcp_f32 v79, v79
    v_rcp_f32 v80, v80
    v_rcp_f32 v81, v81
    v_rcp_f32 v82, v82
    v_rcp_f32 v83, v83
    v_pk_mul_f32 v[156:157], v[156:157], v[76:77]
    v_pk_mul_f32 v[158:159], v[158:159], v[78:79]
    v_pk_mul_f32 v[160:161], v[160:161], v[80:81]
    v_pk_mul_f32 v[162:163], v[162:163], v[82:83]
    v_cvt_pk_bf16_f32 v172, v156, 0
    v_cvt_pk_bf16_f32 v173, v157, 0
    v_cvt_pk_bf16_f32 v174, v158, 0
    v_cvt_pk_bf16_f32 v175, v159, 0
    v_cvt_pk_bf16_f32 v176, v160, 0
    v_cvt_pk_bf16_f32 v177, v161, 0
    v_cvt_pk_bf16_f32 v178, v162, 0
    v_cvt_pk_bf16_f32 v179, v163, 0
    v_pk_mul_f32 v[80:81], v[156:157], v[156:157]
    v_mov_b32 v76, v156
    v_mov_b32 v77, v157
    v_pk_mul_f32 v[82:83], v[158:159], v[158:159]
    v_mov_b32 v78, v158
    v_mov_b32 v79, v159
    v_pk_mul_f32 v[88:89], v[160:161], v[160:161]
    v_mov_b32 v84, v160
    v_mov_b32 v85, v161
    v_pk_mul_f32 v[90:91], v[162:163], v[162:163]
    v_mov_b32 v86, v162
    v_mov_b32 v87, v163
    v_add_f32_dpp v156, v76, v76 row_ror:8 row_mask:0xf bank_mask:0x3
    v_add_f32_dpp v157, v77, v77 row_ror:8 row_mask:0xf bank_mask:0x3
    v_add_f32_dpp v158, v78, v78 row_ror:8 row_mask:0xf bank_mask:0x3
    v_add_f32_dpp v159, v79, v79 row_ror:8 row_mask:0xf bank_mask:0x3
    v_add_f32_dpp v160, v80, v80 row_ror:8 row_mask:0xf bank_mask:0x3
    v_add_f32_dpp v161, v81, v81 row_ror:8 row_mask:0xf bank_mask:0x3
    v_add_f32_dpp v162, v82, v82 row_ror:8 row_mask:0xf bank_mask:0x3
    v_add_f32_dpp v163, v83, v83 row_ror:8 row_mask:0xf bank_mask:0x3
    v_add_f32_dpp v156, v84, v84 row_ror:8 row_mask:0xf bank_mask:0xc
    v_add_f32_dpp v157, v85, v85 row_ror:8 row_mask:0xf bank_mask:0xc
    v_add_f32_dpp v158, v86, v86 row_ror:8 row_mask:0xf bank_mask:0xc
    v_add_f32_dpp v159, v87, v87 row_ror:8 row_mask:0xf bank_mask:0xc
    v_add_f32_dpp v160, v88, v88 row_ror:8 row_mask:0xf bank_mask:0xc
    v_add_f32_dpp v161, v89, v89 row_ror:8 row_mask:0xf bank_mask:0xc
    v_add_f32_dpp v162, v90, v90 row_ror:8 row_mask:0xf bank_mask:0xc
    v_add_f32_dpp v163, v91, v91 row_ror:8 row_mask:0xf bank_mask:0xc
    v_add_f32_dpp v164, v156, v156 row_half_mirror row_mask:0xf bank_mask:0x5
    v_add_f32_dpp v165, v157, v157 row_half_mirror row_mask:0xf bank_mask:0x5
    v_add_f32_dpp v166, v158, v158 row_half_mirror row_mask:0xf bank_mask:0x5
    v_add_f32_dpp v167, v159, v159 row_half_mirror row_mask:0xf bank_mask:0x5
    v_add_f32_dpp v164, v160, v160 row_half_mirror row_mask:0xf bank_mask:0xa
    v_add_f32_dpp v165, v161, v161 row_half_mirror row_mask:0xf bank_mask:0xa
    v_add_f32_dpp v166, v162, v162 row_half_mirror row_mask:0xf bank_mask:0xa
    v_add_f32_dpp v167, v163, v163 row_half_mirror row_mask:0xf bank_mask:0xa
    v_add_f32_dpp v164, v164, v164 quad_perm:[1,0,3,2] row_mask:0xf bank_mask:0xf
    v_add_f32_dpp v165, v165, v165 quad_perm:[1,0,3,2] row_mask:0xf bank_mask:0xf
    v_add_f32_dpp v166, v166, v166 quad_perm:[1,0,3,2] row_mask:0xf bank_mask:0xf
    v_add_f32_dpp v167, v167, v167 quad_perm:[1,0,3,2] row_mask:0xf bank_mask:0xf
    v_add_f32_dpp v164, v164, v164 quad_perm:[2,3,0,1] row_mask:0xf bank_mask:0xf
    v_add_f32_dpp v165, v165, v165 quad_perm:[2,3,0,1] row_mask:0xf bank_mask:0xf
    v_add_f32_dpp v166, v166, v166 quad_perm:[2,3,0,1] row_mask:0xf bank_mask:0xf
    v_add_f32_dpp v167, v167, v167 quad_perm:[2,3,0,1] row_mask:0xf bank_mask:0xf
    v_lshrrev_b32 v18, 2, v2
    v_lshlrev_b32 v18, 6, v18
    v_lshl_add_u32 v18, v3, 4, v18
    v_lshl_add_u32 v18, s22, 8, v18
    ds_write_b128 v18, v[164:167] offset:64
    s_waitcnt vmcnt(12)
    s_waitcnt lgkmcnt(0)
    s_barrier
    s_cmp_lg_u32 s22, 7
    s_cbranch_scc1 P1_S12
    ds_read2_b32 v[92:93], v49 offset0:16 offset1:32
    ds_read2_b32 v[94:95], v49 offset0:80 offset1:96
    ds_read2_b32 v[96:97], v49 offset0:144 offset1:160
    ds_read2_b32 v[98:99], v49 offset0:208 offset1:224
    s_lshl_b32 s24, s21, 10
    s_add_u32 s24, s24, s52
    v_mov_b32 v101, v250
    v_mov_b32 v103, v250
    s_waitcnt lgkmcnt(0)
    v_add_f32 v92, v92, v94
    v_add_f32 v93, v93, v95
    v_add_f32 v96, v96, v98
    v_add_f32 v97, v97, v99
    v_add_f32 v100, v92, v96
    v_add_f32 v102, v93, v97
    buffer_store_dwordx4 v[100:103], v23, s[12:15], s24 offen sc1
P1_S12:
    ds_read_b128 v[108:111], v32 offset:0
    ds_read_b128 v[112:115], v32 offset:4096
    ds_read_b64_tr_b16 v[132:133], v24 offset:57344
    ds_read_b64_tr_b16 v[134:135], v24 offset:59392
    ds_read_b64_tr_b16 v[136:137], v26 offset:57344
    ds_read_b64_tr_b16 v[138:139], v26 offset:59392
    s_waitcnt lgkmcnt(12)
    v_mfma_f32_16x16x32_bf16 v[52:55], v[140:143], v[116:119], 0
    v_mov_b32 v251, 0
    v_mfma_f32_16x16x32_bf16 v[56:59], v[140:143], v[120:123], 0
    ds_read_b32 v250, v251 offset:32
    v_mfma_f32_16x16x32_bf16 v[68:71], v[8:11], v[140:143], 0
    ds_read_b64_tr_b16 v[100:101], v44
    v_mfma_f32_16x16x32_bf16 v[60:63], v[144:147], v[116:119], 0
    ds_read_b64_tr_b16 v[102:103], v45
    v_mfma_f32_16x16x32_bf16 v[64:67], v[144:147], v[120:123], 0
    ds_read_b128 v[76:79], v48 offset:0
    ds_read_b128 v[116:119], v33 offset:0
    ds_read_b128 v[120:123], v33 offset:4096
    ds_read_b64_tr_b16 v[140:141], v25 offset:0
    ds_read_b64_tr_b16 v[142:143], v25 offset:2048
    ds_read_b64_tr_b16 v[144:145], v27 offset:0
    ds_read_b64_tr_b16 v[146:147], v27 offset:2048
    s_waitcnt lgkmcnt(12)
    v_mfma_f32_16x16x32_bf16 v[52:55], v[148:151], v[124:127], v[52:55]
    ds_read_b128 v[84:87], v48 offset:256
    v_mfma_f32_16x16x32_bf16 v[56:59], v[148:151], v[128:131], v[56:59]
    ds_read_b128 v[80:83], v48 offset:16
    v_mfma_f32_16x16x32_bf16 v[68:71], v[8:11], v[148:151], v[68:71]
    ds_read_b128 v[88:91], v48 offset:272
    v_mfma_f32_16x16x32_bf16 v[60:63], v[152:155], v[124:127], v[60:63]
    v_mfma_f32_16x16x32_bf16 v[64:67], v[152:155], v[128:131], v[64:67]
    s_waitcnt vmcnt(0)
    v_lshlrev_b32 v16, 7, v1
    s_lshl_b32 s23, s2, 15
    s_lshl_b32 s24, s22, 12
    s_add_u32 s23, s23, s24
    s_mov_b32 exec_hi, 0
    buffer_load_dword v43, v16, s[16:19], s23 offen
    s_mov_b32 exec_hi, -1
    s_mul_i32 s23, s2, 3584
    s_min_u32 s24, s22, 6
    s_lshl_b32 s24, s24, 9
    s_add_u32 s23, s23, s24
    s_mov_b32 s60, s6
    s_and_b32 s61, s7, 0xffff
    s_mov_b32 s62, 0x000e0000
    s_mov_b32 s63, 0x00020000
    s_mov_b64 exec, 15
    buffer_load_dword v43, v16, s[60:63], s23 offen
    s_mov_b64 exec, -1
    s_barrier
    ds_read_b128 v[124:127], v30 offset:16384
    ds_read_b128 v[128:131], v30 offset:20480
    ds_read_b64_tr_b16 v[148:149], v25 offset:8192
    ds_read_b64_tr_b16 v[150:151], v25 offset:10240
    ds_read_b64_tr_b16 v[152:153], v27 offset:8192
    ds_read_b64_tr_b16 v[154:155], v27 offset:10240
    s_waitcnt lgkmcnt(12)
    v_mfma_f32_16x16x32_bf16 v[52:55], v[132:135], v[108:111], v[52:55]
    ds_write_b128 v37, v[180:183] offset:40960
    v_mfma_f32_16x16x32_bf16 v[56:59], v[132:135], v[112:115], v[56:59]
    ds_write_b128 v37, v[184:187] offset:49152
    v_mfma_f32_16x16x32_bf16 v[68:71], v[8:11], v[132:135], v[68:71]
    v_mfma_f32_16x16x32_bf16 v[60:63], v[136:139], v[108:111], v[60:63]
    v_mfma_f32_16x16x32_bf16 v[64:67], v[136:139], v[112:115], v[64:67]
    ds_read_b128 v[108:111], v31 offset:16384
    ds_read_b128 v[112:115], v31 offset:20480
    ds_read_b64_tr_b16 v[132:133], v25 offset:16384
    ds_read_b64_tr_b16 v[134:135], v25 offset:18432
    ds_read_b64_tr_b16 v[136:137], v27 offset:16384
    ds_read_b64_tr_b16 v[138:139], v27 offset:18432
    s_waitcnt lgkmcnt(12)
    v_mfma_f32_16x16x32_bf16 v[52:55], v[140:143], v[116:119], v[52:55]
    v_mfma_f32_16x16x32_bf16 v[56:59], v[140:143], v[120:123], v[56:59]
    v_mfma_f32_16x16x32_bf16 v[68:71], v[8:11], v[140:143], v[68:71]
    v_mfma_f32_16x16x32_bf16 v[60:63], v[144:147], v[116:119], v[60:63]
    v_mfma_f32_16x16x32_bf16 v[64:67], v[144:147], v[120:123], v[64:67]
    s_barrier
    ds_read_b128 v[116:119], v32 offset:16384
    ds_read_b128 v[120:123], v32 offset:20480
    ds_read_b64_tr_b16 v[140:141], v24 offset:0
    ds_read_b64_tr_b16 v[142:143], v24 offset:2048
    ds_read_b64_tr_b16 v[144:145], v26 offset:0
    ds_read_b64_tr_b16 v[146:147], v26 offset:2048
    s_waitcnt lgkmcnt(12)
    v_mfma_f32_16x16x32_bf16 v[52:55], v[148:151], v[124:127], v[52:55]
    ds_write_b128 v37, v[188:191] offset:57344
    v_mfma_f32_16x16x32_bf16 v[56:59], v[148:151], v[128:131], v[56:59]
    ds_write_b128 v38, v[192:195] offset:0
    v_mfma_f32_16x16x32_bf16 v[68:71], v[8:11], v[148:151], v[68:71]
    ds_bpermute_b32 v100, v46, v100
    v_mfma_f32_16x16x32_bf16 v[60:63], v[152:155], v[124:127], v[60:63]
    ds_bpermute_b32 v101, v46, v101
    v_mfma_f32_16x16x32_bf16 v[64:67], v[152:155], v[128:131], v[64:67]
    ds_bpermute_b32 v102, v46, v102
    ds_read_b128 v[124:127], v33 offset:16384
    ds_read_b128 v[128:131], v33 offset:20480
    ds_read_b64_tr_b16 v[148:149], v24 offset:8192
    ds_read_b64_tr_b16 v[150:151], v24 offset:10240
    ds_read_b64_tr_b16 v[152:153], v26 offset:8192
    ds_read_b64_tr_b16 v[154:155], v26 offset:10240
    s_waitcnt lgkmcnt(12)
    v_mfma_f32_16x16x32_bf16 v[52:55], v[132:135], v[108:111], v[52:55]
    ds_bpermute_b32 v103, v46, v103
    v_mfma_f32_16x16x32_bf16 v[56:59], v[132:135], v[112:115], v[56:59]
    v_mfma_f32_16x16x32_bf16 v[68:71], v[8:11], v[132:135], v[68:71]
    v_mfma_f32_16x16x32_bf16 v[60:63], v[136:139], v[108:111], v[60:63]
    v_mfma_f32_16x16x32_bf16 v[64:67], v[136:139], v[112:115], v[64:67]
    s_waitcnt lgkmcnt(0)
    s_barrier
    ds_read_b128 v[108:111], v30 offset:32768
    ds_read_b128 v[112:115], v30 offset:36864
    ds_read_b64_tr_b16 v[132:133], v24 offset:16384
    ds_read_b64_tr_b16 v[134:135], v24 offset:18432
    ds_read_b64_tr_b16 v[136:137], v26 offset:16384
    ds_read_b64_tr_b16 v[138:139], v26 offset:18432
    s_waitcnt lgkmcnt(12)
    v_mfma_f32_16x16x32_bf16 v[52:55], v[140:143], v[116:119], v[52:55]
    ds_write_b128 v38, v[196:199] offset:8192
    v_lshlrev_b32 v92, 16, v100
    v_and_b32 v93, 0xffff0000, v100
    v_mfma_f32_16x16x32_bf16 v[56:59], v[140:143], v[120:123], v[56:59]
    v_lshlrev_b32 v94, 16, v101
    v_and_b32 v95, 0xffff0000, v101
    v_lshlrev_b32 v96, 16, v102
    v_mfma_f32_16x16x32_bf16 v[68:71], v[8:11], v[140:143], v[68:71]
    v_and_b32 v97, 0xffff0000, v102
    v_lshlrev_b32 v98, 16, v103
    v_and_b32 v99, 0xffff0000, v103
    v_mfma_f32_16x16x32_bf16 v[60:63], v[144:147], v[116:119], v[60:63]
    v_add_f32 v92, v92, v76
    v_add_f32 v93, v93, v77
    v_add_f32 v94, v94, v78
    v_mfma_f32_16x16x32_bf16 v[64:67], v[144:147], v[120:123], v[64:67]
    v_add_f32 v95, v95, v79
    v_add_f32 v96, v96, v80
    v_add_f32 v97, v97, v81
    ds_read_b128 v[116:119], v31 offset:32768
    ds_read_b128 v[120:123], v31 offset:36864
    ds_read_b64_tr_b16 v[140:141], v24 offset:24576
    ds_read_b64_tr_b16 v[142:143], v24 offset:26624
    ds_read_b64_tr_b16 v[144:145], v26 offset:24576
    ds_read_b64_tr_b16 v[146:147], v26 offset:26624
    s_waitcnt lgkmcnt(12)
    v_mfma_f32_16x16x32_bf16 v[52:55], v[148:151], v[124:127], v[52:55]
    v_add_f32 v98, v98, v82
    v_add_f32 v99, v99, v83
    v_mul_f32 v92, v92, v84
    v_mfma_f32_16x16x32_bf16 v[56:59], v[148:151], v[128:131], v[56:59]
    v_mul_f32 v93, v93, v85
    v_mul_f32 v94, v94, v86
    v_mul_f32 v95, v95, v87
    v_mfma_f32_16x16x32_bf16 v[68:71], v[8:11], v[148:151], v[68:71]
    v_mul_f32 v96, v96, v88
    v_mul_f32 v97, v97, v89
    v_mul_f32 v98, v98, v90
    v_mfma_f32_16x16x32_bf16 v[60:63], v[152:155], v[124:127], v[60:63]
    v_mul_f32 v99, v99, v91
    v_mfma_f32_16x16x32_bf16 v[64:67], v[152:155], v[128:131], v[64:67]
    s_cmp_lg_u32 s22, 7
    s_cbranch_scc1 P1_S13
    buffer_load_dwordx4 v[208:211], v23, s[12:15], s52 offen offset:0 sc1
    buffer_load_dwordx4 v[212:215], v23, s[12:15], s52 offen offset:1024 sc1
    buffer_load_dwordx4 v[216:219], v23, s[12:15], s52 offen offset:2048 sc1
    buffer_load_dwordx4 v[220:223], v23, s[12:15], s52 offen offset:3072 sc1
    buffer_load_dwordx4 v[224:227], v23, s[12:15], s53 offen offset:0 sc1
    buffer_load_dwordx4 v[228:231], v23, s[12:15], s53 offen offset:1024 sc1
    buffer_load_dwordx4 v[232:235], v23, s[12:15], s53 offen offset:2048 sc1
    buffer_load_dwordx4 v[236:239], v23, s[12:15], s53 offen offset:3072 sc1
P1_S13:
    ds_read_b128 v[124:127], v32 offset:32768
    ds_read_b128 v[128:131], v32 offset:36864
    ds_read_b64_tr_b16 v[148:149], v24 offset:32768
    ds_read_b64_tr_b16 v[150:151], v24 offset:34816
    ds_read_b64_tr_b16 v[152:153], v26 offset:32768
    ds_read_b64_tr_b16 v[154:155], v26 offset:34816
    s_waitcnt lgkmcnt(12)
    v_mfma_f32_16x16x32_bf16 v[52:55], v[132:135], v[108:111], v[52:55]
    v_cvt_pk_bf16_f32 v100, v92, v93
    v_mfma_f32_16x16x32_bf16 v[56:59], v[132:135], v[112:115], v[56:59]
    v_cvt_pk_bf16_f32 v101, v94, v95
    v_mfma_f32_16x16x32_bf16 v[68:71], v[8:11], v[132:135], v[68:71]
    v_cvt_pk_bf16_f32 v102, v96, v97
    v_mfma_f32_16x16x32_bf16 v[60:63], v[136:139], v[108:111], v[60:63]
    v_cvt_pk_bf16_f32 v103, v98, v99
    v_mfma_f32_16x16x32_bf16 v[64:67], v[136:139], v[112:115], v[64:67]
    buffer_store_dwordx4 v[100:103], v47, s[12:15], s51 offen sc1
    ds_read_b128 v[108:111], v33 offset:32768
    ds_read_b128 v[112:115], v33 offset:36864
    ds_read_b64_tr_b16 v[132:133], v24 offset:40960
    ds_read_b64_tr_b16 v[134:135], v24 offset:43008
    ds_read_b64_tr_b16 v[136:137], v26 offset:40960
    ds_read_b64_tr_b16 v[138:139], v26 offset:43008
    s_waitcnt lgkmcnt(12)
    v_mfma_f32_16x16x32_bf16 v[52:55], v[140:143], v[116:119], v[52:55]
    v_mfma_f32_16x16x32_bf16 v[56:59], v[140:143], v[120:123], v[56:59]
    v_mfma_f32_16x16x32_bf16 v[68:71], v[8:11], v[140:143], v[68:71]
    v_mfma_f32_16x16x32_bf16 v[60:63], v[144:147], v[116:119], v[60:63]
    v_mfma_f32_16x16x32_bf16 v[64:67], v[144:147], v[120:123], v[64:67]
    ds_read_b128 v[116:119], v30 offset:49152
    ds_read_b128 v[120:123], v30 offset:53248
    ds_read_b64_tr_b16 v[140:141], v24 offset:49152
    ds_read_b64_tr_b16 v[142:143], v24 offset:51200
    ds_read_b64_tr_b16 v[144:145], v26 offset:49152
    ds_read_b64_tr_b16 v[146:147], v26 offset:51200
    s_waitcnt lgkmcnt(12)
    v_mfma_f32_16x16x32_bf16 v[52:55], v[148:151], v[124:127], v[52:55]
    v_mfma_f32_16x16x32_bf16 v[56:59], v[148:151], v[128:131], v[56:59]
    v_mfma_f32_16x16x32_bf16 v[68:71], v[8:11], v[148:151], v[68:71]
    v_mfma_f32_16x16x32_bf16 v[60:63], v[152:155], v[124:127], v[60:63]
    v_mfma_f32_16x16x32_bf16 v[64:67], v[152:155], v[128:131], v[64:67]
    ds_read_b128 v[124:127], v31 offset:49152
    ds_read_b128 v[128:131], v31 offset:53248
    ds_read_b64_tr_b16 v[148:149], v24 offset:57344
    ds_read_b64_tr_b16 v[150:151], v24 offset:59392
    ds_read_b64_tr_b16 v[152:153], v26 offset:57344
    ds_read_b64_tr_b16 v[154:155], v26 offset:59392
    s_waitcnt lgkmcnt(12)
    v_mfma_f32_16x16x32_bf16 v[52:55], v[132:135], v[108:111], v[52:55]
    v_mfma_f32_16x16x32_bf16 v[56:59], v[132:135], v[112:115], v[56:59]
    v_mfma_f32_16x16x32_bf16 v[68:71], v[8:11], v[132:135], v[68:71]
    v_mfma_f32_16x16x32_bf16 v[60:63], v[136:139], v[108:111], v[60:63]
    v_mfma_f32_16x16x32_bf16 v[64:67], v[136:139], v[112:115], v[64:67]
    s_cmp_lg_u32 s22, 7
    s_cbranch_scc1 P1_S14
    s_waitcnt vmcnt(0)
    s_mov_b32 s25, 0
P1_POLL12:
    v_xor_b32 v209, v250, v209
    v_xor_b32 v211, v250, v211
    v_xor_b32 v213, v250, v213
    v_xor_b32 v215, v250, v215
    v_xor_b32 v217, v250, v217
    v_xor_b32 v219, v250, v219
    v_xor_b32 v221, v250, v221
    v_xor_b32 v223, v250, v223
    v_xor_b32 v225, v250, v225
    v_xor_b32 v227, v250, v227
    v_xor_b32 v229, v250, v229
    v_xor_b32 v231, v250, v231
    v_xor_b32 v233, v250, v233
    v_xor_b32 v235, v250, v235
    v_xor_b32 v237, v250, v237
    v_xor_b32 v239, v250, v239
    v_or3_b32 v209, v209, v211, v213
    v_or3_b32 v209, v209, v215, v217
    v_or3_b32 v209, v209, v219, v221
    v_or3_b32 v209, v209, v223, v225
    v_or3_b32 v209, v209, v227, v229
    v_or3_b32 v209, v209, v231, v233
    v_or3_b32 v209, v209, v235, v237
    v_or3_b32 v209, v209, v239, v239
    v_cmp_ne_u32 vcc, 0, v209
    s_cmp_eq_u64 vcc, 0
    s_cbranch_scc1 P1_GO12
    buffer_load_dwordx4 v[208:211], v23, s[12:15], s52 offen offset:0 sc1
    buffer_load_dwordx4 v[212:215], v23, s[12:15], s52 offen offset:1024 sc1
    buffer_load_dwordx4 v[216:219], v23, s[12:15], s52 offen offset:2048 sc1
    buffer_load_dwordx4 v[220:223], v23, s[12:15], s52 offen offset:3072 sc1
    buffer_load_dwordx4 v[224:227], v23, s[12:15], s53 offen offset:0 sc1
    buffer_load_dwordx4 v[228:231], v23, s[12:15], s53 offen offset:1024 sc1
    buffer_load_dwordx4 v[232:235], v23, s[12:15], s53 offen offset:2048 sc1
    buffer_load_dwordx4 v[236:239], v23, s[12:15], s53 offen offset:3072 sc1
    s_waitcnt vmcnt(0)
    s_add_u32 s25, s25, 1
    s_cmp_lt_u32 s25, 0x20000
    s_cbranch_scc1 P1_POLL12
P1_GO12:
    v_add_f32 v208, v208, v224
    v_add_f32 v210, v210, v226
    v_add_f32 v212, v212, v228
    v_add_f32 v214, v214, v230
    v_add_f32 v216, v216, v232
    v_add_f32 v218, v218, v234
    v_add_f32 v220, v220, v236
    v_add_f32 v222, v222, v238
    v_add_f32 v208, v208, v216
    v_add_f32 v210, v210, v218
    v_add_f32 v212, v212, v220
    v_add_f32 v214, v214, v222
    v_add_f32 v208, v208, v212
    v_add_f32 v210, v210, v214
    v_mul_f32 v208, 0x3a924925, v208
    v_mul_f32 v210, 0x3a924925, v210
    v_fma_f32 v210, -v208, v208, v210
    v_max_f32 v210, 0, v210
    v_cvt_pk_bf16_f32 v214, v208, v210
    v_lshlrev_b32 v212, 16, v214
    v_xor_b32 v212, 0x80000000, v212
    v_and_b32 v214, 0xffff0000, v214
    v_add_f32 v214, 0x3727c5ac, v214
    v_cvt_pk_bf16_f32 v214, v214, v214
    v_and_b32 v214, 0xffff0000, v214
    v_sqrt_f32 v214, v214
    s_nop 0
    v_cvt_pk_bf16_f32 v214, v214, v214
    v_and_b32 v214, 0xffff0000, v214
    v_rcp_f32 v213, v214
    v_lshlrev_b32 v16, 2, v1
    ds_write_b32 v16, v212 offset:2112
    ds_write_b32 v16, v213 offset:2368
    s_waitcnt lgkmcnt(0)
P1_S14:
    s_barrier
    v_lshlrev_b32 v16, 4, v3
    v_lshl_add_u32 v16, s36, 7, v16
    ds_read_b128 v[208:211], v16 offset:2112
    ds_read_b128 v[216:219], v16 offset:2368
    ds_read_b128 v[212:215], v16 offset:2176
    ds_read_b128 v[220:223], v16 offset:2432
    s_add_u32 s23, s44, s42
    s_lshl_b32 s23, s23, 6
    s_lshl_b32 s24, s20, 1
    s_add_u32 s23, s23, s24
    s_add_u32 s23, s23, s36
    s_lshl_b32 s23, s23, 10
    s_add_u32 s23, s23, 5832704
    v_and_b32 v17, 1, v3
    v_lshlrev_b32 v17, 9, v17
    v_lshrrev_b32 v18, 1, v3
    v_lshl_add_u32 v17, v18, 8, v17
    v_lshl_add_u32 v17, v2, 4, v17
    v_lshlrev_b32 v156, 16, v172
    v_lshlrev_b32 v157, 16, v173
    v_lshlrev_b32 v158, 16, v174
    v_lshlrev_b32 v159, 16, v175
    v_lshlrev_b32 v160, 16, v176
    v_lshlrev_b32 v161, 16, v177
    v_lshlrev_b32 v162, 16, v178
    v_lshlrev_b32 v163, 16, v179
    s_waitcnt lgkmcnt(0)
    v_pk_add_f32 v[156:157], v[156:157], v[208:209]
    v_pk_add_f32 v[158:159], v[158:159], v[210:211]
    v_pk_add_f32 v[160:161], v[160:161], v[212:213]
    v_pk_add_f32 v[162:163], v[162:163], v[214:215]
    v_pk_mul_f32 v[156:157], v[156:157], v[216:217]
    v_pk_mul_f32 v[158:159], v[158:159], v[218:219]
    v_pk_mul_f32 v[160:161], v[160:161], v[220:221]
    v_pk_mul_f32 v[162:163], v[162:163], v[222:223]
    v_cvt_pk_bf16_f32 v224, v156, v157
    v_cvt_pk_bf16_f32 v225, v158, v159
    v_cvt_pk_bf16_f32 v226, v160, v161
    v_cvt_pk_bf16_f32 v227, v162, v163
    s_nop 0
    v_permlane16_swap_b32 v224, v226
    v_permlane16_swap_b32 v225, v227
    buffer_store_dwordx4 v[224:227], v17, s[12:15], s23 offen sc1
    ds_read_b128 v[108:111], v32 offset:49152
    ds_read_b128 v[112:115], v32 offset:53248
    ds_read_b64_tr_b16 v[132:133], v25 offset:0
    ds_read_b64_tr_b16 v[134:135], v25 offset:2048
    ds_read_b64_tr_b16 v[136:137], v27 offset:0
    ds_read_b64_tr_b16 v[138:139], v27 offset:2048
    s_waitcnt lgkmcnt(12)
    v_mfma_f32_16x16x32_bf16 v[52:55], v[140:143], v[116:119], v[52:55]
    v_mfma_f32_16x16x32_bf16 v[56:59], v[140:143], v[120:123], v[56:59]
    v_mfma_f32_16x16x32_bf16 v[68:71], v[8:11], v[140:143], v[68:71]
    v_mfma_f32_16x16x32_bf16 v[60:63], v[144:147], v[116:119], v[60:63]
    v_mfma_f32_16x16x32_bf16 v[64:67], v[144:147], v[120:123], v[64:67]
    ds_read_b128 v[116:119], v33 offset:49152
    ds_read_b128 v[120:123], v33 offset:53248
    ds_read_b64_tr_b16 v[140:141], v25 offset:8192
    ds_read_b64_tr_b16 v[142:143], v25 offset:10240
    ds_read_b64_tr_b16 v[144:145], v27 offset:8192
    ds_read_b64_tr_b16 v[146:147], v27 offset:10240
    s_waitcnt lgkmcnt(12)
    v_mfma_f32_16x16x32_bf16 v[52:55], v[148:151], v[124:127], v[52:55]
    v_mfma_f32_16x16x32_bf16 v[56:59], v[148:151], v[128:131], v[56:59]
    v_mfma_f32_16x16x32_bf16 v[68:71], v[8:11], v[148:151], v[68:71]
    v_mfma_f32_16x16x32_bf16 v[60:63], v[152:155], v[124:127], v[60:63]
    v_mfma_f32_16x16x32_bf16 v[64:67], v[152:155], v[128:131], v[64:67]
    s_waitcnt lgkmcnt(6)
    v_mfma_f32_16x16x32_bf16 v[52:55], v[132:135], v[108:111], v[52:55]
    v_mfma_f32_16x16x32_bf16 v[56:59], v[132:135], v[112:115], v[56:59]
    v_mfma_f32_16x16x32_bf16 v[68:71], v[8:11], v[132:135], v[68:71]
    v_mfma_f32_16x16x32_bf16 v[60:63], v[136:139], v[108:111], v[60:63]
    v_mfma_f32_16x16x32_bf16 v[64:67], v[136:139], v[112:115], v[64:67]
    s_waitcnt lgkmcnt(0)
    v_mfma_f32_16x16x32_bf16 v[52:55], v[140:143], v[116:119], v[52:55]
    v_mfma_f32_16x16x32_bf16 v[56:59], v[140:143], v[120:123], v[56:59]
    v_mfma_f32_16x16x32_bf16 v[68:71], v[8:11], v[140:143], v[68:71]
    v_mfma_f32_16x16x32_bf16 v[60:63], v[144:147], v[116:119], v[60:63]
    v_mfma_f32_16x16x32_bf16 v[64:67], v[144:147], v[120:123], v[64:67]
    s_xor_b32 s23, s36, 0
    s_add_u32 s23, s23, s48
    s_lshl_b32 s23, s23, 6
    s_add_u32 s23, s23, 162560
    v_lshl_add_u32 v19, v2, 2, s23
    s_nop 0
    ds_write_b32 v19, v68
    s_xor_b32 s23, s36, 0
    s_add_u32 s23, s23, s48
    s_lshl_b32 s23, s23, 6
    s_add_u32 s23, s23, 162560
    v_lshl_add_u32 v19, v3, 4, s23
    s_xor_b32 s23, s36, 1
    s_add_u32 s23, s23, s48
    s_lshl_b32 s23, s23, 6
    s_add_u32 s23, s23, 162560
    v_lshl_add_u32 v20, v3, 4, s23
    s_waitcnt lgkmcnt(0)
    s_waitcnt vmcnt(0)
    s_barrier
    s_setprio 0
    ds_read_b128 v[68:71], v19
    ds_read_b128 v[72:75], v20
    s_cmp_lg_u32 s22, 0
    s_cbranch_scc1 KF_A2
    s_lshl_b32 s24, s20, 1
    s_and_b32 s25, s21, 1
    s_add_u32 s24, s24, s25
    s_lshl_b32 s24, s24, 2
    s_lshr_b32 s23, s21, 1
    s_lshl_b32 s23, s23, 8
    s_add_u32 s23, s23, s24
    s_add_u32 s23, s23, 15532032
    v_lshlrev_b32 v252, 10, v1
    s_mov_b64 exec, 0xf
    buffer_store_dword v250, v252, s[12:15], s23 offen sc1
    s_mov_b64 exec, -1
KF_A2:
    v_lshlrev_b32 v18, 2, v2
    v_lshl_add_u32 v18, s36, 7, v18
    v_add_u32 v18, 161536, v18
    ds_read_b32 v84, v18 offset:0
    ds_read_b32 v88, v18 offset:256
    ds_read_b32 v86, v18 offset:64
    ds_read_b32 v90, v18 offset:320
    s_lshl_b32 s23, s20, 2
    s_lshl_b32 s24, s36, 1
    s_add_u32 s23, s23, s24
    s_mul_i32 s23, s23, 56
    s_add_u32 s23, s23, s45
    s_add_u32 s23, s23, s43
    s_lshl_b32 s23, s23, 9
    s_add_u32 s46, s23, 2162688
    s_add_u32 s47, s46, 28672
    v_lshl_add_u32 v21, s36, 9, v22
    v_xor_b32 v23, 0x200, v21
    s_cmp_ge_u32 s22, 4
    s_cbranch_scc1 KF_WV3
    s_mul_i32 s28, s21, 458752
    s_lshl_b32 s23, s22, 14
    s_add_u32 s28, s28, s23
    s_add_u32 s28, s28, 5832704
    s_add_u32 s29, s28, 65536
    s_add_u32 s30, s28, 131072
    s_add_u32 s31, s28, 196608
    s_add_u32 s32, s28, 262144
    s_add_u32 s33, s28, 327680
    s_add_u32 s34, s28, 393216
    s_lshl_b32 s23, s20, 18
    s_lshl_b32 s24, s22, 10
    s_add_u32 s23, s23, s24
    s_xor_b32 s24, s22, 0
    s_lshl_b32 s24, s24, 16
    s_add_u32 s36, s23, s24
    s_xor_b32 s24, s22, 1
    s_lshl_b32 s24, s24, 16
    s_add_u32 s37, s23, s24
    s_xor_b32 s24, s22, 2
    s_lshl_b32 s24, s24, 16
    s_add_u32 s38, s23, s24
    s_xor_b32 s24, s22, 3
    s_lshl_b32 s24, s24, 16
    s_add_u32 s39, s23, s24
    s_mul_i32 s40, s22, 24576
    s_add_u32 s40, s40, 63232
    v_lshlrev_b32 v7, 4, v1
    v_and_b32 v124, 7, v1
    v_lshrrev_b32 v125, 3, v1
    v_xor_b32 v126, v124, v3
    v_lshlrev_b32 v8, 12, v125
    v_lshl_add_u32 v8, v126, 4, v8
    v_xor_b32 v240, 64, v8
    v_add_u32 v240, 0x8000, v240
    v_lshrrev_b32 v124, 1, v2
    v_xor_b32 v124, v124, v3
    v_lshlrev_b32 v9, 7, v2
    v_lshl_add_u32 v9, v124, 4, v9
    v_add_u32 v9, s40, v9
    v_xor_b32 v241, 64, v9
    s_and_b32 s41, s20, 7
    s_lshl_b32 s41, s41, 1
    s_mov_b32 s41, 0
    s_add_u32 s23, s41, 0
    s_and_b32 s23, s23, 15
    s_lshl_b32 s23, s23, 6
    s_add_u32 s23, s23, s36
    s_add_u32 m0, s40, 0
    s_nop 0
    buffer_load_dwordx4 v8, s[16:19], s23 offen lds
    s_add_u32 s23, s41, 0
    s_and_b32 s23, s23, 15
    s_lshl_b32 s23, s23, 6
    s_add_u32 s23, s23, s36
    s_add_u32 m0, s40, 1024
    s_nop 0
    buffer_load_dwordx4 v240, s[16:19], s23 offen lds
    s_add_u32 s23, s41, 0
    s_and_b32 s23, s23, 15
    s_lshl_b32 s23, s23, 6
    s_add_u32 s23, s23, s37
    s_add_u32 m0, s40, 2048
    s_nop 0
    buffer_load_dwordx4 v8, s[16:19], s23 offen lds
    s_add_u32 s23, s41, 0
    s_and_b32 s23, s23, 15
    s_lshl_b32 s23, s23, 6
    s_add_u32 s23, s23, s37
    s_add_u32 m0, s40, 3072
    s_nop 0
    buffer_load_dwordx4 v240, s[16:19], s23 offen lds
    s_add_u32 s23, s41, 0
    s_and_b32 s23, s23, 15
    s_lshl_b32 s23, s23, 6
    s_add_u32 s23, s23, s38
    s_add_u32 m0, s40, 4096
    s_nop 0
    buffer_load_dwordx4 v8, s[16:19], s23 offen lds
    s_add_u32 s23, s41, 0
    s_and_b32 s23, s23, 15
    s_lshl_b32 s23, s23, 6
    s_add_u32 s23, s23, s38
    s_add_u32 m0, s40, 5120
    s_nop 0
    buffer_load_dwordx4 v240, s[16:19], s23 offen lds
    s_add_u32 s23, s41, 0
    s_and_b32 s23, s23, 15
    s_lshl_b32 s23, s23, 6
    s_add_u32 s23, s23, s39
    s_add_u32 m0, s40, 6144
    s_nop 0
    buffer_load_dwordx4 v8, s[16:19], s23 offen lds
    s_add_u32 s23, s41, 0
    s_and_b32 s23, s23, 15
    s_lshl_b32 s23, s23, 6
    s_add_u32 s23, s23, s39
    s_add_u32 m0, s40, 7168
    s_nop 0
    buffer_load_dwordx4 v240, s[16:19], s23 offen lds
KF_WV3:
    s_waitcnt lgkmcnt(0)
    v_pk_fma_f32 v[52:53], v[68:69], v[84:85], v[52:53] op_sel_hi:[1,0,1]
    v_pk_fma_f32 v[54:55], v[70:71], v[84:85], v[54:55] op_sel_hi:[1,0,1]
    v_pk_fma_f32 v[56:57], v[68:69], v[86:87], v[56:57] op_sel_hi:[1,0,1]
    v_pk_fma_f32 v[58:59], v[70:71], v[86:87], v[58:59] op_sel_hi:[1,0,1]
    v_pk_fma_f32 v[60:61], v[72:73], v[84:85], v[60:61] op_sel_hi:[1,0,1]
    v_pk_fma_f32 v[62:63], v[74:75], v[84:85], v[62:63] op_sel_hi:[1,0,1]
    s_cmp_ge_u32 s22, 4
    s_cbranch_scc1 KF_WV4
    s_add_u32 s23, s41, 2
    s_and_b32 s23, s23, 15
    s_lshl_b32 s23, s23, 6
    s_add_u32 s23, s23, s36
    s_add_u32 m0, s40, 8192
    s_nop 0
    buffer_load_dwordx4 v8, s[16:19], s23 offen lds
    s_add_u32 s23, s41, 2
    s_and_b32 s23, s23, 15
    s_lshl_b32 s23, s23, 6
    s_add_u32 s23, s23, s36
    s_add_u32 m0, s40, 9216
    s_nop 0
    buffer_load_dwordx4 v240, s[16:19], s23 offen lds
KF_WV4:
    v_pk_fma_f32 v[64:65], v[72:73], v[86:87], v[64:65] op_sel_hi:[1,0,1]
    v_pk_fma_f32 v[66:67], v[74:75], v[86:87], v[66:67] op_sel_hi:[1,0,1]
    v_pk_mul_f32 v[52:53], v[52:53], v[88:89] op_sel_hi:[1,0]
    v_pk_mul_f32 v[54:55], v[54:55], v[88:89] op_sel_hi:[1,0]
    v_pk_mul_f32 v[56:57], v[56:57], v[90:91] op_sel_hi:[1,0]
    v_pk_mul_f32 v[58:59], v[58:59], v[90:91] op_sel_hi:[1,0]
    s_cmp_ge_u32 s22, 4
    s_cbranch_scc1 KF_WV5
    s_add_u32 s23, s41, 2
    s_and_b32 s23, s23, 15
    s_lshl_b32 s23, s23, 6
    s_add_u32 s23, s23, s37
    s_add_u32 m0, s40, 10240
    s_nop 0
    buffer_load_dwordx4 v8, s[16:19], s23 offen lds
    s_add_u32 s23, s41, 2
    s_and_b32 s23, s23, 15
    s_lshl_b32 s23, s23, 6
    s_add_u32 s23, s23, s37
    s_add_u32 m0, s40, 11264
    s_nop 0
    buffer_load_dwordx4 v240, s[16:19], s23 offen lds
KF_WV5:
    v_pk_mul_f32 v[60:61], v[60:61], v[88:89] op_sel_hi:[1,0]
    v_pk_mul_f32 v[62:63], v[62:63], v[88:89] op_sel_hi:[1,0]
    v_pk_mul_f32 v[64:65], v[64:65], v[90:91] op_sel_hi:[1,0]
    v_pk_mul_f32 v[66:67], v[66:67], v[90:91] op_sel_hi:[1,0]
    v_pk_mul_f32 v[92:93], v[52:53], v[52:53]
    v_pk_mul_f32 v[94:95], v[54:55], v[54:55]
    s_cmp_ge_u32 s22, 4
    s_cbranch_scc1 KF_WV6
    s_add_u32 s23, s41, 2
    s_and_b32 s23, s23, 15
    s_lshl_b32 s23, s23, 6
    s_add_u32 s23, s23, s38
    s_add_u32 m0, s40, 12288
    s_nop 0
    buffer_load_dwordx4 v8, s[16:19], s23 offen lds
    s_add_u32 s23, s41, 2
    s_and_b32 s23, s23, 15
    s_lshl_b32 s23, s23, 6
    s_add_u32 s23, s23, s38
    s_add_u32 m0, s40, 13312
    s_nop 0
    buffer_load_dwordx4 v240, s[16:19], s23 offen lds
KF_WV6:
    v_pk_mul_f32 v[96:97], v[56:57], v[56:57]
    v_pk_mul_f32 v[98:99], v[58:59], v[58:59]
    v_pk_mul_f32 v[100:101], v[60:61], v[60:61]
    v_pk_mul_f32 v[102:103], v[62:63], v[62:63]
    v_pk_mul_f32 v[104:105], v[64:65], v[64:65]
    v_pk_mul_f32 v[106:107], v[66:67], v[66:67]
    s_cmp_ge_u32 s22, 4
    s_cbranch_scc1 KF_WV7
    s_add_u32 s23, s41, 2
    s_and_b32 s23, s23, 15
    s_lshl_b32 s23, s23, 6
    s_add_u32 s23, s23, s39
    s_add_u32 m0, s40, 14336
    s_nop 0
    buffer_load_dwordx4 v8, s[16:19], s23 offen lds
    s_add_u32 s23, s41, 2
    s_and_b32 s23, s23, 15
    s_lshl_b32 s23, s23, 6
    s_add_u32 s23, s23, s39
    s_add_u32 m0, s40, 15360
    s_nop 0
    buffer_load_dwordx4 v240, s[16:19], s23 offen lds
KF_WV7:
    v_pk_fma_f32 v[92:93], v[92:93], s[54:55], v[12:13]
    v_pk_fma_f32 v[94:95], v[94:95], s[54:55], v[12:13]
    v_pk_fma_f32 v[96:97], v[96:97], s[54:55], v[12:13]
    v_pk_fma_f32 v[98:99], v[98:99], s[54:55], v[12:13]
    v_pk_fma_f32 v[100:101], v[100:101], s[54:55], v[12:13]
    v_pk_fma_f32 v[102:103], v[102:103], s[54:55], v[12:13]
    s_cmp_ge_u32 s22, 4
    s_cbranch_scc1 KF_WV8
    s_add_u32 s23, s41, 4
    s_and_b32 s23, s23, 15
    s_lshl_b32 s23, s23, 6
    s_add_u32 s23, s23, s36
    s_add_u32 m0, s40, 16384
    s_nop 0
    buffer_load_dwordx4 v8, s[16:19], s23 offen lds
    s_add_u32 s23, s41, 4
    s_and_b32 s23, s23, 15
    s_lshl_b32 s23, s23, 6
    s_add_u32 s23, s23, s36
    s_add_u32 m0, s40, 17408
    s_nop 0
    buffer_load_dwordx4 v240, s[16:19], s23 offen lds
KF_WV8:
    v_pk_fma_f32 v[104:105], v[104:105], s[54:55], v[12:13]
    v_pk_fma_f32 v[106:107], v[106:107], s[54:55], v[12:13]
    v_pk_mul_f32 v[92:93], v[92:93], v[52:53]
    v_pk_mul_f32 v[94:95], v[94:95], v[54:55]
    v_pk_mul_f32 v[96:97], v[96:97], v[56:57]
    v_pk_mul_f32 v[98:99], v[98:99], v[58:59]
    s_cmp_ge_u32 s22, 4
    s_cbranch_scc1 KF_WV9
    s_add_u32 s23, s41, 4
    s_and_b32 s23, s23, 15
    s_lshl_b32 s23, s23, 6
    s_add_u32 s23, s23, s37
    s_add_u32 m0, s40, 18432
    s_nop 0
    buffer_load_dwordx4 v8, s[16:19], s23 offen lds
    s_add_u32 s23, s41, 4
    s_and_b32 s23, s23, 15
    s_lshl_b32 s23, s23, 6
    s_add_u32 s23, s23, s37
    s_add_u32 m0, s40, 19456
    s_nop 0
    buffer_load_dwordx4 v240, s[16:19], s23 offen lds
KF_WV9:
    v_pk_mul_f32 v[100:101], v[100:101], v[60:61]
    v_pk_mul_f32 v[102:103], v[102:103], v[62:63]
    v_pk_mul_f32 v[104:105], v[104:105], v[64:65]
    v_pk_mul_f32 v[106:107], v[106:107], v[66:67]
    v_exp_f32 v92, v92
    v_exp_f32 v93, v93
    s_cmp_ge_u32 s22, 4
    s_cbranch_scc1 KF_WV10
    s_add_u32 s23, s41, 4
    s_and_b32 s23, s23, 15
    s_lshl_b32 s23, s23, 6
    s_add_u32 s23, s23, s38
    s_add_u32 m0, s40, 20480
    s_nop 0
    buffer_load_dwordx4 v8, s[16:19], s23 offen lds
    s_add_u32 s23, s41, 4
    s_and_b32 s23, s23, 15
    s_lshl_b32 s23, s23, 6
    s_add_u32 s23, s23, s38
    s_add_u32 m0, s40, 21504
    s_nop 0
    buffer_load_dwordx4 v240, s[16:19], s23 offen lds
KF_WV10:
    v_exp_f32 v94, v94
    v_exp_f32 v95, v95
    v_exp_f32 v96, v96
    v_exp_f32 v97, v97
    v_exp_f32 v98, v98
    v_exp_f32 v99, v99
    s_cmp_ge_u32 s22, 4
    s_cbranch_scc1 KF_WV11
    s_add_u32 s23, s41, 4
    s_and_b32 s23, s23, 15
    s_lshl_b32 s23, s23, 6
    s_add_u32 s23, s23, s39
    s_add_u32 m0, s40, 22528
    s_nop 0
    buffer_load_dwordx4 v8, s[16:19], s23 offen lds
    s_add_u32 s23, s41, 4
    s_and_b32 s23, s23, 15
    s_lshl_b32 s23, s23, 6
    s_add_u32 s23, s23, s39
    s_add_u32 m0, s40, 23552
    s_nop 0
    buffer_load_dwordx4 v240, s[16:19], s23 offen lds
KF_WV11:
    v_exp_f32 v100, v100
    v_exp_f32 v101, v101
    v_exp_f32 v102, v102
    v_exp_f32 v103, v103
    v_exp_f32 v104, v104
    v_exp_f32 v105, v105
    s_cmp_ge_u32 s22, 4
    s_cbranch_scc1 KF_WV12
    s_waitcnt vmcnt(16)
    ds_read_b128 v[208:211], v9 offset:0
    ds_read_b128 v[212:215], v9 offset:2048
    ds_read_b128 v[216:219], v9 offset:4096
    ds_read_b128 v[220:223], v9 offset:6144
    ds_read_b128 v[224:227], v241 offset:0
    ds_read_b128 v[228:231], v241 offset:2048
    ds_read_b128 v[232:235], v241 offset:4096
    ds_read_b128 v[236:239], v241 offset:6144
KF_WV12:
    v_exp_f32 v106, v106
    v_exp_f32 v107, v107
    v_pk_add_f32 v[92:93], v[92:93], v[14:15]
    v_pk_add_f32 v[94:95], v[94:95], v[14:15]
    v_pk_add_f32 v[96:97], v[96:97], v[14:15]
    v_pk_add_f32 v[98:99], v[98:99], v[14:15]
    s_cmp_ge_u32 s22, 4
    s_cbranch_scc1 KF_WV13
    s_waitcnt lgkmcnt(0)
    s_add_u32 s23, s41, 6
    s_and_b32 s23, s23, 15
    s_lshl_b32 s23, s23, 6
    s_add_u32 s23, s23, s36
    s_add_u32 m0, s40, 0
    s_nop 0
    buffer_load_dwordx4 v8, s[16:19], s23 offen lds
    s_add_u32 s23, s41, 6
    s_and_b32 s23, s23, 15
    s_lshl_b32 s23, s23, 6
    s_add_u32 s23, s23, s36
    s_add_u32 m0, s40, 1024
    s_nop 0
    buffer_load_dwordx4 v240, s[16:19], s23 offen lds
KF_WV13:
    v_pk_add_f32 v[100:101], v[100:101], v[14:15]
    v_pk_add_f32 v[102:103], v[102:103], v[14:15]
    v_pk_add_f32 v[104:105], v[104:105], v[14:15]
    v_pk_add_f32 v[106:107], v[106:107], v[14:15]
    v_rcp_f32 v92, v92
    v_rcp_f32 v93, v93
    s_cmp_ge_u32 s22, 4
    s_cbranch_scc1 KF_WV14
    s_add_u32 s23, s41, 6
    s_and_b32 s23, s23, 15
    s_lshl_b32 s23, s23, 6
    s_add_u32 s23, s23, s37
    s_add_u32 m0, s40, 2048
    s_nop 0
    buffer_load_dwordx4 v8, s[16:19], s23 offen lds
    s_add_u32 s23, s41, 6
    s_and_b32 s23, s23, 15
    s_lshl_b32 s23, s23, 6
    s_add_u32 s23, s23, s37
    s_add_u32 m0, s40, 3072
    s_nop 0
    buffer_load_dwordx4 v240, s[16:19], s23 offen lds
KF_WV14:
    v_rcp_f32 v94, v94
    v_rcp_f32 v95, v95
    v_rcp_f32 v96, v96
    v_rcp_f32 v97, v97
    v_rcp_f32 v98, v98
    v_rcp_f32 v99, v99
    s_cmp_ge_u32 s22, 4
    s_cbranch_scc1 KF_WV15
    s_add_u32 s23, s41, 6
    s_and_b32 s23, s23, 15
    s_lshl_b32 s23, s23, 6
    s_add_u32 s23, s23, s38
    s_add_u32 m0, s40, 4096
    s_nop 0
    buffer_load_dwordx4 v8, s[16:19], s23 offen lds
    s_add_u32 s23, s41, 6
    s_and_b32 s23, s23, 15
    s_lshl_b32 s23, s23, 6
    s_add_u32 s23, s23, s38
    s_add_u32 m0, s40, 5120
    s_nop 0
    buffer_load_dwordx4 v240, s[16:19], s23 offen lds
KF_WV15:
    v_rcp_f32 v100, v100
    v_rcp_f32 v101, v101
    v_rcp_f32 v102, v102
    v_rcp_f32 v103, v103
    v_rcp_f32 v104, v104
    v_rcp_f32 v105, v105
    s_cmp_ge_u32 s22, 4
    s_cbranch_scc1 KF_WV16
    s_add_u32 s23, s41, 6
    s_and_b32 s23, s23, 15
    s_lshl_b32 s23, s23, 6
    s_add_u32 s23, s23, s39
    s_add_u32 m0, s40, 6144
    s_nop 0
    buffer_load_dwordx4 v8, s[16:19], s23 offen lds
    s_add_u32 s23, s41, 6
    s_and_b32 s23, s23, 15
    s_lshl_b32 s23, s23, 6
    s_add_u32 s23, s23, s39
    s_add_u32 m0, s40, 7168
    s_nop 0
    buffer_load_dwordx4 v240, s[16:19], s23 offen lds
KF_WV16:
    v_rcp_f32 v106, v106
    v_rcp_f32 v107, v107
    v_pk_mul_f32 v[52:53], v[52:53], v[92:93]
    v_pk_mul_f32 v[54:55], v[54:55], v[94:95]
    v_pk_mul_f32 v[56:57], v[56:57], v[96:97]
    v_pk_mul_f32 v[58:59], v[58:59], v[98:99]
    v_pk_mul_f32 v[60:61], v[60:61], v[100:101]
    v_pk_mul_f32 v[62:63], v[62:63], v[102:103]
    v_pk_mul_f32 v[64:65], v[64:65], v[104:105]
    v_pk_mul_f32 v[66:67], v[66:67], v[106:107]
    v_cvt_pk_bf16_f32 v76, v52, v53
    v_cvt_pk_bf16_f32 v77, v54, v55
    buffer_store_dwordx2 v[76:77], v21, s[12:15], s46 offen sc1
    v_cvt_pk_bf16_f32 v78, v56, v57
    v_cvt_pk_bf16_f32 v79, v58, v59
    buffer_store_dwordx2 v[78:79], v21, s[12:15], s47 offen sc1
    v_cvt_pk_bf16_f32 v80, v60, v61
    v_cvt_pk_bf16_f32 v81, v62, v63
    buffer_store_dwordx2 v[80:81], v23, s[12:15], s46 offen sc1
    v_cvt_pk_bf16_f32 v82, v64, v65
    v_cvt_pk_bf16_f32 v83, v66, v67
    buffer_store_dwordx2 v[82:83], v23, s[12:15], s47 offen sc1
    s_nop 1
    s_branch P1_DONE
P1_P21:
    s_xor_b32 s23, s36, 0
    s_add_u32 s23, s23, s47
    v_xor_b32 v16, s23, v29
    v_lshl_add_u32 v24, v16, 5, v28
    v_add_u32 v25, 0x10000, v24
    s_xor_b32 s23, s36, 1
    s_add_u32 s23, s23, s47
    v_xor_b32 v16, s23, v29
    v_lshl_add_u32 v26, v16, 5, v28
    v_add_u32 v27, 0x10000, v26
    s_cmp_eq_u32 s36, 0
    s_cbranch_scc1 P1_S15
    s_setprio 1
P1_S15:
    s_barrier
    ds_read_b128 v[108:111], v30 offset:0
    ds_read_b128 v[112:115], v30 offset:4096
    ds_read_b64_tr_b16 v[132:133], v24 offset:0
    ds_read_b64_tr_b16 v[134:135], v24 offset:2048
    ds_read_b64_tr_b16 v[136:137], v26 offset:0
    ds_read_b64_tr_b16 v[138:139], v26 offset:2048
    ds_read_b128 v[116:119], v31 offset:0
    ds_read_b128 v[120:123], v31 offset:4096
    ds_read_b64_tr_b16 v[140:141], v24 offset:8192
    ds_read_b64_tr_b16 v[142:143], v24 offset:10240
    ds_read_b64_tr_b16 v[144:145], v26 offset:8192
    ds_read_b64_tr_b16 v[146:147], v26 offset:10240
    s_cmp_lg_u32 s36, 0
    s_cbranch_scc1 P1_S16
    ds_read_b128 v[92:95], v39 offset:0
    ds_read_b128 v[96:99], v40 offset:0
    ds_read_b128 v[100:103], v41 offset:0
    ds_read_b128 v[104:107], v42 offset:0
P1_S16:
    ds_read_b128 v[124:127], v32 offset:0
    ds_read_b128 v[128:131], v32 offset:4096
    ds_read_b64_tr_b16 v[148:149], v24 offset:16384
    ds_read_b64_tr_b16 v[150:151], v24 offset:18432
    ds_read_b64_tr_b16 v[152:153], v26 offset:16384
    ds_read_b64_tr_b16 v[154:155], v26 offset:18432
    s_waitcnt lgkmcnt(12)
    v_mfma_f32_16x16x32_bf16 v[156:159], v[108:111], v[132:135], 0
    s_add_u32 s25, s39, 688128
    s_add_u32 m0, s41, 49152
    s_nop 0
    buffer_load_dwordx4 v34, s[32:35], s25 offen lds
    v_mfma_f32_16x16x32_bf16 v[160:163], v[112:115], v[132:135], 0
    s_add_u32 s25, s39, 802816
    s_add_u32 m0, s41, 57344
    s_nop 0
    buffer_load_dwordx4 v34, s[32:35], s25 offen lds
    v_mfma_f32_16x16x32_bf16 v[68:71], v[8:11], v[132:135], 0
    s_add_u32 m0, s50, 32768
    s_add_u32 s25, s49, 512
    buffer_load_dwordx4 v35, s[28:31], s25 offen offset:0 lds
    buffer_load_dwordx4 v36, s[28:31], s25 offen offset:1024 lds
    v_mfma_f32_16x16x32_bf16 v[164:167], v[108:111], v[136:139], 0
    s_add_u32 s25, s39, 917504
    s_add_u32 m0, s41, 65536
    s_nop 0
    buffer_load_dwordx4 v34, s[32:35], s25 offen lds
    v_mfma_f32_16x16x32_bf16 v[168:171], v[112:115], v[136:139], 0
    ds_read_b128 v[108:111], v33 offset:0
    ds_read_b128 v[112:115], v33 offset:4096
    ds_read_b64_tr_b16 v[132:133], v24 offset:24576
    ds_read_b64_tr_b16 v[134:135], v24 offset:26624
    ds_read_b64_tr_b16 v[136:137], v26 offset:24576
    ds_read_b64_tr_b16 v[138:139], v26 offset:26624
    s_waitcnt lgkmcnt(12)
    v_mfma_f32_16x16x32_bf16 v[156:159], v[116:119], v[140:143], v[156:159]
    v_mfma_f32_16x16x32_bf16 v[160:163], v[120:123], v[140:143], v[160:163]
    v_mfma_f32_16x16x32_bf16 v[68:71], v[8:11], v[140:143], v[68:71]
    v_mfma_f32_16x16x32_bf16 v[164:167], v[116:119], v[144:147], v[164:167]
    v_mfma_f32_16x16x32_bf16 v[168:171], v[120:123], v[144:147], v[168:171]
    s_waitcnt vmcnt(5)
    s_barrier
    s_cmp_lg_u32 s36, 0
    s_cbranch_scc1 P1_S17
    s_waitcnt lgkmcnt(12)
    v_mfma_f32_16x16x32_bf16 v[172:175], v[92:95], v[8:11], 0
    v_mfma_f32_16x16x32_bf16 v[176:179], v[92:95], v[92:95], 0
    v_mfma_f32_16x16x32_bf16 v[172:175], v[96:99], v[8:11], v[172:175]
    v_mfma_f32_16x16x32_bf16 v[176:179], v[96:99], v[96:99], v[176:179]
    v_mfma_f32_16x16x32_bf16 v[172:175], v[100:103], v[8:11], v[172:175]
    v_mfma_f32_16x16x32_bf16 v[176:179], v[100:103], v[100:103], v[176:179]
    v_mfma_f32_16x16x32_bf16 v[172:175], v[104:107], v[8:11], v[172:175]
    v_mfma_f32_16x16x32_bf16 v[176:179], v[104:107], v[104:107], v[176:179]
    ds_read_b128 v[92:95], v39 offset:16384
    ds_read_b128 v[96:99], v40 offset:16384
    ds_read_b128 v[100:103], v41 offset:16384
    ds_read_b128 v[104:107], v42 offset:16384
P1_S17:
    ds_read_b128 v[116:119], v30 offset:16384
    ds_read_b128 v[120:123], v30 offset:20480
    ds_read_b64_tr_b16 v[140:141], v24 offset:32768
    ds_read_b64_tr_b16 v[142:143], v24 offset:34816
    ds_read_b64_tr_b16 v[144:145], v26 offset:32768
    ds_read_b64_tr_b16 v[146:147], v26 offset:34816
    s_waitcnt lgkmcnt(12)
    v_mfma_f32_16x16x32_bf16 v[156:159], v[124:127], v[148:151], v[156:159]
    s_add_u32 s25, s39, 1032192
    s_add_u32 m0, s41, 73728
    s_nop 0
    buffer_load_dwordx4 v34, s[32:35], s25 offen lds
    v_mfma_f32_16x16x32_bf16 v[160:163], v[128:131], v[148:151], v[160:163]
    s_add_u32 s25, s39, 1146880
    s_add_u32 m0, s41, 81920
    s_nop 0
    buffer_load_dwordx4 v34, s[32:35], s25 offen lds
    v_mfma_f32_16x16x32_bf16 v[68:71], v[8:11], v[148:151], v[68:71]
    s_add_u32 s25, s39, 1261568
    s_add_u32 m0, s41, 0
    s_nop 0
    buffer_load_dwordx4 v34, s[32:35], s25 offen lds
    v_mfma_f32_16x16x32_bf16 v[164:167], v[124:127], v[152:155], v[164:167]
    s_add_u32 m0, s50, 49152
    s_add_u32 s25, s49, 768
    buffer_load_dwordx4 v35, s[28:31], s25 offen offset:0 lds
    v_mfma_f32_16x16x32_bf16 v[168:171], v[128:131], v[152:155], v[168:171]
    ds_read_b128 v[124:127], v31 offset:16384
    ds_read_b128 v[128:131], v31 offset:20480
    ds_read_b64_tr_b16 v[148:149], v24 offset:40960
    ds_read_b64_tr_b16 v[150:151], v24 offset:43008
    ds_read_b64_tr_b16 v[152:153], v26 offset:40960
    ds_read_b64_tr_b16 v[154:155], v26 offset:43008
    s_waitcnt lgkmcnt(12)
    v_mfma_f32_16x16x32_bf16 v[156:159], v[108:111], v[132:135], v[156:159]
    v_mfma_f32_16x16x32_bf16 v[160:163], v[112:115], v[132:135], v[160:163]
    v_mfma_f32_16x16x32_bf16 v[68:71], v[8:11], v[132:135], v[68:71]
    v_mfma_f32_16x16x32_bf16 v[164:167], v[108:111], v[136:139], v[164:167]
    v_mfma_f32_16x16x32_bf16 v[168:171], v[112:115], v[136:139], v[168:171]
    s_waitcnt vmcnt(7)
    s_barrier
    s_cmp_lg_u32 s36, 0
    s_cbranch_scc1 P1_S18
    s_waitcnt lgkmcnt(12)
    v_mfma_f32_16x16x32_bf16 v[172:175], v[92:95], v[8:11], v[172:175]
    v_mfma_f32_16x16x32_bf16 v[176:179], v[92:95], v[92:95], v[176:179]
    v_mfma_f32_16x16x32_bf16 v[172:175], v[96:99], v[8:11], v[172:175]
    v_mfma_f32_16x16x32_bf16 v[176:179], v[96:99], v[96:99], v[176:179]
    v_mfma_f32_16x16x32_bf16 v[172:175], v[100:103], v[8:11], v[172:175]
    v_mfma_f32_16x16x32_bf16 v[176:179], v[100:103], v[100:103], v[176:179]
    v_mfma_f32_16x16x32_bf16 v[172:175], v[104:107], v[8:11], v[172:175]
    v_mfma_f32_16x16x32_bf16 v[176:179], v[104:107], v[104:107], v[176:179]
P1_S18:
    ds_read_b128 v[108:111], v32 offset:16384
    ds_read_b128 v[112:115], v32 offset:20480
    ds_read_b64_tr_b16 v[132:133], v24 offset:49152
    ds_read_b64_tr_b16 v[134:135], v24 offset:51200
    ds_read_b64_tr_b16 v[136:137], v26 offset:49152
    ds_read_b64_tr_b16 v[138:139], v26 offset:51200
    s_waitcnt lgkmcnt(12)
    v_mfma_f32_16x16x32_bf16 v[156:159], v[116:119], v[140:143], v[156:159]
    s_add_u32 m0, s50, 49152
    s_add_u32 s25, s49, 768
    buffer_load_dwordx4 v36, s[28:31], s25 offen offset:1024 lds
    v_mfma_f32_16x16x32_bf16 v[160:163], v[120:123], v[140:143], v[160:163]
    s_add_u32 s25, s39, 1376256
    s_add_u32 m0, s41, 8192
    s_nop 0
    buffer_load_dwordx4 v34, s[32:35], s25 offen lds
    v_mfma_f32_16x16x32_bf16 v[68:71], v[8:11], v[140:143], v[68:71]
    s_add_u32 s25, s39, 1490944
    s_add_u32 m0, s41, 16384
    s_nop 0
    buffer_load_dwordx4 v34, s[32:35], s25 offen lds
    v_mfma_f32_16x16x32_bf16 v[164:167], v[116:119], v[144:147], v[164:167]
    s_add_u32 s25, s39, 1605632
    s_add_u32 m0, s41, 24576
    s_nop 0
    buffer_load_dwordx4 v34, s[32:35], s25 offen lds
    v_mfma_f32_16x16x32_bf16 v[168:171], v[120:123], v[144:147], v[168:171]
    ds_read_b128 v[116:119], v33 offset:16384
    ds_read_b128 v[120:123], v33 offset:20480
    ds_read_b64_tr_b16 v[140:141], v24 offset:57344
    ds_read_b64_tr_b16 v[142:143], v24 offset:59392
    ds_read_b64_tr_b16 v[144:145], v26 offset:57344
    ds_read_b64_tr_b16 v[146:147], v26 offset:59392
    s_waitcnt lgkmcnt(12)
    v_mfma_f32_16x16x32_bf16 v[156:159], v[124:127], v[148:151], v[156:159]
    v_mfma_f32_16x16x32_bf16 v[160:163], v[128:131], v[148:151], v[160:163]
    v_mfma_f32_16x16x32_bf16 v[68:71], v[8:11], v[148:151], v[68:71]
    v_mfma_f32_16x16x32_bf16 v[164:167], v[124:127], v[152:155], v[164:167]
    v_mfma_f32_16x16x32_bf16 v[168:171], v[128:131], v[152:155], v[168:171]
    s_waitcnt vmcnt(7)
    s_barrier
    s_cmp_lg_u32 s36, 0
    s_cbranch_scc1 P1_S19
    ds_read_b128 v[92:95], v39 offset:32768
    ds_read_b128 v[96:99], v40 offset:32768
    ds_read_b128 v[100:103], v41 offset:32768
    ds_read_b128 v[104:107], v42 offset:32768
P1_S19:
    s_cmp_lg_u32 s22, 7
    s_cbranch_scc1 P1_S20
    s_mov_b32 s60, s100
    s_and_b32 s61, s101, 0xffff
    s_mov_b32 s62, 0x00000100
    s_mov_b32 s63, 0x00020000
    v_mov_b32 v251, 0
    buffer_load_dword v250, v251, s[60:63], 0 offen sc1
P1_S20:
    ds_read_b128 v[124:127], v30 offset:32768
    ds_read_b128 v[128:131], v30 offset:36864
    ds_read_b64_tr_b16 v[148:149], v25 offset:0
    ds_read_b64_tr_b16 v[150:151], v25 offset:2048
    ds_read_b64_tr_b16 v[152:153], v27 offset:0
    ds_read_b64_tr_b16 v[154:155], v27 offset:2048
    s_waitcnt lgkmcnt(12)
    v_mfma_f32_16x16x32_bf16 v[156:159], v[108:111], v[132:135], v[156:159]
    s_add_u32 s25, s39, 1720320
    s_add_u32 m0, s41, 32768
    s_nop 0
    buffer_load_dwordx4 v34, s[32:35], s25 offen lds
    v_mfma_f32_16x16x32_bf16 v[160:163], v[112:115], v[132:135], v[160:163]
    s_add_u32 s25, s40, 0
    s_add_u32 m0, s41, 40960
    s_nop 0
    buffer_load_dwordx4 v34, s[32:35], s25 offen lds
    v_mfma_f32_16x16x32_bf16 v[68:71], v[8:11], v[132:135], v[68:71]
    v_mfma_f32_16x16x32_bf16 v[164:167], v[108:111], v[136:139], v[164:167]
    v_mfma_f32_16x16x32_bf16 v[168:171], v[112:115], v[136:139], v[168:171]
    ds_read_b128 v[108:111], v31 offset:32768
    ds_read_b128 v[112:115], v31 offset:36864
    ds_read_b64_tr_b16 v[132:133], v25 offset:8192
    ds_read_b64_tr_b16 v[134:135], v25 offset:10240
    ds_read_b64_tr_b16 v[136:137], v27 offset:8192
    ds_read_b64_tr_b16 v[138:139], v27 offset:10240
    s_waitcnt lgkmcnt(12)
    v_mfma_f32_16x16x32_bf16 v[156:159], v[116:119], v[140:143], v[156:159]
    v_mfma_f32_16x16x32_bf16 v[160:163], v[120:123], v[140:143], v[160:163]
    v_mfma_f32_16x16x32_bf16 v[68:71], v[8:11], v[140:143], v[68:71]
    v_mfma_f32_16x16x32_bf16 v[164:167], v[116:119], v[144:147], v[164:167]
    v_mfma_f32_16x16x32_bf16 v[168:171], v[120:123], v[144:147], v[168:171]
    s_waitcnt vmcnt(7)
    s_barrier
    s_cmp_lg_u32 s36, 0
    s_cbranch_scc1 P1_S21
    s_waitcnt lgkmcnt(12)
    v_mfma_f32_16x16x32_bf16 v[172:175], v[92:95], v[8:11], v[172:175]
    v_mfma_f32_16x16x32_bf16 v[176:179], v[92:95], v[92:95], v[176:179]
    v_mfma_f32_16x16x32_bf16 v[172:175], v[96:99], v[8:11], v[172:175]
    v_mfma_f32_16x16x32_bf16 v[176:179], v[96:99], v[96:99], v[176:179]
    v_mfma_f32_16x16x32_bf16 v[172:175], v[100:103], v[8:11], v[172:175]
    v_mfma_f32_16x16x32_bf16 v[176:179], v[100:103], v[100:103], v[176:179]
    v_mfma_f32_16x16x32_bf16 v[172:175], v[104:107], v[8:11], v[172:175]
    v_mfma_f32_16x16x32_bf16 v[176:179], v[104:107], v[104:107], v[176:179]
P1_S21:
    ds_read_b128 v[116:119], v32 offset:32768
    ds_read_b128 v[120:123], v32 offset:36864
    ds_read_b64_tr_b16 v[140:141], v25 offset:16384
    ds_read_b64_tr_b16 v[142:143], v25 offset:18432
    ds_read_b64_tr_b16 v[144:145], v27 offset:16384
    ds_read_b64_tr_b16 v[146:147], v27 offset:18432
    s_waitcnt lgkmcnt(12)
    v_mfma_f32_16x16x32_bf16 v[156:159], v[124:127], v[148:151], v[156:159]
    s_add_u32 s25, s40, 114688
    s_add_u32 m0, s41, 49152
    s_nop 0
    buffer_load_dwordx4 v34, s[32:35], s25 offen lds
    v_mfma_f32_16x16x32_bf16 v[160:163], v[128:131], v[148:151], v[160:163]
    s_add_u32 s25, s40, 229376
    s_add_u32 m0, s41, 57344
    s_nop 0
    buffer_load_dwordx4 v34, s[32:35], s25 offen lds
    v_mfma_f32_16x16x32_bf16 v[68:71], v[8:11], v[148:151], v[68:71]
    v_mfma_f32_16x16x32_bf16 v[164:167], v[124:127], v[152:155], v[164:167]
    v_mfma_f32_16x16x32_bf16 v[168:171], v[128:131], v[152:155], v[168:171]
    ds_read_b128 v[124:127], v33 offset:32768
    ds_read_b128 v[128:131], v33 offset:36864
    ds_read_b64_tr_b16 v[148:149], v24 offset:0
    ds_read_b64_tr_b16 v[150:151], v24 offset:2048
    ds_read_b64_tr_b16 v[152:153], v26 offset:0
    ds_read_b64_tr_b16 v[154:155], v26 offset:2048
    s_waitcnt lgkmcnt(12)
    v_mfma_f32_16x16x32_bf16 v[156:159], v[108:111], v[132:135], v[156:159]
    v_mfma_f32_16x16x32_bf16 v[160:163], v[112:115], v[132:135], v[160:163]
    v_mfma_f32_16x16x32_bf16 v[68:71], v[8:11], v[132:135], v[68:71]
    v_mfma_f32_16x16x32_bf16 v[164:167], v[108:111], v[136:139], v[164:167]
    v_mfma_f32_16x16x32_bf16 v[168:171], v[112:115], v[136:139], v[168:171]
    s_waitcnt vmcnt(5)
    s_barrier
    s_cmp_lg_u32 s36, 0
    s_cbranch_scc1 P1_S22
    ds_read_b128 v[92:95], v39 offset:49152
    ds_read_b128 v[96:99], v40 offset:49152
    ds_read_b128 v[100:103], v41 offset:49152
    ds_read_b128 v[104:107], v42 offset:49152
P1_S22:
    ds_read_b128 v[108:111], v30 offset:49152
    ds_read_b128 v[112:115], v30 offset:53248
    ds_read_b64_tr_b16 v[132:133], v24 offset:8192
    ds_read_b64_tr_b16 v[134:135], v24 offset:10240
    ds_read_b64_tr_b16 v[136:137], v26 offset:8192
    ds_read_b64_tr_b16 v[138:139], v26 offset:10240
    s_waitcnt lgkmcnt(12)
    v_mfma_f32_16x16x32_bf16 v[156:159], v[116:119], v[140:143], v[156:159]
    s_add_u32 s25, s40, 344064
    s_add_u32 m0, s41, 65536
    s_nop 0
    buffer_load_dwordx4 v34, s[32:35], s25 offen lds
    v_mfma_f32_16x16x32_bf16 v[160:163], v[120:123], v[140:143], v[160:163]
    s_add_u32 s25, s40, 458752
    s_add_u32 m0, s41, 73728
    s_nop 0
    buffer_load_dwordx4 v34, s[32:35], s25 offen lds
    v_mfma_f32_16x16x32_bf16 v[68:71], v[8:11], v[140:143], v[68:71]
    v_mfma_f32_16x16x32_bf16 v[164:167], v[116:119], v[144:147], v[164:167]
    v_mfma_f32_16x16x32_bf16 v[168:171], v[120:123], v[144:147], v[168:171]
    ds_read_b128 v[116:119], v31 offset:49152
    ds_read_b128 v[120:123], v31 offset:53248
    ds_read_b64_tr_b16 v[140:141], v24 offset:16384
    ds_read_b64_tr_b16 v[142:143], v24 offset:18432
    ds_read_b64_tr_b16 v[144:145], v26 offset:16384
    ds_read_b64_tr_b16 v[146:147], v26 offset:18432
    s_waitcnt lgkmcnt(12)
    v_mfma_f32_16x16x32_bf16 v[156:159], v[124:127], v[148:151], v[156:159]
    v_mfma_f32_16x16x32_bf16 v[160:163], v[128:131], v[148:151], v[160:163]
    v_mfma_f32_16x16x32_bf16 v[68:71], v[8:11], v[148:151], v[68:71]
    v_mfma_f32_16x16x32_bf16 v[164:167], v[124:127], v[152:155], v[164:167]
    v_mfma_f32_16x16x32_bf16 v[168:171], v[128:131], v[152:155], v[168:171]
    s_waitcnt vmcnt(5)
    s_barrier
    s_cmp_lg_u32 s36, 0
    s_cbranch_scc1 P1_S23
    s_waitcnt lgkmcnt(12)
    v_mfma_f32_16x16x32_bf16 v[172:175], v[92:95], v[8:11], v[172:175]
    v_mfma_f32_16x16x32_bf16 v[176:179], v[92:95], v[92:95], v[176:179]
    v_mfma_f32_16x16x32_bf16 v[172:175], v[96:99], v[8:11], v[172:175]
    v_mfma_f32_16x16x32_bf16 v[176:179], v[96:99], v[96:99], v[176:179]
    v_mfma_f32_16x16x32_bf16 v[172:175], v[100:103], v[8:11], v[172:175]
    v_mfma_f32_16x16x32_bf16 v[176:179], v[100:103], v[100:103], v[176:179]
    v_mfma_f32_16x16x32_bf16 v[172:175], v[104:107], v[8:11], v[172:175]
    v_mfma_f32_16x16x32_bf16 v[176:179], v[104:107], v[104:107], v[176:179]
P1_S23:
    s_cmp_lg_u32 s22, 7
    s_cbranch_scc1 P1_S24
    s_mov_b32 s25, 0
KF_NL17:
    v_readfirstlane_b32 s26, v250
    s_cmp_lg_u32 s26, 0
    s_cbranch_scc1 KF_NG17
    s_mov_b32 s60, s100
    s_and_b32 s61, s101, 0xffff
    s_mov_b32 s62, 0x00000100
    s_mov_b32 s63, 0x00020000
    v_mov_b32 v251, 0
    buffer_load_dword v250, v251, s[60:63], 0 offen sc1
    s_waitcnt vmcnt(0)
    s_add_u32 s25, s25, 1
    s_cmp_lt_u32 s25, 0x40000
    s_cbranch_scc1 KF_NL17
KF_NG17:
    ds_write_b32 v251, v250 offset:32
P1_S24:
    ds_read_b128 v[124:127], v32 offset:49152
    ds_read_b128 v[128:131], v32 offset:53248
    ds_read_b64_tr_b16 v[148:149], v24 offset:24576
    ds_read_b64_tr_b16 v[150:151], v24 offset:26624
    ds_read_b64_tr_b16 v[152:153], v26 offset:24576
    ds_read_b64_tr_b16 v[154:155], v26 offset:26624
    s_waitcnt lgkmcnt(12)
    v_mfma_f32_16x16x32_bf16 v[156:159], v[108:111], v[132:135], v[156:159]
    s_add_u32 s25, s40, 573440
    s_add_u32 m0, s41, 81920
    s_nop 0
    buffer_load_dwordx4 v34, s[32:35], s25 offen lds
    s_add_u32 s25, s40, 688128
    s_add_u32 m0, s41, 0
    s_nop 0
    buffer_load_dwordx4 v34, s[32:35], s25 offen lds
    v_and_b32 v92, 3, v2
    v_mfma_f32_16x16x32_bf16 v[160:163], v[112:115], v[132:135], v[160:163]
    v_mov_b32 v76, v172
    v_mov_b32 v77, v176
    v_cmp_eq_u32 vcc, 1, v92
    s_nop 1
    v_cndmask_b32 v76, v76, v173, vcc
    v_cndmask_b32 v77, v77, v177, vcc
    v_mfma_f32_16x16x32_bf16 v[68:71], v[8:11], v[132:135], v[68:71]
    v_cmp_eq_u32 vcc, 2, v92
    s_nop 1
    v_cndmask_b32 v76, v76, v174, vcc
    v_cndmask_b32 v77, v77, v178, vcc
    v_cmp_eq_u32 vcc, 3, v92
    s_nop 1
    v_cndmask_b32 v76, v76, v175, vcc
    v_cndmask_b32 v77, v77, v179, vcc
    v_mul_f32 v76, 0x3b000000, v76
    v_mfma_f32_16x16x32_bf16 v[164:167], v[108:111], v[136:139], v[164:167]
    v_mul_f32 v77, 0x3b000000, v77
    v_fma_f32 v77, -v76, v76, v77
    v_max_f32 v77, 0, v77
    v_mfma_f32_16x16x32_bf16 v[168:171], v[112:115], v[136:139], v[168:171]
    v_cvt_pk_bf16_f32 v92, v76, v77
    v_lshlrev_b32 v78, 16, v92
    v_xor_b32 v78, 0x80000000, v78
    ds_read_b128 v[108:111], v33 offset:49152
    ds_read_b128 v[112:115], v33 offset:53248
    ds_read_b64_tr_b16 v[132:133], v24 offset:32768
    ds_read_b64_tr_b16 v[134:135], v24 offset:34816
    ds_read_b64_tr_b16 v[136:137], v26 offset:32768
    ds_read_b64_tr_b16 v[138:139], v26 offset:34816
    s_waitcnt lgkmcnt(12)
    v_mfma_f32_16x16x32_bf16 v[156:159], v[116:119], v[140:143], v[156:159]
    v_and_b32 v92, 0xffff0000, v92
    v_add_f32 v92, 0x3727c5ac, v92
    v_cvt_pk_bf16_f32 v92, v92, v92
    v_mfma_f32_16x16x32_bf16 v[160:163], v[120:123], v[140:143], v[160:163]
    v_and_b32 v92, 0xffff0000, v92
    v_sqrt_f32 v92, v92
    s_nop 0
    v_cvt_pk_bf16_f32 v92, v92, v92
    v_mfma_f32_16x16x32_bf16 v[68:71], v[8:11], v[140:143], v[68:71]
    v_and_b32 v92, 0xffff0000, v92
    v_rcp_f32 v79, v92
    v_lshlrev_b32 v18, 2, v2
    v_mfma_f32_16x16x32_bf16 v[164:167], v[116:119], v[144:147], v[164:167]
    v_lshl_add_u32 v18, s37, 6, v18
    v_add_u32 v18, 161536, v18
    s_cmp_lg_u32 s36, 0
    s_cbranch_scc1 P1_S25
    s_mov_b32 exec_lo, 0x00f0000f
    s_mov_b32 exec_hi, 0xf0000f00
    ds_write_b32 v18, v78
    ds_write_b32 v18, v79 offset:256
    s_mov_b64 exec, -1
P1_S25:
    v_mfma_f32_16x16x32_bf16 v[168:171], v[120:123], v[144:147], v[168:171]
    s_waitcnt vmcnt(5)
    s_waitcnt lgkmcnt(0)
    s_barrier
    v_xor_b32 v16, s48, v29
    v_lshl_add_u32 v24, v16, 5, v28
    v_add_u32 v25, 0x10000, v24
    ds_read_b128 v[116:119], v30 offset:0
    ds_read_b128 v[120:123], v30 offset:4096
    ds_read_b64_tr_b16 v[140:141], v24 offset:40960
    ds_read_b64_tr_b16 v[142:143], v24 offset:43008
    s_waitcnt lgkmcnt(10)
    v_mfma_f32_16x16x32_bf16 v[156:159], v[124:127], v[148:151], v[156:159]
    s_add_u32 s25, s40, 802816
    s_add_u32 m0, s41, 8192
    s_nop 0
    buffer_load_dwordx4 v34, s[32:35], s25 offen lds
    v_mfma_f32_16x16x32_bf16 v[160:163], v[128:131], v[148:151], v[160:163]
    s_add_u32 s25, s40, 917504
    s_add_u32 m0, s41, 16384
    s_nop 0
    buffer_load_dwordx4 v34, s[32:35], s25 offen lds
    v_mfma_f32_16x16x32_bf16 v[68:71], v[8:11], v[148:151], v[68:71]
    v_lshlrev_b32 v18, 4, v3
    v_mfma_f32_16x16x32_bf16 v[164:167], v[124:127], v[152:155], v[164:167]
    v_lshl_add_u32 v18, s36, 7, v18
    v_mfma_f32_16x16x32_bf16 v[168:171], v[128:131], v[152:155], v[168:171]
    v_add_u32 v18, 161536, v18
    ds_read_b128 v[124:127], v31 offset:0
    ds_read_b128 v[128:131], v31 offset:4096
    ds_read_b64_tr_b16 v[148:149], v24 offset:49152
    ds_read_b64_tr_b16 v[150:151], v24 offset:51200
    s_waitcnt lgkmcnt(8)
    v_mfma_f32_16x16x32_bf16 v[156:159], v[108:111], v[132:135], v[156:159]
    ds_read_b128 v[76:79], v18 offset:0
    v_mfma_f32_16x16x32_bf16 v[160:163], v[112:115], v[132:135], v[160:163]
    ds_read_b128 v[84:87], v18 offset:256
    v_mfma_f32_16x16x32_bf16 v[68:71], v[8:11], v[132:135], v[68:71]
    ds_read_b128 v[80:83], v18 offset:64
    v_mfma_f32_16x16x32_bf16 v[164:167], v[108:111], v[136:139], v[164:167]
    ds_read_b128 v[88:91], v18 offset:320
    v_mfma_f32_16x16x32_bf16 v[168:171], v[112:115], v[136:139], v[168:171]
    s_xor_b32 s23, s36, 0
    s_add_u32 s23, s23, s47
    s_lshl_b32 s23, s23, 6
    s_add_u32 s23, s23, 162048
    v_lshl_add_u32 v19, v2, 2, s23
    ds_write_b32 v19, v68
    s_xor_b32 s23, s36, 1
    s_add_u32 s23, s23, s47
    s_lshl_b32 s23, s23, 6
    s_add_u32 s23, s23, 162048
    v_lshl_add_u32 v19, v2, 2, s23
    s_waitcnt lgkmcnt(0)
    s_barrier
    ds_read_b32 v72, v19
    s_waitcnt lgkmcnt(0)
    v_pk_fma_f32 v[156:157], v[76:77], v[68:69], v[156:157] op_sel_hi:[1,0,1]
    v_pk_fma_f32 v[158:159], v[78:79], v[68:69], v[158:159] op_sel_hi:[1,0,1]
    v_pk_fma_f32 v[160:161], v[80:81], v[68:69], v[160:161] op_sel_hi:[1,0,1]
    v_pk_fma_f32 v[162:163], v[82:83], v[68:69], v[162:163] op_sel_hi:[1,0,1]
    v_pk_fma_f32 v[164:165], v[76:77], v[72:73], v[164:165] op_sel_hi:[1,0,1]
    v_pk_fma_f32 v[166:167], v[78:79], v[72:73], v[166:167] op_sel_hi:[1,0,1]
    v_pk_fma_f32 v[168:169], v[80:81], v[72:73], v[168:169] op_sel_hi:[1,0,1]
    v_pk_fma_f32 v[170:171], v[82:83], v[72:73], v[170:171] op_sel_hi:[1,0,1]
    s_add_u32 s25, s40, 1032192
    s_add_u32 m0, s41, 24576
    s_nop 0
    buffer_load_dwordx4 v34, s[32:35], s25 offen lds
    v_pk_mul_f32 v[156:157], v[156:157], v[84:85]
    v_pk_mul_f32 v[158:159], v[158:159], v[86:87]
    v_pk_mul_f32 v[160:161], v[160:161], v[88:89]
    v_pk_mul_f32 v[162:163], v[162:163], v[90:91]
    v_pk_mul_f32 v[164:165], v[164:165], v[84:85]
    v_pk_mul_f32 v[166:167], v[166:167], v[86:87]
    v_pk_mul_f32 v[168:169], v[168:169], v[88:89]
    v_pk_mul_f32 v[170:171], v[170:171], v[90:91]
    s_add_u32 s25, s40, 1146880
    s_add_u32 m0, s41, 32768
    s_nop 0
    buffer_load_dwordx4 v34, s[32:35], s25 offen lds
    v_pk_mul_f32 v[76:77], v[156:157], v[156:157]
    v_pk_mul_f32 v[78:79], v[158:159], v[158:159]
    v_pk_mul_f32 v[80:81], v[160:161], v[160:161]
    v_pk_mul_f32 v[82:83], v[162:163], v[162:163]
    v_pk_mul_f32 v[84:85], v[164:165], v[164:165]
    v_pk_mul_f32 v[86:87], v[166:167], v[166:167]
    v_pk_mul_f32 v[88:89], v[168:169], v[168:169]
    v_pk_mul_f32 v[90:91], v[170:171], v[170:171]
    s_add_u32 s25, s40, 1261568
    buffer_load_dwordx4 v[180:183], v34, s[32:35], s25 offen
    v_pk_fma_f32 v[76:77], v[76:77], s[54:55], v[12:13]
    v_pk_fma_f32 v[78:79], v[78:79], s[54:55], v[12:13]
    v_pk_fma_f32 v[80:81], v[80:81], s[54:55], v[12:13]
    v_pk_fma_f32 v[82:83], v[82:83], s[54:55], v[12:13]
    v_pk_fma_f32 v[84:85], v[84:85], s[54:55], v[12:13]
    v_pk_fma_f32 v[86:87], v[86:87], s[54:55], v[12:13]
    v_pk_fma_f32 v[88:89], v[88:89], s[54:55], v[12:13]
    v_pk_fma_f32 v[90:91], v[90:91], s[54:55], v[12:13]
    s_add_u32 s25, s40, 1376256
    buffer_load_dwordx4 v[184:187], v34, s[32:35], s25 offen
    v_pk_mul_f32 v[76:77], v[76:77], v[156:157]
    v_pk_mul_f32 v[78:79], v[78:79], v[158:159]
    v_pk_mul_f32 v[80:81], v[80:81], v[160:161]
    v_pk_mul_f32 v[82:83], v[82:83], v[162:163]
    v_pk_mul_f32 v[84:85], v[84:85], v[164:165]
    v_pk_mul_f32 v[86:87], v[86:87], v[166:167]
    v_pk_mul_f32 v[88:89], v[88:89], v[168:169]
    v_pk_mul_f32 v[90:91], v[90:91], v[170:171]
    s_add_u32 s25, s40, 1490944
    buffer_load_dwordx4 v[188:191], v34, s[32:35], s25 offen
    v_exp_f32 v76, v76
    v_exp_f32 v77, v77
    v_exp_f32 v78, v78
    v_exp_f32 v79, v79
    v_exp_f32 v80, v80
    v_exp_f32 v81, v81
    v_exp_f32 v82, v82
    v_exp_f32 v83, v83
    s_add_u32 s25, s40, 1605632
    buffer_load_dwordx4 v[192:195], v34, s[32:35], s25 offen
    v_exp_f32 v84, v84
    v_exp_f32 v85, v85
    v_exp_f32 v86, v86
    v_exp_f32 v87, v87
    v_exp_f32 v88, v88
    v_exp_f32 v89, v89
    v_exp_f32 v90, v90
    v_exp_f32 v91, v91
    s_add_u32 s25, s40, 1720320
    buffer_load_dwordx4 v[196:199], v34, s[32:35], s25 offen
    v_pk_add_f32 v[76:77], v[76:77], v[14:15]
    v_pk_add_f32 v[78:79], v[78:79], v[14:15]
    v_pk_add_f32 v[80:81], v[80:81], v[14:15]
    v_pk_add_f32 v[82:83], v[82:83], v[14:15]
    v_pk_add_f32 v[84:85], v[84:85], v[14:15]
    v_pk_add_f32 v[86:87], v[86:87], v[14:15]
    v_pk_add_f32 v[88:89], v[88:89], v[14:15]
    v_pk_add_f32 v[90:91], v[90:91], v[14:15]
    v_rcp_f32 v76, v76
    v_rcp_f32 v77, v77
    v_rcp_f32 v78, v78
    v_rcp_f32 v79, v79
    v_rcp_f32 v80, v80
    v_rcp_f32 v81, v81
    v_rcp_f32 v82, v82
    v_rcp_f32 v83, v83
    v_rcp_f32 v84, v84
    v_rcp_f32 v85, v85
    v_rcp_f32 v86, v86
    v_rcp_f32 v87, v87
    v_rcp_f32 v88, v88
    v_rcp_f32 v89, v89
    v_rcp_f32 v90, v90
    v_rcp_f32 v91, v91
    v_pk_mul_f32 v[156:157], v[156:157], v[76:77]
    v_pk_mul_f32 v[158:159], v[158:159], v[78:79]
    v_pk_mul_f32 v[160:161], v[160:161], v[80:81]
    v_pk_mul_f32 v[162:163], v[162:163], v[82:83]
    v_pk_mul_f32 v[164:165], v[164:165], v[84:85]
    v_pk_mul_f32 v[166:167], v[166:167], v[86:87]
    v_pk_mul_f32 v[168:169], v[168:169], v[88:89]
    v_pk_mul_f32 v[170:171], v[170:171], v[90:91]
    v_cvt_pk_bf16_f32 v172, v156, v164
    v_cvt_pk_bf16_f32 v173, v157, v165
    v_cvt_pk_bf16_f32 v174, v158, v166
    v_cvt_pk_bf16_f32 v175, v159, v167
    v_cvt_pk_bf16_f32 v176, v160, v168
    v_cvt_pk_bf16_f32 v177, v161, v169
    v_cvt_pk_bf16_f32 v178, v162, v170
    v_cvt_pk_bf16_f32 v179, v163, v171
    v_pk_mul_f32 v[80:81], v[156:157], v[156:157]
    v_pk_add_f32 v[76:77], v[156:157], v[164:165]
    v_pk_fma_f32 v[80:81], v[164:165], v[164:165], v[80:81]
    v_pk_mul_f32 v[82:83], v[158:159], v[158:159]
    v_pk_add_f32 v[78:79], v[158:159], v[166:167]
    v_pk_fma_f32 v[82:83], v[166:167], v[166:167], v[82:83]
    v_pk_mul_f32 v[88:89], v[160:161], v[160:161]
    v_pk_add_f32 v[84:85], v[160:161], v[168:169]
    v_pk_fma_f32 v[88:89], v[168:169], v[168:169], v[88:89]
    v_pk_mul_f32 v[90:91], v[162:163], v[162:163]
    v_pk_add_f32 v[86:87], v[162:163], v[170:171]
    v_pk_fma_f32 v[90:91], v[170:171], v[170:171], v[90:91]
    v_add_f32_dpp v156, v76, v76 row_ror:8 row_mask:0xf bank_mask:0x3
    v_add_f32_dpp v157, v77, v77 row_ror:8 row_mask:0xf bank_mask:0x3
    v_add_f32_dpp v158, v78, v78 row_ror:8 row_mask:0xf bank_mask:0x3
    v_add_f32_dpp v159, v79, v79 row_ror:8 row_mask:0xf bank_mask:0x3
    v_add_f32_dpp v160, v80, v80 row_ror:8 row_mask:0xf bank_mask:0x3
    v_add_f32_dpp v161, v81, v81 row_ror:8 row_mask:0xf bank_mask:0x3
    v_add_f32_dpp v162, v82, v82 row_ror:8 row_mask:0xf bank_mask:0x3
    v_add_f32_dpp v163, v83, v83 row_ror:8 row_mask:0xf bank_mask:0x3
    v_add_f32_dpp v156, v84, v84 row_ror:8 row_mask:0xf bank_mask:0xc
    v_add_f32_dpp v157, v85, v85 row_ror:8 row_mask:0xf bank_mask:0xc
    v_add_f32_dpp v158, v86, v86 row_ror:8 row_mask:0xf bank_mask:0xc
    v_add_f32_dpp v159, v87, v87 row_ror:8 row_mask:0xf bank_mask:0xc
    v_add_f32_dpp v160, v88, v88 row_ror:8 row_mask:0xf bank_mask:0xc
    v_add_f32_dpp v161, v89, v89 row_ror:8 row_mask:0xf bank_mask:0xc
    v_add_f32_dpp v162, v90, v90 row_ror:8 row_mask:0xf bank_mask:0xc
    v_add_f32_dpp v163, v91, v91 row_ror:8 row_mask:0xf bank_mask:0xc
    v_add_f32_dpp v164, v156, v156 row_half_mirror row_mask:0xf bank_mask:0x5
    v_add_f32_dpp v165, v157, v157 row_half_mirror row_mask:0xf bank_mask:0x5
    v_add_f32_dpp v166, v158, v158 row_half_mirror row_mask:0xf bank_mask:0x5
    v_add_f32_dpp v167, v159, v159 row_half_mirror row_mask:0xf bank_mask:0x5
    v_add_f32_dpp v164, v160, v160 row_half_mirror row_mask:0xf bank_mask:0xa
    v_add_f32_dpp v165, v161, v161 row_half_mirror row_mask:0xf bank_mask:0xa
    v_add_f32_dpp v166, v162, v162 row_half_mirror row_mask:0xf bank_mask:0xa
    v_add_f32_dpp v167, v163, v163 row_half_mirror row_mask:0xf bank_mask:0xa
    v_add_f32_dpp v164, v164, v164 quad_perm:[1,0,3,2] row_mask:0xf bank_mask:0xf
    v_add_f32_dpp v165, v165, v165 quad_perm:[1,0,3,2] row_mask:0xf bank_mask:0xf
    v_add_f32_dpp v166, v166, v166 quad_perm:[1,0,3,2] row_mask:0xf bank_mask:0xf
    v_add_f32_dpp v167, v167, v167 quad_perm:[1,0,3,2] row_mask:0xf bank_mask:0xf
    v_add_f32_dpp v164, v164, v164 quad_perm:[2,3,0,1] row_mask:0xf bank_mask:0xf
    v_add_f32_dpp v165, v165, v165 quad_perm:[2,3,0,1] row_mask:0xf bank_mask:0xf
    v_add_f32_dpp v166, v166, v166 quad_perm:[2,3,0,1] row_mask:0xf bank_mask:0xf
    v_add_f32_dpp v167, v167, v167 quad_perm:[2,3,0,1] row_mask:0xf bank_mask:0xf
    v_lshrrev_b32 v18, 2, v2
    v_lshlrev_b32 v18, 6, v18
    v_lshl_add_u32 v18, v3, 4, v18
    v_lshl_add_u32 v18, s22, 8, v18
    ds_write_b128 v18, v[164:167] offset:64
    s_waitcnt vmcnt(12)
    s_waitcnt lgkmcnt(0)
    s_barrier
    s_cmp_lg_u32 s22, 7
    s_cbranch_scc1 P1_S26
    ds_read2_b32 v[92:93], v49 offset0:16 offset1:32
    ds_read2_b32 v[94:95], v49 offset0:80 offset1:96
    ds_read2_b32 v[96:97], v49 offset0:144 offset1:160
    ds_read2_b32 v[98:99], v49 offset0:208 offset1:224
    s_lshl_b32 s24, s21, 10
    s_add_u32 s24, s24, s52
    v_mov_b32 v101, v250
    v_mov_b32 v103, v250
    s_waitcnt lgkmcnt(0)
    v_add_f32 v92, v92, v94
    v_add_f32 v93, v93, v95
    v_add_f32 v96, v96, v98
    v_add_f32 v97, v97, v99
    v_add_f32 v100, v92, v96
    v_add_f32 v102, v93, v97
    buffer_store_dwordx4 v[100:103], v23, s[12:15], s24 offen sc1
P1_S26:
    ds_read_b128 v[108:111], v32 offset:0
    ds_read_b128 v[112:115], v32 offset:4096
    ds_read_b64_tr_b16 v[132:133], v24 offset:57344
    ds_read_b64_tr_b16 v[134:135], v24 offset:59392
    s_waitcnt lgkmcnt(8)
    v_mfma_f32_16x16x32_bf16 v[52:55], v[140:143], v[116:119], 0
    v_mov_b32 v251, 0
    ds_read_b32 v250, v251 offset:32
    v_mfma_f32_16x16x32_bf16 v[56:59], v[140:143], v[120:123], 0
    ds_read_b64_tr_b16 v[100:101], v44
    ds_read_b64_tr_b16 v[102:103], v45
    v_mfma_f32_16x16x32_bf16 v[68:71], v[8:11], v[140:143], 0
    ds_read_b128 v[76:79], v48 offset:0
    ds_read_b128 v[84:87], v48 offset:256
    ds_read_b128 v[116:119], v33 offset:0
    ds_read_b128 v[120:123], v33 offset:4096
    ds_read_b64_tr_b16 v[140:141], v25 offset:0
    ds_read_b64_tr_b16 v[142:143], v25 offset:2048
    s_waitcnt lgkmcnt(8)
    v_mfma_f32_16x16x32_bf16 v[52:55], v[148:151], v[124:127], v[52:55]
    ds_read_b128 v[80:83], v48 offset:16
    ds_read_b128 v[88:91], v48 offset:272
    v_mfma_f32_16x16x32_bf16 v[56:59], v[148:151], v[128:131], v[56:59]
    v_mfma_f32_16x16x32_bf16 v[68:71], v[8:11], v[148:151], v[68:71]
    s_waitcnt vmcnt(0)
    v_lshlrev_b32 v16, 7, v1
    s_lshl_b32 s23, s2, 15
    s_lshl_b32 s24, s22, 12
    s_add_u32 s23, s23, s24
    s_mov_b32 exec_hi, 0
    buffer_load_dword v43, v16, s[16:19], s23 offen
    s_mov_b32 exec_hi, -1
    s_mul_i32 s23, s2, 3584
    s_min_u32 s24, s22, 6
    s_lshl_b32 s24, s24, 9
    s_add_u32 s23, s23, s24
    s_mov_b32 s60, s6
    s_and_b32 s61, s7, 0xffff
    s_mov_b32 s62, 0x000e0000
    s_mov_b32 s63, 0x00020000
    s_mov_b64 exec, 15
    buffer_load_dword v43, v16, s[60:63], s23 offen
    s_mov_b64 exec, -1
    s_barrier
    ds_read_b128 v[124:127], v30 offset:16384
    ds_read_b128 v[128:131], v30 offset:20480
    ds_read_b64_tr_b16 v[148:149], v25 offset:8192
    ds_read_b64_tr_b16 v[150:151], v25 offset:10240
    s_waitcnt lgkmcnt(8)
    v_mfma_f32_16x16x32_bf16 v[52:55], v[132:135], v[108:111], v[52:55]
    ds_write_b128 v37, v[180:183] offset:40960
    v_mfma_f32_16x16x32_bf16 v[56:59], v[132:135], v[112:115], v[56:59]
    ds_write_b128 v37, v[184:187] offset:49152
    v_mfma_f32_16x16x32_bf16 v[68:71], v[8:11], v[132:135], v[68:71]
    ds_read_b128 v[108:111], v31 offset:16384
    ds_read_b128 v[112:115], v31 offset:20480
    ds_read_b64_tr_b16 v[132:133], v25 offset:16384
    ds_read_b64_tr_b16 v[134:135], v25 offset:18432
    s_waitcnt lgkmcnt(8)
    v_mfma_f32_16x16x32_bf16 v[52:55], v[140:143], v[116:119], v[52:55]
    v_mfma_f32_16x16x32_bf16 v[56:59], v[140:143], v[120:123], v[56:59]
    v_mfma_f32_16x16x32_bf16 v[68:71], v[8:11], v[140:143], v[68:71]
    s_barrier
    ds_read_b128 v[116:119], v32 offset:16384
    ds_read_b128 v[120:123], v32 offset:20480
    ds_read_b64_tr_b16 v[140:141], v24 offset:0
    ds_read_b64_tr_b16 v[142:143], v24 offset:2048
    s_waitcnt lgkmcnt(8)
    v_mfma_f32_16x16x32_bf16 v[52:55], v[148:151], v[124:127], v[52:55]
    ds_write_b128 v37, v[188:191] offset:57344
    v_mfma_f32_16x16x32_bf16 v[56:59], v[148:151], v[128:131], v[56:59]
    ds_write_b128 v38, v[192:195] offset:0
    v_mfma_f32_16x16x32_bf16 v[68:71], v[8:11], v[148:151], v[68:71]
    ds_bpermute_b32 v100, v46, v100
    ds_read_b128 v[124:127], v33 offset:16384
    ds_read_b128 v[128:131], v33 offset:20480
    ds_read_b64_tr_b16 v[148:149], v24 offset:8192
    ds_read_b64_tr_b16 v[150:151], v24 offset:10240
    s_waitcnt lgkmcnt(8)
    v_mfma_f32_16x16x32_bf16 v[52:55], v[132:135], v[108:111], v[52:55]
    ds_bpermute_b32 v101, v46, v101
    v_mfma_f32_16x16x32_bf16 v[56:59], v[132:135], v[112:115], v[56:59]
    ds_bpermute_b32 v102, v46, v102
    v_mfma_f32_16x16x32_bf16 v[68:71], v[8:11], v[132:135], v[68:71]
    ds_bpermute_b32 v103, v46, v103
    s_waitcnt lgkmcnt(0)
    s_barrier
    ds_read_b128 v[108:111], v30 offset:32768
    ds_read_b128 v[112:115], v30 offset:36864
    ds_read_b64_tr_b16 v[132:133], v24 offset:16384
    ds_read_b64_tr_b16 v[134:135], v24 offset:18432
    s_waitcnt lgkmcnt(8)
    v_mfma_f32_16x16x32_bf16 v[52:55], v[140:143], v[116:119], v[52:55]
    ds_write_b128 v38, v[196:199] offset:8192
    v_lshlrev_b32 v92, 16, v100
    v_and_b32 v93, 0xffff0000, v100
    v_lshlrev_b32 v94, 16, v101
    v_and_b32 v95, 0xffff0000, v101
    v_mfma_f32_16x16x32_bf16 v[56:59], v[140:143], v[120:123], v[56:59]
    v_lshlrev_b32 v96, 16, v102
    v_and_b32 v97, 0xffff0000, v102
    v_lshlrev_b32 v98, 16, v103
    v_and_b32 v99, 0xffff0000, v103
    v_add_f32 v92, v92, v76
    v_mfma_f32_16x16x32_bf16 v[68:71], v[8:11], v[140:143], v[68:71]
    v_add_f32 v93, v93, v77
    v_add_f32 v94, v94, v78
    v_add_f32 v95, v95, v79
    v_add_f32 v96, v96, v80
    v_add_f32 v97, v97, v81
    ds_read_b128 v[116:119], v31 offset:32768
    ds_read_b128 v[120:123], v31 offset:36864
    ds_read_b64_tr_b16 v[140:141], v24 offset:24576
    ds_read_b64_tr_b16 v[142:143], v24 offset:26624
    s_waitcnt lgkmcnt(8)
    v_mfma_f32_16x16x32_bf16 v[52:55], v[148:151], v[124:127], v[52:55]
    v_add_f32 v98, v98, v82
    v_add_f32 v99, v99, v83
    v_mul_f32 v92, v92, v84
    v_mul_f32 v93, v93, v85
    v_mul_f32 v94, v94, v86
    v_mfma_f32_16x16x32_bf16 v[56:59], v[148:151], v[128:131], v[56:59]
    v_mul_f32 v95, v95, v87
    v_mul_f32 v96, v96, v88
    v_mul_f32 v97, v97, v89
    v_mul_f32 v98, v98, v90
    v_mul_f32 v99, v99, v91
    v_mfma_f32_16x16x32_bf16 v[68:71], v[8:11], v[148:151], v[68:71]
    s_cmp_lg_u32 s22, 7
    s_cbranch_scc1 P1_S27
    buffer_load_dwordx4 v[208:211], v23, s[12:15], s52 offen offset:0 sc1
    buffer_load_dwordx4 v[212:215], v23, s[12:15], s52 offen offset:1024 sc1
    buffer_load_dwordx4 v[216:219], v23, s[12:15], s52 offen offset:2048 sc1
    buffer_load_dwordx4 v[220:223], v23, s[12:15], s52 offen offset:3072 sc1
    buffer_load_dwordx4 v[224:227], v23, s[12:15], s53 offen offset:0 sc1
    buffer_load_dwordx4 v[228:231], v23, s[12:15], s53 offen offset:1024 sc1
    buffer_load_dwordx4 v[232:235], v23, s[12:15], s53 offen offset:2048 sc1
    buffer_load_dwordx4 v[236:239], v23, s[12:15], s53 offen offset:3072 sc1
P1_S27:
    ds_read_b128 v[124:127], v32 offset:32768
    ds_read_b128 v[128:131], v32 offset:36864
    ds_read_b64_tr_b16 v[148:149], v24 offset:32768
    ds_read_b64_tr_b16 v[150:151], v24 offset:34816
    s_waitcnt lgkmcnt(8)
    v_mfma_f32_16x16x32_bf16 v[52:55], v[132:135], v[108:111], v[52:55]
    v_cvt_pk_bf16_f32 v100, v92, v93
    v_mfma_f32_16x16x32_bf16 v[56:59], v[132:135], v[112:115], v[56:59]
    v_cvt_pk_bf16_f32 v101, v94, v95
    v_mfma_f32_16x16x32_bf16 v[68:71], v[8:11], v[132:135], v[68:71]
    v_cvt_pk_bf16_f32 v102, v96, v97
    ds_read_b128 v[108:111], v33 offset:32768
    ds_read_b128 v[112:115], v33 offset:36864
    ds_read_b64_tr_b16 v[132:133], v24 offset:40960
    ds_read_b64_tr_b16 v[134:135], v24 offset:43008
    s_waitcnt lgkmcnt(8)
    v_mfma_f32_16x16x32_bf16 v[52:55], v[140:143], v[116:119], v[52:55]
    v_cvt_pk_bf16_f32 v103, v98, v99
    v_mfma_f32_16x16x32_bf16 v[56:59], v[140:143], v[120:123], v[56:59]
    buffer_store_dwordx4 v[100:103], v47, s[12:15], s51 offen sc1
    v_mfma_f32_16x16x32_bf16 v[68:71], v[8:11], v[140:143], v[68:71]
    ds_read_b128 v[116:119], v30 offset:49152
    ds_read_b128 v[120:123], v30 offset:53248
    ds_read_b64_tr_b16 v[140:141], v24 offset:49152
    ds_read_b64_tr_b16 v[142:143], v24 offset:51200
    s_waitcnt lgkmcnt(8)
    v_mfma_f32_16x16x32_bf16 v[52:55], v[148:151], v[124:127], v[52:55]
    v_mfma_f32_16x16x32_bf16 v[56:59], v[148:151], v[128:131], v[56:59]
    v_mfma_f32_16x16x32_bf16 v[68:71], v[8:11], v[148:151], v[68:71]
    ds_read_b128 v[124:127], v31 offset:49152
    ds_read_b128 v[128:131], v31 offset:53248
    ds_read_b64_tr_b16 v[148:149], v24 offset:57344
    ds_read_b64_tr_b16 v[150:151], v24 offset:59392
    s_waitcnt lgkmcnt(8)
    v_mfma_f32_16x16x32_bf16 v[52:55], v[132:135], v[108:111], v[52:55]
    v_mfma_f32_16x16x32_bf16 v[56:59], v[132:135], v[112:115], v[56:59]
    v_mfma_f32_16x16x32_bf16 v[68:71], v[8:11], v[132:135], v[68:71]
    s_cmp_lg_u32 s22, 7
    s_cbranch_scc1 P1_S28
    s_waitcnt vmcnt(0)
    s_mov_b32 s25, 0
P1_POLL21:
    v_xor_b32 v209, v250, v209
    v_xor_b32 v211, v250, v211
    v_xor_b32 v213, v250, v213
    v_xor_b32 v215, v250, v215
    v_xor_b32 v217, v250, v217
    v_xor_b32 v219, v250, v219
    v_xor_b32 v221, v250, v221
    v_xor_b32 v223, v250, v223
    v_xor_b32 v225, v250, v225
    v_xor_b32 v227, v250, v227
    v_xor_b32 v229, v250, v229
    v_xor_b32 v231, v250, v231
    v_xor_b32 v233, v250, v233
    v_xor_b32 v235, v250, v235
    v_xor_b32 v237, v250, v237
    v_xor_b32 v239, v250, v239
    v_or3_b32 v209, v209, v211, v213
    v_or3_b32 v209, v209, v215, v217
    v_or3_b32 v209, v209, v219, v221
    v_or3_b32 v209, v209, v223, v225
    v_or3_b32 v209, v209, v227, v229
    v_or3_b32 v209, v209, v231, v233
    v_or3_b32 v209, v209, v235, v237
    v_or3_b32 v209, v209, v239, v239
    v_cmp_ne_u32 vcc, 0, v209
    s_cmp_eq_u64 vcc, 0
    s_cbranch_scc1 P1_GO21
    buffer_load_dwordx4 v[208:211], v23, s[12:15], s52 offen offset:0 sc1
    buffer_load_dwordx4 v[212:215], v23, s[12:15], s52 offen offset:1024 sc1
    buffer_load_dwordx4 v[216:219], v23, s[12:15], s52 offen offset:2048 sc1
    buffer_load_dwordx4 v[220:223], v23, s[12:15], s52 offen offset:3072 sc1
    buffer_load_dwordx4 v[224:227], v23, s[12:15], s53 offen offset:0 sc1
    buffer_load_dwordx4 v[228:231], v23, s[12:15], s53 offen offset:1024 sc1
    buffer_load_dwordx4 v[232:235], v23, s[12:15], s53 offen offset:2048 sc1
    buffer_load_dwordx4 v[236:239], v23, s[12:15], s53 offen offset:3072 sc1
    s_waitcnt vmcnt(0)
    s_add_u32 s25, s25, 1
    s_cmp_lt_u32 s25, 0x20000
    s_cbranch_scc1 P1_POLL21
P1_GO21:
    v_add_f32 v208, v208, v224
    v_add_f32 v210, v210, v226
    v_add_f32 v212, v212, v228
    v_add_f32 v214, v214, v230
    v_add_f32 v216, v216, v232
    v_add_f32 v218, v218, v234
    v_add_f32 v220, v220, v236
    v_add_f32 v222, v222, v238
    v_add_f32 v208, v208, v216
    v_add_f32 v210, v210, v218
    v_add_f32 v212, v212, v220
    v_add_f32 v214, v214, v222
    v_add_f32 v208, v208, v212
    v_add_f32 v210, v210, v214
    v_mul_f32 v208, 0x3a924925, v208
    v_mul_f32 v210, 0x3a924925, v210
    v_fma_f32 v210, -v208, v208, v210
    v_max_f32 v210, 0, v210
    v_cvt_pk_bf16_f32 v214, v208, v210
    v_lshlrev_b32 v212, 16, v214
    v_xor_b32 v212, 0x80000000, v212
    v_and_b32 v214, 0xffff0000, v214
    v_add_f32 v214, 0x3727c5ac, v214
    v_cvt_pk_bf16_f32 v214, v214, v214
    v_and_b32 v214, 0xffff0000, v214
    v_sqrt_f32 v214, v214
    s_nop 0
    v_cvt_pk_bf16_f32 v214, v214, v214
    v_and_b32 v214, 0xffff0000, v214
    v_rcp_f32 v213, v214
    v_lshlrev_b32 v16, 2, v1
    ds_write_b32 v16, v212 offset:2112
    ds_write_b32 v16, v213 offset:2368
    s_waitcnt lgkmcnt(0)
P1_S28:
    s_barrier
    v_lshlrev_b32 v16, 4, v3
    v_lshl_add_u32 v16, s36, 7, v16
    ds_read_b128 v[208:211], v16 offset:2112
    ds_read_b128 v[216:219], v16 offset:2368
    ds_read_b128 v[212:215], v16 offset:2176
    ds_read_b128 v[220:223], v16 offset:2432
    s_add_u32 s23, s44, s42
    s_lshl_b32 s23, s23, 6
    s_lshl_b32 s24, s20, 1
    s_add_u32 s23, s23, s24
    s_add_u32 s23, s23, s36
    s_lshl_b32 s23, s23, 10
    s_add_u32 s23, s23, 5832704
    s_lshl_b32 s25, s36, 16
    s_add_u32 s24, s23, 65536
    s_sub_u32 s24, s24, s25
    s_add_u32 s23, s23, s25
    v_and_b32 v17, 1, v3
    v_lshlrev_b32 v17, 9, v17
    v_lshrrev_b32 v18, 1, v3
    v_lshl_add_u32 v17, v18, 8, v17
    v_lshl_add_u32 v17, v2, 4, v17
    v_lshlrev_b32 v156, 16, v172
    v_and_b32 v164, 0xffff0000, v172
    v_lshlrev_b32 v157, 16, v173
    v_and_b32 v165, 0xffff0000, v173
    v_lshlrev_b32 v158, 16, v174
    v_and_b32 v166, 0xffff0000, v174
    v_lshlrev_b32 v159, 16, v175
    v_and_b32 v167, 0xffff0000, v175
    v_lshlrev_b32 v160, 16, v176
    v_and_b32 v168, 0xffff0000, v176
    v_lshlrev_b32 v161, 16, v177
    v_and_b32 v169, 0xffff0000, v177
    v_lshlrev_b32 v162, 16, v178
    v_and_b32 v170, 0xffff0000, v178
    v_lshlrev_b32 v163, 16, v179
    v_and_b32 v171, 0xffff0000, v179
    s_waitcnt lgkmcnt(0)
    v_pk_add_f32 v[156:157], v[156:157], v[208:209]
    v_pk_add_f32 v[158:159], v[158:159], v[210:211]
    v_pk_add_f32 v[160:161], v[160:161], v[212:213]
    v_pk_add_f32 v[162:163], v[162:163], v[214:215]
    v_pk_mul_f32 v[156:157], v[156:157], v[216:217]
    v_pk_mul_f32 v[158:159], v[158:159], v[218:219]
    v_pk_mul_f32 v[160:161], v[160:161], v[220:221]
    v_pk_mul_f32 v[162:163], v[162:163], v[222:223]
    v_cvt_pk_bf16_f32 v224, v156, v157
    v_cvt_pk_bf16_f32 v225, v158, v159
    v_cvt_pk_bf16_f32 v226, v160, v161
    v_cvt_pk_bf16_f32 v227, v162, v163
    s_nop 0
    v_permlane16_swap_b32 v224, v226
    v_permlane16_swap_b32 v225, v227
    buffer_store_dwordx4 v[224:227], v17, s[12:15], s23 offen sc1
    v_pk_add_f32 v[164:165], v[164:165], v[208:209]
    v_pk_add_f32 v[166:167], v[166:167], v[210:211]
    v_pk_add_f32 v[168:169], v[168:169], v[212:213]
    v_pk_add_f32 v[170:171], v[170:171], v[214:215]
    v_pk_mul_f32 v[164:165], v[164:165], v[216:217]
    v_pk_mul_f32 v[166:167], v[166:167], v[218:219]
    v_pk_mul_f32 v[168:169], v[168:169], v[220:221]
    v_pk_mul_f32 v[170:171], v[170:171], v[222:223]
    v_cvt_pk_bf16_f32 v228, v164, v165
    v_cvt_pk_bf16_f32 v229, v166, v167
    v_cvt_pk_bf16_f32 v230, v168, v169
    v_cvt_pk_bf16_f32 v231, v170, v171
    s_nop 0
    v_permlane16_swap_b32 v228, v230
    v_permlane16_swap_b32 v229, v231
    buffer_store_dwordx4 v[228:231], v17, s[12:15], s24 offen sc1
    ds_read_b128 v[108:111], v32 offset:49152
    ds_read_b128 v[112:115], v32 offset:53248
    ds_read_b64_tr_b16 v[132:133], v25 offset:0
    ds_read_b64_tr_b16 v[134:135], v25 offset:2048
    s_waitcnt lgkmcnt(8)
    v_mfma_f32_16x16x32_bf16 v[52:55], v[140:143], v[116:119], v[52:55]
    v_mfma_f32_16x16x32_bf16 v[56:59], v[140:143], v[120:123], v[56:59]
    v_mfma_f32_16x16x32_bf16 v[68:71], v[8:11], v[140:143], v[68:71]
    ds_read_b128 v[116:119], v33 offset:49152
    ds_read_b128 v[120:123], v33 offset:53248
    ds_read_b64_tr_b16 v[140:141], v25 offset:8192
    ds_read_b64_tr_b16 v[142:143], v25 offset:10240
    s_waitcnt lgkmcnt(8)
    v_mfma_f32_16x16x32_bf16 v[52:55], v[148:151], v[124:127], v[52:55]
    v_mfma_f32_16x16x32_bf16 v[56:59], v[148:151], v[128:131], v[56:59]
    v_mfma_f32_16x16x32_bf16 v[68:71], v[8:11], v[148:151], v[68:71]
    s_waitcnt lgkmcnt(4)
    v_mfma_f32_16x16x32_bf16 v[52:55], v[132:135], v[108:111], v[52:55]
    v_mfma_f32_16x16x32_bf16 v[56:59], v[132:135], v[112:115], v[56:59]
    v_mfma_f32_16x16x32_bf16 v[68:71], v[8:11], v[132:135], v[68:71]
    s_waitcnt lgkmcnt(0)
    v_mfma_f32_16x16x32_bf16 v[52:55], v[140:143], v[116:119], v[52:55]
    v_mfma_f32_16x16x32_bf16 v[56:59], v[140:143], v[120:123], v[56:59]
    v_mfma_f32_16x16x32_bf16 v[68:71], v[8:11], v[140:143], v[68:71]
    s_lshl_b32 s23, s48, 6
    s_add_u32 s23, s23, 162560
    v_lshl_add_u32 v19, v2, 2, s23
    s_nop 4
    ds_write_b32 v19, v68
    s_lshl_b32 s23, s48, 6
    s_add_u32 s23, s23, 162560
    v_lshl_add_u32 v19, v3, 4, s23
    s_waitcnt lgkmcnt(0)
    s_waitcnt vmcnt(0)
    s_barrier
    s_setprio 0
    ds_read_b128 v[68:71], v19
    s_cmp_lg_u32 s22, 0
    s_cbranch_scc1 KF_A18
    s_lshl_b32 s24, s20, 1
    s_and_b32 s25, s21, 1
    s_add_u32 s24, s24, s25
    s_lshl_b32 s24, s24, 2
    s_lshr_b32 s23, s21, 1
    s_lshl_b32 s23, s23, 8
    s_add_u32 s23, s23, s24
    s_add_u32 s23, s23, 15532032
    v_lshlrev_b32 v252, 10, v1
    s_mov_b64 exec, 0xf
    buffer_store_dword v250, v252, s[12:15], s23 offen sc1
    s_mov_b64 exec, -1
KF_A18:
    v_lshlrev_b32 v18, 2, v2
    v_lshl_add_u32 v18, s36, 7, v18
    v_add_u32 v18, 161536, v18
    ds_read_b32 v84, v18 offset:0
    ds_read_b32 v88, v18 offset:256
    ds_read_b32 v86, v18 offset:64
    ds_read_b32 v90, v18 offset:320
    s_lshl_b32 s23, s20, 2
    s_lshl_b32 s24, s36, 1
    s_add_u32 s23, s23, s24
    s_mul_i32 s23, s23, 56
    s_add_u32 s23, s23, s45
    s_add_u32 s23, s23, s43
    s_lshl_b32 s23, s23, 9
    s_add_u32 s46, s23, 2162688
    s_add_u32 s47, s46, 28672
    v_lshl_add_u32 v21, s36, 9, v22
    v_xor_b32 v23, 0x200, v21
    s_cmp_ge_u32 s22, 4
    s_cbranch_scc1 KF_WV19
    s_mul_i32 s28, s21, 458752
    s_lshl_b32 s23, s22, 14
    s_add_u32 s28, s28, s23
    s_add_u32 s28, s28, 5832704
    s_add_u32 s29, s28, 65536
    s_add_u32 s30, s28, 131072
    s_add_u32 s31, s28, 196608
    s_add_u32 s32, s28, 262144
    s_add_u32 s33, s28, 327680
    s_add_u32 s34, s28, 393216
    s_lshl_b32 s23, s20, 18
    s_lshl_b32 s24, s22, 10
    s_add_u32 s23, s23, s24
    s_xor_b32 s24, s22, 0
    s_lshl_b32 s24, s24, 16
    s_add_u32 s36, s23, s24
    s_xor_b32 s24, s22, 1
    s_lshl_b32 s24, s24, 16
    s_add_u32 s37, s23, s24
    s_xor_b32 s24, s22, 2
    s_lshl_b32 s24, s24, 16
    s_add_u32 s38, s23, s24
    s_xor_b32 s24, s22, 3
    s_lshl_b32 s24, s24, 16
    s_add_u32 s39, s23, s24
    s_mul_i32 s40, s22, 24576
    s_add_u32 s40, s40, 63232
    v_lshlrev_b32 v7, 4, v1
    v_and_b32 v124, 7, v1
    v_lshrrev_b32 v125, 3, v1
    v_xor_b32 v126, v124, v3
    v_lshlrev_b32 v8, 12, v125
    v_lshl_add_u32 v8, v126, 4, v8
    v_xor_b32 v240, 64, v8
    v_add_u32 v240, 0x8000, v240
    v_lshrrev_b32 v124, 1, v2
    v_xor_b32 v124, v124, v3
    v_lshlrev_b32 v9, 7, v2
    v_lshl_add_u32 v9, v124, 4, v9
    v_add_u32 v9, s40, v9
    v_xor_b32 v241, 64, v9
    s_and_b32 s41, s20, 7
    s_lshl_b32 s41, s41, 1
    s_mov_b32 s41, 0
    s_add_u32 s23, s41, 0
    s_and_b32 s23, s23, 15
    s_lshl_b32 s23, s23, 6
    s_add_u32 s23, s23, s36
    s_add_u32 m0, s40, 0
    s_nop 0
    buffer_load_dwordx4 v8, s[16:19], s23 offen lds
    s_add_u32 s23, s41, 0
    s_and_b32 s23, s23, 15
    s_lshl_b32 s23, s23, 6
    s_add_u32 s23, s23, s36
    s_add_u32 m0, s40, 1024
    s_nop 0
    buffer_load_dwordx4 v240, s[16:19], s23 offen lds
    s_add_u32 s23, s41, 0
    s_and_b32 s23, s23, 15
    s_lshl_b32 s23, s23, 6
    s_add_u32 s23, s23, s37
    s_add_u32 m0, s40, 2048
    s_nop 0
    buffer_load_dwordx4 v8, s[16:19], s23 offen lds
    s_add_u32 s23, s41, 0
    s_and_b32 s23, s23, 15
    s_lshl_b32 s23, s23, 6
    s_add_u32 s23, s23, s37
    s_add_u32 m0, s40, 3072
    s_nop 0
    buffer_load_dwordx4 v240, s[16:19], s23 offen lds
    s_add_u32 s23, s41, 0
    s_and_b32 s23, s23, 15
    s_lshl_b32 s23, s23, 6
    s_add_u32 s23, s23, s38
    s_add_u32 m0, s40, 4096
    s_nop 0
    buffer_load_dwordx4 v8, s[16:19], s23 offen lds
    s_add_u32 s23, s41, 0
    s_and_b32 s23, s23, 15
    s_lshl_b32 s23, s23, 6
    s_add_u32 s23, s23, s38
    s_add_u32 m0, s40, 5120
    s_nop 0
    buffer_load_dwordx4 v240, s[16:19], s23 offen lds
    s_add_u32 s23, s41, 0
    s_and_b32 s23, s23, 15
    s_lshl_b32 s23, s23, 6
    s_add_u32 s23, s23, s39
    s_add_u32 m0, s40, 6144
    s_nop 0
    buffer_load_dwordx4 v8, s[16:19], s23 offen lds
    s_add_u32 s23, s41, 0
    s_and_b32 s23, s23, 15
    s_lshl_b32 s23, s23, 6
    s_add_u32 s23, s23, s39
    s_add_u32 m0, s40, 7168
    s_nop 0
    buffer_load_dwordx4 v240, s[16:19], s23 offen lds
KF_WV19:
    s_waitcnt lgkmcnt(0)
    v_pk_fma_f32 v[52:53], v[68:69], v[84:85], v[52:53] op_sel_hi:[1,0,1]
    v_pk_fma_f32 v[54:55], v[70:71], v[84:85], v[54:55] op_sel_hi:[1,0,1]
    v_pk_fma_f32 v[56:57], v[68:69], v[86:87], v[56:57] op_sel_hi:[1,0,1]
    s_cmp_ge_u32 s22, 4
    s_cbranch_scc1 KF_WV20
    s_add_u32 s23, s41, 2
    s_and_b32 s23, s23, 15
    s_lshl_b32 s23, s23, 6
    s_add_u32 s23, s23, s36
    s_add_u32 m0, s40, 8192
    s_nop 0
    buffer_load_dwordx4 v8, s[16:19], s23 offen lds
    s_add_u32 s23, s41, 2
    s_and_b32 s23, s23, 15
    s_lshl_b32 s23, s23, 6
    s_add_u32 s23, s23, s36
    s_add_u32 m0, s40, 9216
    s_nop 0
    buffer_load_dwordx4 v240, s[16:19], s23 offen lds
KF_WV20:
    v_pk_fma_f32 v[58:59], v[70:71], v[86:87], v[58:59] op_sel_hi:[1,0,1]
    v_pk_mul_f32 v[52:53], v[52:53], v[88:89] op_sel_hi:[1,0]
    v_pk_mul_f32 v[54:55], v[54:55], v[88:89] op_sel_hi:[1,0]
    s_cmp_ge_u32 s22, 4
    s_cbranch_scc1 KF_WV21
    s_add_u32 s23, s41, 2
    s_and_b32 s23, s23, 15
    s_lshl_b32 s23, s23, 6
    s_add_u32 s23, s23, s37
    s_add_u32 m0, s40, 10240
    s_nop 0
    buffer_load_dwordx4 v8, s[16:19], s23 offen lds
    s_add_u32 s23, s41, 2
    s_and_b32 s23, s23, 15
    s_lshl_b32 s23, s23, 6
    s_add_u32 s23, s23, s37
    s_add_u32 m0, s40, 11264
    s_nop 0
    buffer_load_dwordx4 v240, s[16:19], s23 offen lds
KF_WV21:
    v_pk_mul_f32 v[56:57], v[56:57], v[90:91] op_sel_hi:[1,0]
    v_pk_mul_f32 v[58:59], v[58:59], v[90:91] op_sel_hi:[1,0]
    v_pk_mul_f32 v[92:93], v[52:53], v[52:53]
    s_cmp_ge_u32 s22, 4
    s_cbranch_scc1 KF_WV22
    s_add_u32 s23, s41, 2
    s_and_b32 s23, s23, 15
    s_lshl_b32 s23, s23, 6
    s_add_u32 s23, s23, s38
    s_add_u32 m0, s40, 12288
    s_nop 0
    buffer_load_dwordx4 v8, s[16:19], s23 offen lds
    s_add_u32 s23, s41, 2
    s_and_b32 s23, s23, 15
    s_lshl_b32 s23, s23, 6
    s_add_u32 s23, s23, s38
    s_add_u32 m0, s40, 13312
    s_nop 0
    buffer_load_dwordx4 v240, s[16:19], s23 offen lds
KF_WV22:
    v_pk_mul_f32 v[94:95], v[54:55], v[54:55]
    v_pk_mul_f32 v[96:97], v[56:57], v[56:57]
    v_pk_mul_f32 v[98:99], v[58:59], v[58:59]
    s_cmp_ge_u32 s22, 4
    s_cbranch_scc1 KF_WV23
    s_add_u32 s23, s41, 2
    s_and_b32 s23, s23, 15
    s_lshl_b32 s23, s23, 6
    s_add_u32 s23, s23, s39
    s_add_u32 m0, s40, 14336
    s_nop 0
    buffer_load_dwordx4 v8, s[16:19], s23 offen lds
    s_add_u32 s23, s41, 2
    s_and_b32 s23, s23, 15
    s_lshl_b32 s23, s23, 6
    s_add_u32 s23, s23, s39
    s_add_u32 m0, s40, 15360
    s_nop 0
    buffer_load_dwordx4 v240, s[16:19], s23 offen lds
KF_WV23:
    v_pk_fma_f32 v[92:93], v[92:93], s[54:55], v[12:13]
    v_pk_fma_f32 v[94:95], v[94:95], s[54:55], v[12:13]
    v_pk_fma_f32 v[96:97], v[96:97], s[54:55], v[12:13]
    s_cmp_ge_u32 s22, 4
    s_cbranch_scc1 KF_WV24
    s_add_u32 s23, s41, 4
    s_and_b32 s23, s23, 15
    s_lshl_b32 s23, s23, 6
    s_add_u32 s23, s23, s36
    s_add_u32 m0, s40, 16384
    s_nop 0
    buffer_load_dwordx4 v8, s[16:19], s23 offen lds
    s_add_u32 s23, s41, 4
    s_and_b32 s23, s23, 15
    s_lshl_b32 s23, s23, 6
    s_add_u32 s23, s23, s36
    s_add_u32 m0, s40, 17408
    s_nop 0
    buffer_load_dwordx4 v240, s[16:19], s23 offen lds
KF_WV24:
    v_pk_fma_f32 v[98:99], v[98:99], s[54:55], v[12:13]
    v_pk_mul_f32 v[92:93], v[92:93], v[52:53]
    v_pk_mul_f32 v[94:95], v[94:95], v[54:55]
    s_cmp_ge_u32 s22, 4
    s_cbranch_scc1 KF_WV25
    s_add_u32 s23, s41, 4
    s_and_b32 s23, s23, 15
    s_lshl_b32 s23, s23, 6
    s_add_u32 s23, s23, s37
    s_add_u32 m0, s40, 18432
    s_nop 0
    buffer_load_dwordx4 v8, s[16:19], s23 offen lds
    s_add_u32 s23, s41, 4
    s_and_b32 s23, s23, 15
    s_lshl_b32 s23, s23, 6
    s_add_u32 s23, s23, s37
    s_add_u32 m0, s40, 19456
    s_nop 0
    buffer_load_dwordx4 v240, s[16:19], s23 offen lds
KF_WV25:
    v_pk_mul_f32 v[96:97], v[96:97], v[56:57]
    v_pk_mul_f32 v[98:99], v[98:99], v[58:59]
    v_exp_f32 v92, v92
    s_cmp_ge_u32 s22, 4
    s_cbranch_scc1 KF_WV26
    s_add_u32 s23, s41, 4
    s_and_b32 s23, s23, 15
    s_lshl_b32 s23, s23, 6
    s_add_u32 s23, s23, s38
    s_add_u32 m0, s40, 20480
    s_nop 0
    buffer_load_dwordx4 v8, s[16:19], s23 offen lds
    s_add_u32 s23, s41, 4
    s_and_b32 s23, s23, 15
    s_lshl_b32 s23, s23, 6
    s_add_u32 s23, s23, s38
    s_add_u32 m0, s40, 21504
    s_nop 0
    buffer_load_dwordx4 v240, s[16:19], s23 offen lds
KF_WV26:
    v_exp_f32 v93, v93
    v_exp_f32 v94, v94
    v_exp_f32 v95, v95
    s_cmp_ge_u32 s22, 4
    s_cbranch_scc1 KF_WV27
    s_add_u32 s23, s41, 4
    s_and_b32 s23, s23, 15
    s_lshl_b32 s23, s23, 6
    s_add_u32 s23, s23, s39
    s_add_u32 m0, s40, 22528
    s_nop 0
    buffer_load_dwordx4 v8, s[16:19], s23 offen lds
    s_add_u32 s23, s41, 4
    s_and_b32 s23, s23, 15
    s_lshl_b32 s23, s23, 6
    s_add_u32 s23, s23, s39
    s_add_u32 m0, s40, 23552
    s_nop 0
    buffer_load_dwordx4 v240, s[16:19], s23 offen lds
KF_WV27:
    v_exp_f32 v96, v96
    v_exp_f32 v97, v97
    v_exp_f32 v98, v98
    s_cmp_ge_u32 s22, 4
    s_cbranch_scc1 KF_WV28
    s_waitcnt vmcnt(16)
    ds_read_b128 v[208:211], v9 offset:0
    ds_read_b128 v[212:215], v9 offset:2048
    ds_read_b128 v[216:219], v9 offset:4096
    ds_read_b128 v[220:223], v9 offset:6144
    ds_read_b128 v[224:227], v241 offset:0
    ds_read_b128 v[228:231], v241 offset:2048
    ds_read_b128 v[232:235], v241 offset:4096
    ds_read_b128 v[236:239], v241 offset:6144
KF_WV28:
    v_exp_f32 v99, v99
    v_pk_add_f32 v[92:93], v[92:93], v[14:15]
    v_pk_add_f32 v[94:95], v[94:95], v[14:15]
    s_cmp_ge_u32 s22, 4
    s_cbranch_scc1 KF_WV29
    s_waitcnt lgkmcnt(0)
    s_add_u32 s23, s41, 6
    s_and_b32 s23, s23, 15
    s_lshl_b32 s23, s23, 6
    s_add_u32 s23, s23, s36
    s_add_u32 m0, s40, 0
    s_nop 0
    buffer_load_dwordx4 v8, s[16:19], s23 offen lds
    s_add_u32 s23, s41, 6
    s_and_b32 s23, s23, 15
    s_lshl_b32 s23, s23, 6
    s_add_u32 s23, s23, s36
    s_add_u32 m0, s40, 1024
    s_nop 0
    buffer_load_dwordx4 v240, s[16:19], s23 offen lds
KF_WV29:
    v_pk_add_f32 v[96:97], v[96:97], v[14:15]
    v_pk_add_f32 v[98:99], v[98:99], v[14:15]
    v_rcp_f32 v92, v92
    s_cmp_ge_u32 s22, 4
    s_cbranch_scc1 KF_WV30
    s_add_u32 s23, s41, 6
    s_and_b32 s23, s23, 15
    s_lshl_b32 s23, s23, 6
    s_add_u32 s23, s23, s37
    s_add_u32 m0, s40, 2048
    s_nop 0
    buffer_load_dwordx4 v8, s[16:19], s23 offen lds
    s_add_u32 s23, s41, 6
    s_and_b32 s23, s23, 15
    s_lshl_b32 s23, s23, 6
    s_add_u32 s23, s23, s37
    s_add_u32 m0, s40, 3072
    s_nop 0
    buffer_load_dwordx4 v240, s[16:19], s23 offen lds
KF_WV30:
    v_rcp_f32 v93, v93
    v_rcp_f32 v94, v94
    v_rcp_f32 v95, v95
    s_cmp_ge_u32 s22, 4
    s_cbranch_scc1 KF_WV31
    s_add_u32 s23, s41, 6
    s_and_b32 s23, s23, 15
    s_lshl_b32 s23, s23, 6
    s_add_u32 s23, s23, s38
    s_add_u32 m0, s40, 4096
    s_nop 0
    buffer_load_dwordx4 v8, s[16:19], s23 offen lds
    s_add_u32 s23, s41, 6
    s_and_b32 s23, s23, 15
    s_lshl_b32 s23, s23, 6
    s_add_u32 s23, s23, s38
    s_add_u32 m0, s40, 5120
    s_nop 0
    buffer_load_dwordx4 v240, s[16:19], s23 offen lds
KF_WV31:
    v_rcp_f32 v96, v96
    v_rcp_f32 v97, v97
    v_rcp_f32 v98, v98
    s_cmp_ge_u32 s22, 4
    s_cbranch_scc1 KF_WV32
    s_add_u32 s23, s41, 6
    s_and_b32 s23, s23, 15
    s_lshl_b32 s23, s23, 6
    s_add_u32 s23, s23, s39
    s_add_u32 m0, s40, 6144
    s_nop 0
    buffer_load_dwordx4 v8, s[16:19], s23 offen lds
    s_add_u32 s23, s41, 6
    s_and_b32 s23, s23, 15
    s_lshl_b32 s23, s23, 6
    s_add_u32 s23, s23, s39
    s_add_u32 m0, s40, 7168
    s_nop 0
    buffer_load_dwordx4 v240, s[16:19], s23 offen lds
KF_WV32:
    v_rcp_f32 v99, v99
    v_pk_mul_f32 v[52:53], v[52:53], v[92:93]
    v_pk_mul_f32 v[54:55], v[54:55], v[94:95]
    v_pk_mul_f32 v[56:57], v[56:57], v[96:97]
    v_pk_mul_f32 v[58:59], v[58:59], v[98:99]
    v_cvt_pk_bf16_f32 v76, v52, v53
    v_cvt_pk_bf16_f32 v77, v54, v55
    buffer_store_dwordx2 v[76:77], v22, s[12:15], s46 offen sc1
    v_cvt_pk_bf16_f32 v78, v56, v57
    v_cvt_pk_bf16_f32 v79, v58, v59
    buffer_store_dwordx2 v[78:79], v22, s[12:15], s47 offen sc1
    s_nop 1
    s_branch P1_DONE
P1_P22:
    s_xor_b32 s23, s36, 0
    s_add_u32 s23, s23, s47
    v_xor_b32 v16, s23, v29
    v_lshl_add_u32 v24, v16, 5, v28
    v_add_u32 v25, 0x10000, v24
    s_xor_b32 s23, s36, 1
    s_add_u32 s23, s23, s47
    v_xor_b32 v16, s23, v29
    v_lshl_add_u32 v26, v16, 5, v28
    v_add_u32 v27, 0x10000, v26
    s_cmp_eq_u32 s36, 0
    s_cbranch_scc1 P1_S29
    s_setprio 1
P1_S29:
    s_barrier
    ds_read_b128 v[108:111], v30 offset:0
    ds_read_b128 v[112:115], v30 offset:4096
    ds_read_b64_tr_b16 v[132:133], v24 offset:0
    ds_read_b64_tr_b16 v[134:135], v24 offset:2048
    ds_read_b64_tr_b16 v[136:137], v26 offset:0
    ds_read_b64_tr_b16 v[138:139], v26 offset:2048
    ds_read_b128 v[116:119], v31 offset:0
    ds_read_b128 v[120:123], v31 offset:4096
    ds_read_b64_tr_b16 v[140:141], v24 offset:8192
    ds_read_b64_tr_b16 v[142:143], v24 offset:10240
    ds_read_b64_tr_b16 v[144:145], v26 offset:8192
    ds_read_b64_tr_b16 v[146:147], v26 offset:10240
    s_cmp_lg_u32 s36, 0
    s_cbranch_scc1 P1_S30
    ds_read_b128 v[92:95], v39 offset:0
    ds_read_b128 v[96:99], v40 offset:0
    ds_read_b128 v[100:103], v41 offset:0
    ds_read_b128 v[104:107], v42 offset:0
P1_S30:
    ds_read_b128 v[124:127], v32 offset:0
    ds_read_b128 v[128:131], v32 offset:4096
    ds_read_b64_tr_b16 v[148:149], v24 offset:16384
    ds_read_b64_tr_b16 v[150:151], v24 offset:18432
    ds_read_b64_tr_b16 v[152:153], v26 offset:16384
    ds_read_b64_tr_b16 v[154:155], v26 offset:18432
    s_waitcnt lgkmcnt(12)
    v_mfma_f32_16x16x32_bf16 v[156:159], v[108:111], v[132:135], 0
    s_add_u32 s25, s39, 688128
    s_add_u32 m0, s41, 49152
    s_nop 0
    buffer_load_dwordx4 v34, s[32:35], s25 offen lds
    v_mfma_f32_16x16x32_bf16 v[160:163], v[112:115], v[132:135], 0
    s_add_u32 s25, s39, 802816
    s_add_u32 m0, s41, 57344
    s_nop 0
    buffer_load_dwordx4 v34, s[32:35], s25 offen lds
    v_mfma_f32_16x16x32_bf16 v[68:71], v[8:11], v[132:135], 0
    s_add_u32 m0, s50, 32768
    s_add_u32 s25, s49, 512
    buffer_load_dwordx4 v35, s[28:31], s25 offen offset:0 lds
    buffer_load_dwordx4 v36, s[28:31], s25 offen offset:1024 lds
    v_mfma_f32_16x16x32_bf16 v[164:167], v[108:111], v[136:139], 0
    s_add_u32 s25, s39, 917504
    s_add_u32 m0, s41, 65536
    s_nop 0
    buffer_load_dwordx4 v34, s[32:35], s25 offen lds
    v_mfma_f32_16x16x32_bf16 v[168:171], v[112:115], v[136:139], 0
    ds_read_b128 v[108:111], v33 offset:0
    ds_read_b128 v[112:115], v33 offset:4096
    ds_read_b64_tr_b16 v[132:133], v24 offset:24576
    ds_read_b64_tr_b16 v[134:135], v24 offset:26624
    ds_read_b64_tr_b16 v[136:137], v26 offset:24576
    ds_read_b64_tr_b16 v[138:139], v26 offset:26624
    s_waitcnt lgkmcnt(12)
    v_mfma_f32_16x16x32_bf16 v[156:159], v[116:119], v[140:143], v[156:159]
    v_mfma_f32_16x16x32_bf16 v[160:163], v[120:123], v[140:143], v[160:163]
    v_mfma_f32_16x16x32_bf16 v[68:71], v[8:11], v[140:143], v[68:71]
    v_mfma_f32_16x16x32_bf16 v[164:167], v[116:119], v[144:147], v[164:167]
    v_mfma_f32_16x16x32_bf16 v[168:171], v[120:123], v[144:147], v[168:171]
    s_waitcnt vmcnt(5)
    s_barrier
    s_cmp_lg_u32 s36, 0
    s_cbranch_scc1 P1_S31
    s_waitcnt lgkmcnt(12)
    v_mfma_f32_16x16x32_bf16 v[172:175], v[92:95], v[8:11], 0
    v_mfma_f32_16x16x32_bf16 v[176:179], v[92:95], v[92:95], 0
    v_mfma_f32_16x16x32_bf16 v[172:175], v[96:99], v[8:11], v[172:175]
    v_mfma_f32_16x16x32_bf16 v[176:179], v[96:99], v[96:99], v[176:179]
    v_mfma_f32_16x16x32_bf16 v[172:175], v[100:103], v[8:11], v[172:175]
    v_mfma_f32_16x16x32_bf16 v[176:179], v[100:103], v[100:103], v[176:179]
    v_mfma_f32_16x16x32_bf16 v[172:175], v[104:107], v[8:11], v[172:175]
    v_mfma_f32_16x16x32_bf16 v[176:179], v[104:107], v[104:107], v[176:179]
    ds_read_b128 v[92:95], v39 offset:16384
    ds_read_b128 v[96:99], v40 offset:16384
    ds_read_b128 v[100:103], v41 offset:16384
    ds_read_b128 v[104:107], v42 offset:16384
P1_S31:
    ds_read_b128 v[116:119], v30 offset:16384
    ds_read_b128 v[120:123], v30 offset:20480
    ds_read_b64_tr_b16 v[140:141], v24 offset:32768
    ds_read_b64_tr_b16 v[142:143], v24 offset:34816
    ds_read_b64_tr_b16 v[144:145], v26 offset:32768
    ds_read_b64_tr_b16 v[146:147], v26 offset:34816
    s_waitcnt lgkmcnt(12)
    v_mfma_f32_16x16x32_bf16 v[156:159], v[124:127], v[148:151], v[156:159]
    s_add_u32 s25, s39, 1032192
    s_add_u32 m0, s41, 73728
    s_nop 0
    buffer_load_dwordx4 v34, s[32:35], s25 offen lds
    v_mfma_f32_16x16x32_bf16 v[160:163], v[128:131], v[148:151], v[160:163]
    s_add_u32 s25, s39, 1146880
    s_add_u32 m0, s41, 81920
    s_nop 0
    buffer_load_dwordx4 v34, s[32:35], s25 offen lds
    v_mfma_f32_16x16x32_bf16 v[68:71], v[8:11], v[148:151], v[68:71]
    s_add_u32 s25, s39, 1261568
    s_add_u32 m0, s41, 0
    s_nop 0
    buffer_load_dwordx4 v34, s[32:35], s25 offen lds
    v_mfma_f32_16x16x32_bf16 v[164:167], v[124:127], v[152:155], v[164:167]
    s_add_u32 m0, s50, 49152
    s_add_u32 s25, s49, 768
    buffer_load_dwordx4 v35, s[28:31], s25 offen offset:0 lds
    v_mfma_f32_16x16x32_bf16 v[168:171], v[128:131], v[152:155], v[168:171]
    ds_read_b128 v[124:127], v31 offset:16384
    ds_read_b128 v[128:131], v31 offset:20480
    ds_read_b64_tr_b16 v[148:149], v24 offset:40960
    ds_read_b64_tr_b16 v[150:151], v24 offset:43008
    ds_read_b64_tr_b16 v[152:153], v26 offset:40960
    ds_read_b64_tr_b16 v[154:155], v26 offset:43008
    s_waitcnt lgkmcnt(12)
    v_mfma_f32_16x16x32_bf16 v[156:159], v[108:111], v[132:135], v[156:159]
    v_mfma_f32_16x16x32_bf16 v[160:163], v[112:115], v[132:135], v[160:163]
    v_mfma_f32_16x16x32_bf16 v[68:71], v[8:11], v[132:135], v[68:71]
    v_mfma_f32_16x16x32_bf16 v[164:167], v[108:111], v[136:139], v[164:167]
    v_mfma_f32_16x16x32_bf16 v[168:171], v[112:115], v[136:139], v[168:171]
    s_waitcnt vmcnt(7)
    s_barrier
    s_cmp_lg_u32 s36, 0
    s_cbranch_scc1 P1_S32
    s_waitcnt lgkmcnt(12)
    v_mfma_f32_16x16x32_bf16 v[172:175], v[92:95], v[8:11], v[172:175]
    v_mfma_f32_16x16x32_bf16 v[176:179], v[92:95], v[92:95], v[176:179]
    v_mfma_f32_16x16x32_bf16 v[172:175], v[96:99], v[8:11], v[172:175]
    v_mfma_f32_16x16x32_bf16 v[176:179], v[96:99], v[96:99], v[176:179]
    v_mfma_f32_16x16x32_bf16 v[172:175], v[100:103], v[8:11], v[172:175]
    v_mfma_f32_16x16x32_bf16 v[176:179], v[100:103], v[100:103], v[176:179]
    v_mfma_f32_16x16x32_bf16 v[172:175], v[104:107], v[8:11], v[172:175]
    v_mfma_f32_16x16x32_bf16 v[176:179], v[104:107], v[104:107], v[176:179]
P1_S32:
    ds_read_b128 v[108:111], v32 offset:16384
    ds_read_b128 v[112:115], v32 offset:20480
    ds_read_b64_tr_b16 v[132:133], v24 offset:49152
    ds_read_b64_tr_b16 v[134:135], v24 offset:51200
    ds_read_b64_tr_b16 v[136:137], v26 offset:49152
    ds_read_b64_tr_b16 v[138:139], v26 offset:51200
    s_waitcnt lgkmcnt(12)
    v_mfma_f32_16x16x32_bf16 v[156:159], v[116:119], v[140:143], v[156:159]
    s_add_u32 m0, s50, 49152
    s_add_u32 s25, s49, 768
    buffer_load_dwordx4 v36, s[28:31], s25 offen offset:1024 lds
    v_mfma_f32_16x16x32_bf16 v[160:163], v[120:123], v[140:143], v[160:163]
    s_add_u32 s25, s39, 1376256
    s_add_u32 m0, s41, 8192
    s_nop 0
    buffer_load_dwordx4 v34, s[32:35], s25 offen lds
    v_mfma_f32_16x16x32_bf16 v[68:71], v[8:11], v[140:143], v[68:71]
    s_add_u32 s25, s39, 1490944
    s_add_u32 m0, s41, 16384
    s_nop 0
    buffer_load_dwordx4 v34, s[32:35], s25 offen lds
    v_mfma_f32_16x16x32_bf16 v[164:167], v[116:119], v[144:147], v[164:167]
    s_add_u32 s25, s39, 1605632
    s_add_u32 m0, s41, 24576
    s_nop 0
    buffer_load_dwordx4 v34, s[32:35], s25 offen lds
    v_mfma_f32_16x16x32_bf16 v[168:171], v[120:123], v[144:147], v[168:171]
    ds_read_b128 v[116:119], v33 offset:16384
    ds_read_b128 v[120:123], v33 offset:20480
    ds_read_b64_tr_b16 v[140:141], v24 offset:57344
    ds_read_b64_tr_b16 v[142:143], v24 offset:59392
    ds_read_b64_tr_b16 v[144:145], v26 offset:57344
    ds_read_b64_tr_b16 v[146:147], v26 offset:59392
    s_waitcnt lgkmcnt(12)
    v_mfma_f32_16x16x32_bf16 v[156:159], v[124:127], v[148:151], v[156:159]
    v_mfma_f32_16x16x32_bf16 v[160:163], v[128:131], v[148:151], v[160:163]
    v_mfma_f32_16x16x32_bf16 v[68:71], v[8:11], v[148:151], v[68:71]
    v_mfma_f32_16x16x32_bf16 v[164:167], v[124:127], v[152:155], v[164:167]
    v_mfma_f32_16x16x32_bf16 v[168:171], v[128:131], v[152:155], v[168:171]
    s_waitcnt vmcnt(7)
    s_barrier
    s_cmp_lg_u32 s36, 0
    s_cbranch_scc1 P1_S33
    ds_read_b128 v[92:95], v39 offset:32768
    ds_read_b128 v[96:99], v40 offset:32768
    ds_read_b128 v[100:103], v41 offset:32768
    ds_read_b128 v[104:107], v42 offset:32768
P1_S33:
    s_cmp_lg_u32 s22, 7
    s_cbranch_scc1 P1_S34
    s_mov_b32 s60, s100
    s_and_b32 s61, s101, 0xffff
    s_mov_b32 s62, 0x00000100
    s_mov_b32 s63, 0x00020000
    v_mov_b32 v251, 0
    buffer_load_dword v250, v251, s[60:63], 0 offen sc1
P1_S34:
    ds_read_b128 v[124:127], v30 offset:32768
    ds_read_b128 v[128:131], v30 offset:36864
    ds_read_b64_tr_b16 v[148:149], v25 offset:0
    ds_read_b64_tr_b16 v[150:151], v25 offset:2048
    ds_read_b64_tr_b16 v[152:153], v27 offset:0
    ds_read_b64_tr_b16 v[154:155], v27 offset:2048
    s_waitcnt lgkmcnt(12)
    v_mfma_f32_16x16x32_bf16 v[156:159], v[108:111], v[132:135], v[156:159]
    s_add_u32 s25, s39, 1720320
    s_add_u32 m0, s41, 32768
    s_nop 0
    buffer_load_dwordx4 v34, s[32:35], s25 offen lds
    v_mfma_f32_16x16x32_bf16 v[160:163], v[112:115], v[132:135], v[160:163]
    s_add_u32 s25, s40, 0
    s_add_u32 m0, s41, 40960
    s_nop 0
    buffer_load_dwordx4 v34, s[32:35], s25 offen lds
    v_mfma_f32_16x16x32_bf16 v[68:71], v[8:11], v[132:135], v[68:71]
    v_mfma_f32_16x16x32_bf16 v[164:167], v[108:111], v[136:139], v[164:167]
    v_mfma_f32_16x16x32_bf16 v[168:171], v[112:115], v[136:139], v[168:171]
    ds_read_b128 v[108:111], v31 offset:32768
    ds_read_b128 v[112:115], v31 offset:36864
    ds_read_b64_tr_b16 v[132:133], v25 offset:8192
    ds_read_b64_tr_b16 v[134:135], v25 offset:10240
    ds_read_b64_tr_b16 v[136:137], v27 offset:8192
    ds_read_b64_tr_b16 v[138:139], v27 offset:10240
    s_waitcnt lgkmcnt(12)
    v_mfma_f32_16x16x32_bf16 v[156:159], v[116:119], v[140:143], v[156:159]
    v_mfma_f32_16x16x32_bf16 v[160:163], v[120:123], v[140:143], v[160:163]
    v_mfma_f32_16x16x32_bf16 v[68:71], v[8:11], v[140:143], v[68:71]
    v_mfma_f32_16x16x32_bf16 v[164:167], v[116:119], v[144:147], v[164:167]
    v_mfma_f32_16x16x32_bf16 v[168:171], v[120:123], v[144:147], v[168:171]
    s_waitcnt vmcnt(7)
    s_barrier
    s_cmp_lg_u32 s36, 0
    s_cbranch_scc1 P1_S35
    s_waitcnt lgkmcnt(12)
    v_mfma_f32_16x16x32_bf16 v[172:175], v[92:95], v[8:11], v[172:175]
    v_mfma_f32_16x16x32_bf16 v[176:179], v[92:95], v[92:95], v[176:179]
    v_mfma_f32_16x16x32_bf16 v[172:175], v[96:99], v[8:11], v[172:175]
    v_mfma_f32_16x16x32_bf16 v[176:179], v[96:99], v[96:99], v[176:179]
    v_mfma_f32_16x16x32_bf16 v[172:175], v[100:103], v[8:11], v[172:175]
    v_mfma_f32_16x16x32_bf16 v[176:179], v[100:103], v[100:103], v[176:179]
    v_mfma_f32_16x16x32_bf16 v[172:175], v[104:107], v[8:11], v[172:175]
    v_mfma_f32_16x16x32_bf16 v[176:179], v[104:107], v[104:107], v[176:179]
P1_S35:
    ds_read_b128 v[116:119], v32 offset:32768
    ds_read_b128 v[120:123], v32 offset:36864
    ds_read_b64_tr_b16 v[140:141], v25 offset:16384
    ds_read_b64_tr_b16 v[142:143], v25 offset:18432
    ds_read_b64_tr_b16 v[144:145], v27 offset:16384
    ds_read_b64_tr_b16 v[146:147], v27 offset:18432
    s_waitcnt lgkmcnt(12)
    v_mfma_f32_16x16x32_bf16 v[156:159], v[124:127], v[148:151], v[156:159]
    s_add_u32 s25, s40, 114688
    s_add_u32 m0, s41, 49152
    s_nop 0
    buffer_load_dwordx4 v34, s[32:35], s25 offen lds
    v_mfma_f32_16x16x32_bf16 v[160:163], v[128:131], v[148:151], v[160:163]
    s_add_u32 s25, s40, 229376
    s_add_u32 m0, s41, 57344
    s_nop 0
    buffer_load_dwordx4 v34, s[32:35], s25 offen lds
    v_mfma_f32_16x16x32_bf16 v[68:71], v[8:11], v[148:151], v[68:71]
    v_mfma_f32_16x16x32_bf16 v[164:167], v[124:127], v[152:155], v[164:167]
    v_mfma_f32_16x16x32_bf16 v[168:171], v[128:131], v[152:155], v[168:171]
    ds_read_b128 v[124:127], v33 offset:32768
    ds_read_b128 v[128:131], v33 offset:36864
    ds_read_b64_tr_b16 v[148:149], v24 offset:0
    ds_read_b64_tr_b16 v[150:151], v24 offset:2048
    ds_read_b64_tr_b16 v[152:153], v26 offset:0
    ds_read_b64_tr_b16 v[154:155], v26 offset:2048
    s_waitcnt lgkmcnt(12)
    v_mfma_f32_16x16x32_bf16 v[156:159], v[108:111], v[132:135], v[156:159]
    v_mfma_f32_16x16x32_bf16 v[160:163], v[112:115], v[132:135], v[160:163]
    v_mfma_f32_16x16x32_bf16 v[68:71], v[8:11], v[132:135], v[68:71]
    v_mfma_f32_16x16x32_bf16 v[164:167], v[108:111], v[136:139], v[164:167]
    v_mfma_f32_16x16x32_bf16 v[168:171], v[112:115], v[136:139], v[168:171]
    s_waitcnt vmcnt(5)
    s_barrier
    s_cmp_lg_u32 s36, 0
    s_cbranch_scc1 P1_S36
    ds_read_b128 v[92:95], v39 offset:49152
    ds_read_b128 v[96:99], v40 offset:49152
    ds_read_b128 v[100:103], v41 offset:49152
    ds_read_b128 v[104:107], v42 offset:49152
P1_S36:
    ds_read_b128 v[108:111], v30 offset:49152
    ds_read_b128 v[112:115], v30 offset:53248
    ds_read_b64_tr_b16 v[132:133], v24 offset:8192
    ds_read_b64_tr_b16 v[134:135], v24 offset:10240
    ds_read_b64_tr_b16 v[136:137], v26 offset:8192
    ds_read_b64_tr_b16 v[138:139], v26 offset:10240
    s_waitcnt lgkmcnt(12)
    v_mfma_f32_16x16x32_bf16 v[156:159], v[116:119], v[140:143], v[156:159]
    s_add_u32 s25, s40, 344064
    s_add_u32 m0, s41, 65536
    s_nop 0
    buffer_load_dwordx4 v34, s[32:35], s25 offen lds
    v_mfma_f32_16x16x32_bf16 v[160:163], v[120:123], v[140:143], v[160:163]
    s_add_u32 s25, s40, 458752
    s_add_u32 m0, s41, 73728
    s_nop 0
    buffer_load_dwordx4 v34, s[32:35], s25 offen lds
    v_mfma_f32_16x16x32_bf16 v[68:71], v[8:11], v[140:143], v[68:71]
    v_mfma_f32_16x16x32_bf16 v[164:167], v[116:119], v[144:147], v[164:167]
    v_mfma_f32_16x16x32_bf16 v[168:171], v[120:123], v[144:147], v[168:171]
    ds_read_b128 v[116:119], v31 offset:49152
    ds_read_b128 v[120:123], v31 offset:53248
    ds_read_b64_tr_b16 v[140:141], v24 offset:16384
    ds_read_b64_tr_b16 v[142:143], v24 offset:18432
    ds_read_b64_tr_b16 v[144:145], v26 offset:16384
    ds_read_b64_tr_b16 v[146:147], v26 offset:18432
    s_waitcnt lgkmcnt(12)
    v_mfma_f32_16x16x32_bf16 v[156:159], v[124:127], v[148:151], v[156:159]
    v_mfma_f32_16x16x32_bf16 v[160:163], v[128:131], v[148:151], v[160:163]
    v_mfma_f32_16x16x32_bf16 v[68:71], v[8:11], v[148:151], v[68:71]
    v_mfma_f32_16x16x32_bf16 v[164:167], v[124:127], v[152:155], v[164:167]
    v_mfma_f32_16x16x32_bf16 v[168:171], v[128:131], v[152:155], v[168:171]
    s_waitcnt vmcnt(5)
    s_barrier
    s_cmp_lg_u32 s36, 0
    s_cbranch_scc1 P1_S37
    s_waitcnt lgkmcnt(12)
    v_mfma_f32_16x16x32_bf16 v[172:175], v[92:95], v[8:11], v[172:175]
    v_mfma_f32_16x16x32_bf16 v[176:179], v[92:95], v[92:95], v[176:179]
    v_mfma_f32_16x16x32_bf16 v[172:175], v[96:99], v[8:11], v[172:175]
    v_mfma_f32_16x16x32_bf16 v[176:179], v[96:99], v[96:99], v[176:179]
    v_mfma_f32_16x16x32_bf16 v[172:175], v[100:103], v[8:11], v[172:175]
    v_mfma_f32_16x16x32_bf16 v[176:179], v[100:103], v[100:103], v[176:179]
    v_mfma_f32_16x16x32_bf16 v[172:175], v[104:107], v[8:11], v[172:175]
    v_mfma_f32_16x16x32_bf16 v[176:179], v[104:107], v[104:107], v[176:179]
P1_S37:
    s_cmp_lg_u32 s22, 7
    s_cbranch_scc1 P1_S38
    s_mov_b32 s25, 0
KF_NL33:
    v_readfirstlane_b32 s26, v250
    s_cmp_lg_u32 s26, 0
    s_cbranch_scc1 KF_NG33
    s_mov_b32 s60, s100
    s_and_b32 s61, s101, 0xffff
    s_mov_b32 s62, 0x00000100
    s_mov_b32 s63, 0x00020000
    v_mov_b32 v251, 0
    buffer_load_dword v250, v251, s[60:63], 0 offen sc1
    s_waitcnt vmcnt(0)
    s_add_u32 s25, s25, 1
    s_cmp_lt_u32 s25, 0x40000
    s_cbranch_scc1 KF_NL33
KF_NG33:
    ds_write_b32 v251, v250 offset:32
P1_S38:
    ds_read_b128 v[124:127], v32 offset:49152
    ds_read_b128 v[128:131], v32 offset:53248
    ds_read_b64_tr_b16 v[148:149], v24 offset:24576
    ds_read_b64_tr_b16 v[150:151], v24 offset:26624
    ds_read_b64_tr_b16 v[152:153], v26 offset:24576
    ds_read_b64_tr_b16 v[154:155], v26 offset:26624
    s_waitcnt lgkmcnt(12)
    v_mfma_f32_16x16x32_bf16 v[156:159], v[108:111], v[132:135], v[156:159]
    s_add_u32 s25, s40, 573440
    s_add_u32 m0, s41, 81920
    s_nop 0
    buffer_load_dwordx4 v34, s[32:35], s25 offen lds
    s_add_u32 s25, s40, 688128
    s_add_u32 m0, s41, 0
    s_nop 0
    buffer_load_dwordx4 v34, s[32:35], s25 offen lds
    v_and_b32 v92, 3, v2
    v_mfma_f32_16x16x32_bf16 v[160:163], v[112:115], v[132:135], v[160:163]
    v_mov_b32 v76, v172
    v_mov_b32 v77, v176
    v_cmp_eq_u32 vcc, 1, v92
    s_nop 1
    v_cndmask_b32 v76, v76, v173, vcc
    v_cndmask_b32 v77, v77, v177, vcc
    v_mfma_f32_16x16x32_bf16 v[68:71], v[8:11], v[132:135], v[68:71]
    v_cmp_eq_u32 vcc, 2, v92
    s_nop 1
    v_cndmask_b32 v76, v76, v174, vcc
    v_cndmask_b32 v77, v77, v178, vcc
    v_cmp_eq_u32 vcc, 3, v92
    s_nop 1
    v_cndmask_b32 v76, v76, v175, vcc
    v_cndmask_b32 v77, v77, v179, vcc
    v_mul_f32 v76, 0x3b000000, v76
    v_mfma_f32_16x16x32_bf16 v[164:167], v[108:111], v[136:139], v[164:167]
    v_mul_f32 v77, 0x3b000000, v77
    v_fma_f32 v77, -v76, v76, v77
    v_max_f32 v77, 0, v77
    v_mfma_f32_16x16x32_bf16 v[168:171], v[112:115], v[136:139], v[168:171]
    v_cvt_pk_bf16_f32 v92, v76, v77
    v_lshlrev_b32 v78, 16, v92
    v_xor_b32 v78, 0x80000000, v78
    ds_read_b128 v[108:111], v33 offset:49152
    ds_read_b128 v[112:115], v33 offset:53248
    ds_read_b64_tr_b16 v[132:133], v24 offset:32768
    ds_read_b64_tr_b16 v[134:135], v24 offset:34816
    ds_read_b64_tr_b16 v[136:137], v26 offset:32768
    ds_read_b64_tr_b16 v[138:139], v26 offset:34816
    s_waitcnt lgkmcnt(12)
    v_mfma_f32_16x16x32_bf16 v[156:159], v[116:119], v[140:143], v[156:159]
    v_and_b32 v92, 0xffff0000, v92
    v_add_f32 v92, 0x3727c5ac, v92
    v_cvt_pk_bf16_f32 v92, v92, v92
    v_mfma_f32_16x16x32_bf16 v[160:163], v[120:123], v[140:143], v[160:163]
    v_and_b32 v92, 0xffff0000, v92
    v_sqrt_f32 v92, v92
    s_nop 0
    v_cvt_pk_bf16_f32 v92, v92, v92
    v_mfma_f32_16x16x32_bf16 v[68:71], v[8:11], v[140:143], v[68:71]
    v_and_b32 v92, 0xffff0000, v92
    v_rcp_f32 v79, v92
    v_lshlrev_b32 v18, 2, v2
    v_mfma_f32_16x16x32_bf16 v[164:167], v[116:119], v[144:147], v[164:167]
    v_lshl_add_u32 v18, s37, 6, v18
    v_add_u32 v18, 161536, v18
    s_cmp_lg_u32 s36, 0
    s_cbranch_scc1 P1_S39
    s_mov_b32 exec_lo, 0x00f0000f
    s_mov_b32 exec_hi, 0xf0000f00
    ds_write_b32 v18, v78
    ds_write_b32 v18, v79 offset:256
    s_mov_b64 exec, -1
P1_S39:
    v_mfma_f32_16x16x32_bf16 v[168:171], v[120:123], v[144:147], v[168:171]
    s_waitcnt vmcnt(5)
    s_waitcnt lgkmcnt(0)
    s_barrier
    s_xor_b32 s23, s36, 0
    s_add_u32 s23, s23, s48
    v_xor_b32 v16, s23, v29
    v_lshl_add_u32 v24, v16, 5, v28
    v_add_u32 v25, 0x10000, v24
    s_xor_b32 s23, s36, 1
    s_add_u32 s23, s23, s48
    v_xor_b32 v16, s23, v29
    v_lshl_add_u32 v26, v16, 5, v28
    v_add_u32 v27, 0x10000, v26
    ds_read_b128 v[116:119], v30 offset:0
    ds_read_b128 v[120:123], v30 offset:4096
    ds_read_b64_tr_b16 v[140:141], v24 offset:40960
    ds_read_b64_tr_b16 v[142:143], v24 offset:43008
    ds_read_b64_tr_b16 v[144:145], v26 offset:40960
    ds_read_b64_tr_b16 v[146:147], v26 offset:43008
    s_waitcnt lgkmcnt(12)
    v_mfma_f32_16x16x32_bf16 v[156:159], v[124:127], v[148:151], v[156:159]
    s_add_u32 s25, s40, 802816
    s_add_u32 m0, s41, 8192
    s_nop 0
    buffer_load_dwordx4 v34, s[32:35], s25 offen lds
    v_mfma_f32_16x16x32_bf16 v[160:163], v[128:131], v[148:151], v[160:163]
    s_add_u32 s25, s40, 917504
    s_add_u32 m0, s41, 16384
    s_nop 0
    buffer_load_dwordx4 v34, s[32:35], s25 offen lds
    v_mfma_f32_16x16x32_bf16 v[68:71], v[8:11], v[148:151], v[68:71]
    v_lshlrev_b32 v18, 4, v3
    v_mfma_f32_16x16x32_bf16 v[164:167], v[124:127], v[152:155], v[164:167]
    v_lshl_add_u32 v18, s36, 7, v18
    v_mfma_f32_16x16x32_bf16 v[168:171], v[128:131], v[152:155], v[168:171]
    v_add_u32 v18, 161536, v18
    ds_read_b128 v[124:127], v31 offset:0
    ds_read_b128 v[128:131], v31 offset:4096
    ds_read_b64_tr_b16 v[148:149], v24 offset:49152
    ds_read_b64_tr_b16 v[150:151], v24 offset:51200
    ds_read_b64_tr_b16 v[152:153], v26 offset:49152
    ds_read_b64_tr_b16 v[154:155], v26 offset:51200
    s_waitcnt lgkmcnt(12)
    v_mfma_f32_16x16x32_bf16 v[156:159], v[108:111], v[132:135], v[156:159]
    ds_read_b128 v[76:79], v18 offset:0
    v_mfma_f32_16x16x32_bf16 v[160:163], v[112:115], v[132:135], v[160:163]
    ds_read_b128 v[84:87], v18 offset:256
    v_mfma_f32_16x16x32_bf16 v[68:71], v[8:11], v[132:135], v[68:71]
    ds_read_b128 v[80:83], v18 offset:64
    v_mfma_f32_16x16x32_bf16 v[164:167], v[108:111], v[136:139], v[164:167]
    ds_read_b128 v[88:91], v18 offset:320
    v_mfma_f32_16x16x32_bf16 v[168:171], v[112:115], v[136:139], v[168:171]
    s_xor_b32 s23, s36, 0
    s_add_u32 s23, s23, s47
    s_lshl_b32 s23, s23, 6
    s_add_u32 s23, s23, 162048
    v_lshl_add_u32 v19, v2, 2, s23
    ds_write_b32 v19, v68
    s_xor_b32 s23, s36, 1
    s_add_u32 s23, s23, s47
    s_lshl_b32 s23, s23, 6
    s_add_u32 s23, s23, 162048
    v_lshl_add_u32 v19, v2, 2, s23
    s_waitcnt lgkmcnt(0)
    s_barrier
    ds_read_b32 v72, v19
    s_waitcnt lgkmcnt(0)
    v_pk_fma_f32 v[156:157], v[76:77], v[68:69], v[156:157] op_sel_hi:[1,0,1]
    v_pk_fma_f32 v[158:159], v[78:79], v[68:69], v[158:159] op_sel_hi:[1,0,1]
    v_pk_fma_f32 v[160:161], v[80:81], v[68:69], v[160:161] op_sel_hi:[1,0,1]
    v_pk_fma_f32 v[162:163], v[82:83], v[68:69], v[162:163] op_sel_hi:[1,0,1]
    v_pk_fma_f32 v[164:165], v[76:77], v[72:73], v[164:165] op_sel_hi:[1,0,1]
    v_pk_fma_f32 v[166:167], v[78:79], v[72:73], v[166:167] op_sel_hi:[1,0,1]
    v_pk_fma_f32 v[168:169], v[80:81], v[72:73], v[168:169] op_sel_hi:[1,0,1]
    v_pk_fma_f32 v[170:171], v[82:83], v[72:73], v[170:171] op_sel_hi:[1,0,1]
    s_add_u32 s25, s40, 1032192
    s_add_u32 m0, s41, 24576
    s_nop 0
    buffer_load_dwordx4 v34, s[32:35], s25 offen lds
    v_pk_mul_f32 v[156:157], v[156:157], v[84:85]
    v_pk_mul_f32 v[158:159], v[158:159], v[86:87]
    v_pk_mul_f32 v[160:161], v[160:161], v[88:89]
    v_pk_mul_f32 v[162:163], v[162:163], v[90:91]
    v_pk_mul_f32 v[164:165], v[164:165], v[84:85]
    v_pk_mul_f32 v[166:167], v[166:167], v[86:87]
    v_pk_mul_f32 v[168:169], v[168:169], v[88:89]
    v_pk_mul_f32 v[170:171], v[170:171], v[90:91]
    s_add_u32 s25, s40, 1146880
    s_add_u32 m0, s41, 32768
    s_nop 0
    buffer_load_dwordx4 v34, s[32:35], s25 offen lds
    v_pk_mul_f32 v[76:77], v[156:157], v[156:157]
    v_pk_mul_f32 v[78:79], v[158:159], v[158:159]
    v_pk_mul_f32 v[80:81], v[160:161], v[160:161]
    v_pk_mul_f32 v[82:83], v[162:163], v[162:163]
    v_pk_mul_f32 v[84:85], v[164:165], v[164:165]
    v_pk_mul_f32 v[86:87], v[166:167], v[166:167]
    v_pk_mul_f32 v[88:89], v[168:169], v[168:169]
    v_pk_mul_f32 v[90:91], v[170:171], v[170:171]
    s_add_u32 s25, s40, 1261568
    buffer_load_dwordx4 v[180:183], v34, s[32:35], s25 offen
    v_pk_fma_f32 v[76:77], v[76:77], s[54:55], v[12:13]
    v_pk_fma_f32 v[78:79], v[78:79], s[54:55], v[12:13]
    v_pk_fma_f32 v[80:81], v[80:81], s[54:55], v[12:13]
    v_pk_fma_f32 v[82:83], v[82:83], s[54:55], v[12:13]
    v_pk_fma_f32 v[84:85], v[84:85], s[54:55], v[12:13]
    v_pk_fma_f32 v[86:87], v[86:87], s[54:55], v[12:13]
    v_pk_fma_f32 v[88:89], v[88:89], s[54:55], v[12:13]
    v_pk_fma_f32 v[90:91], v[90:91], s[54:55], v[12:13]
    s_add_u32 s25, s40, 1376256
    buffer_load_dwordx4 v[184:187], v34, s[32:35], s25 offen
    v_pk_mul_f32 v[76:77], v[76:77], v[156:157]
    v_pk_mul_f32 v[78:79], v[78:79], v[158:159]
    v_pk_mul_f32 v[80:81], v[80:81], v[160:161]
    v_pk_mul_f32 v[82:83], v[82:83], v[162:163]
    v_pk_mul_f32 v[84:85], v[84:85], v[164:165]
    v_pk_mul_f32 v[86:87], v[86:87], v[166:167]
    v_pk_mul_f32 v[88:89], v[88:89], v[168:169]
    v_pk_mul_f32 v[90:91], v[90:91], v[170:171]
    s_add_u32 s25, s40, 1490944
    buffer_load_dwordx4 v[188:191], v34, s[32:35], s25 offen
    v_exp_f32 v76, v76
    v_exp_f32 v77, v77
    v_exp_f32 v78, v78
    v_exp_f32 v79, v79
    v_exp_f32 v80, v80
    v_exp_f32 v81, v81
    v_exp_f32 v82, v82
    v_exp_f32 v83, v83
    s_add_u32 s25, s40, 1605632
    buffer_load_dwordx4 v[192:195], v34, s[32:35], s25 offen
    v_exp_f32 v84, v84
    v_exp_f32 v85, v85
    v_exp_f32 v86, v86
    v_exp_f32 v87, v87
    v_exp_f32 v88, v88
    v_exp_f32 v89, v89
    v_exp_f32 v90, v90
    v_exp_f32 v91, v91
    s_add_u32 s25, s40, 1720320
    buffer_load_dwordx4 v[196:199], v34, s[32:35], s25 offen
    v_pk_add_f32 v[76:77], v[76:77], v[14:15]
    v_pk_add_f32 v[78:79], v[78:79], v[14:15]
    v_pk_add_f32 v[80:81], v[80:81], v[14:15]
    v_pk_add_f32 v[82:83], v[82:83], v[14:15]
    v_pk_add_f32 v[84:85], v[84:85], v[14:15]
    v_pk_add_f32 v[86:87], v[86:87], v[14:15]
    v_pk_add_f32 v[88:89], v[88:89], v[14:15]
    v_pk_add_f32 v[90:91], v[90:91], v[14:15]
    v_rcp_f32 v76, v76
    v_rcp_f32 v77, v77
    v_rcp_f32 v78, v78
    v_rcp_f32 v79, v79
    v_rcp_f32 v80, v80
    v_rcp_f32 v81, v81
    v_rcp_f32 v82, v82
    v_rcp_f32 v83, v83
    v_rcp_f32 v84, v84
    v_rcp_f32 v85, v85
    v_rcp_f32 v86, v86
    v_rcp_f32 v87, v87
    v_rcp_f32 v88, v88
    v_rcp_f32 v89, v89
    v_rcp_f32 v90, v90
    v_rcp_f32 v91, v91
    v_pk_mul_f32 v[156:157], v[156:157], v[76:77]
    v_pk_mul_f32 v[158:159], v[158:159], v[78:79]
    v_pk_mul_f32 v[160:161], v[160:161], v[80:81]
    v_pk_mul_f32 v[162:163], v[162:163], v[82:83]
    v_pk_mul_f32 v[164:165], v[164:165], v[84:85]
    v_pk_mul_f32 v[166:167], v[166:167], v[86:87]
    v_pk_mul_f32 v[168:169], v[168:169], v[88:89]
    v_pk_mul_f32 v[170:171], v[170:171], v[90:91]
    v_cvt_pk_bf16_f32 v172, v156, v164
    v_cvt_pk_bf16_f32 v173, v157, v165
    v_cvt_pk_bf16_f32 v174, v158, v166
    v_cvt_pk_bf16_f32 v175, v159, v167
    v_cvt_pk_bf16_f32 v176, v160, v168
    v_cvt_pk_bf16_f32 v177, v161, v169
    v_cvt_pk_bf16_f32 v178, v162, v170
    v_cvt_pk_bf16_f32 v179, v163, v171
    v_pk_mul_f32 v[80:81], v[156:157], v[156:157]
    v_pk_add_f32 v[76:77], v[156:157], v[164:165]
    v_pk_fma_f32 v[80:81], v[164:165], v[164:165], v[80:81]
    v_pk_mul_f32 v[82:83], v[158:159], v[158:159]
    v_pk_add_f32 v[78:79], v[158:159], v[166:167]
    v_pk_fma_f32 v[82:83], v[166:167], v[166:167], v[82:83]
    v_pk_mul_f32 v[88:89], v[160:161], v[160:161]
    v_pk_add_f32 v[84:85], v[160:161], v[168:169]
    v_pk_fma_f32 v[88:89], v[168:169], v[168:169], v[88:89]
    v_pk_mul_f32 v[90:91], v[162:163], v[162:163]
    v_pk_add_f32 v[86:87], v[162:163], v[170:171]
    v_pk_fma_f32 v[90:91], v[170:171], v[170:171], v[90:91]
    v_add_f32_dpp v156, v76, v76 row_ror:8 row_mask:0xf bank_mask:0x3
    v_add_f32_dpp v157, v77, v77 row_ror:8 row_mask:0xf bank_mask:0x3
    v_add_f32_dpp v158, v78, v78 row_ror:8 row_mask:0xf bank_mask:0x3
    v_add_f32_dpp v159, v79, v79 row_ror:8 row_mask:0xf bank_mask:0x3
    v_add_f32_dpp v160, v80, v80 row_ror:8 row_mask:0xf bank_mask:0x3
    v_add_f32_dpp v161, v81, v81 row_ror:8 row_mask:0xf bank_mask:0x3
    v_add_f32_dpp v162, v82, v82 row_ror:8 row_mask:0xf bank_mask:0x3
    v_add_f32_dpp v163, v83, v83 row_ror:8 row_mask:0xf bank_mask:0x3
    v_add_f32_dpp v156, v84, v84 row_ror:8 row_mask:0xf bank_mask:0xc
    v_add_f32_dpp v157, v85, v85 row_ror:8 row_mask:0xf bank_mask:0xc
    v_add_f32_dpp v158, v86, v86 row_ror:8 row_mask:0xf bank_mask:0xc
    v_add_f32_dpp v159, v87, v87 row_ror:8 row_mask:0xf bank_mask:0xc
    v_add_f32_dpp v160, v88, v88 row_ror:8 row_mask:0xf bank_mask:0xc
    v_add_f32_dpp v161, v89, v89 row_ror:8 row_mask:0xf bank_mask:0xc
    v_add_f32_dpp v162, v90, v90 row_ror:8 row_mask:0xf bank_mask:0xc
    v_add_f32_dpp v163, v91, v91 row_ror:8 row_mask:0xf bank_mask:0xc
    v_add_f32_dpp v164, v156, v156 row_half_mirror row_mask:0xf bank_mask:0x5
    v_add_f32_dpp v165, v157, v157 row_half_mirror row_mask:0xf bank_mask:0x5
    v_add_f32_dpp v166, v158, v158 row_half_mirror row_mask:0xf bank_mask:0x5
    v_add_f32_dpp v167, v159, v159 row_half_mirror row_mask:0xf bank_mask:0x5
    v_add_f32_dpp v164, v160, v160 row_half_mirror row_mask:0xf bank_mask:0xa
    v_add_f32_dpp v165, v161, v161 row_half_mirror row_mask:0xf bank_mask:0xa
    v_add_f32_dpp v166, v162, v162 row_half_mirror row_mask:0xf bank_mask:0xa
    v_add_f32_dpp v167, v163, v163 row_half_mirror row_mask:0xf bank_mask:0xa
    v_add_f32_dpp v164, v164, v164 quad_perm:[1,0,3,2] row_mask:0xf bank_mask:0xf
    v_add_f32_dpp v165, v165, v165 quad_perm:[1,0,3,2] row_mask:0xf bank_mask:0xf
    v_add_f32_dpp v166, v166, v166 quad_perm:[1,0,3,2] row_mask:0xf bank_mask:0xf
    v_add_f32_dpp v167, v167, v167 quad_perm:[1,0,3,2] row_mask:0xf bank_mask:0xf
    v_add_f32_dpp v164, v164, v164 quad_perm:[2,3,0,1] row_mask:0xf bank_mask:0xf
    v_add_f32_dpp v165, v165, v165 quad_perm:[2,3,0,1] row_mask:0xf bank_mask:0xf
    v_add_f32_dpp v166, v166, v166 quad_perm:[2,3,0,1] row_mask:0xf bank_mask:0xf
    v_add_f32_dpp v167, v167, v167 quad_perm:[2,3,0,1] row_mask:0xf bank_mask:0xf
    v_lshrrev_b32 v18, 2, v2
    v_lshlrev_b32 v18, 6, v18
    v_lshl_add_u32 v18, v3, 4, v18
    v_lshl_add_u32 v18, s22, 8, v18
    ds_write_b128 v18, v[164:167] offset:64
    s_waitcnt vmcnt(12)
    s_waitcnt lgkmcnt(0)
    s_barrier
    s_cmp_lg_u32 s22, 7
    s_cbranch_scc1 P1_S40
    ds_read2_b32 v[92:93], v49 offset0:16 offset1:32
    ds_read2_b32 v[94:95], v49 offset0:80 offset1:96
    ds_read2_b32 v[96:97], v49 offset0:144 offset1:160
    ds_read2_b32 v[98:99], v49 offset0:208 offset1:224
    s_lshl_b32 s24, s21, 10
    s_add_u32 s24, s24, s52
    v_mov_b32 v101, v250
    v_mov_b32 v103, v250
    s_waitcnt lgkmcnt(0)
    v_add_f32 v92, v92, v94
    v_add_f32 v93, v93, v95
    v_add_f32 v96, v96, v98
    v_add_f32 v97, v97, v99
    v_add_f32 v100, v92, v96
    v_add_f32 v102, v93, v97
    buffer_store_dwordx4 v[100:103], v23, s[12:15], s24 offen sc1
P1_S40:
    ds_read_b128 v[108:111], v32 offset:0
    ds_read_b128 v[112:115], v32 offset:4096
    ds_read_b64_tr_b16 v[132:133], v24 offset:57344
    ds_read_b64_tr_b16 v[134:135], v24 offset:59392
    ds_read_b64_tr_b16 v[136:137], v26 offset:57344
    ds_read_b64_tr_b16 v[138:139], v26 offset:59392
    s_waitcnt lgkmcnt(12)
    v_mfma_f32_16x16x32_bf16 v[52:55], v[140:143], v[116:119], 0
    v_mov_b32 v251, 0
    v_mfma_f32_16x16x32_bf16 v[56:59], v[140:143], v[120:123], 0
    ds_read_b32 v250, v251 offset:32
    v_mfma_f32_16x16x32_bf16 v[68:71], v[8:11], v[140:143], 0
    ds_read_b64_tr_b16 v[100:101], v44
    v_mfma_f32_16x16x32_bf16 v[60:63], v[144:147], v[116:119], 0
    ds_read_b64_tr_b16 v[102:103], v45
    v_mfma_f32_16x16x32_bf16 v[64:67], v[144:147], v[120:123], 0
    ds_read_b128 v[76:79], v48 offset:0
    ds_read_b128 v[116:119], v33 offset:0
    ds_read_b128 v[120:123], v33 offset:4096
    ds_read_b64_tr_b16 v[140:141], v25 offset:0
    ds_read_b64_tr_b16 v[142:143], v25 offset:2048
    ds_read_b64_tr_b16 v[144:145], v27 offset:0
    ds_read_b64_tr_b16 v[146:147], v27 offset:2048
    s_waitcnt lgkmcnt(12)
    v_mfma_f32_16x16x32_bf16 v[52:55], v[148:151], v[124:127], v[52:55]
    ds_read_b128 v[84:87], v48 offset:256
    v_mfma_f32_16x16x32_bf16 v[56:59], v[148:151], v[128:131], v[56:59]
    ds_read_b128 v[80:83], v48 offset:16
    v_mfma_f32_16x16x32_bf16 v[68:71], v[8:11], v[148:151], v[68:71]
    ds_read_b128 v[88:91], v48 offset:272
    v_mfma_f32_16x16x32_bf16 v[60:63], v[152:155], v[124:127], v[60:63]
    v_mfma_f32_16x16x32_bf16 v[64:67], v[152:155], v[128:131], v[64:67]
    s_waitcnt vmcnt(0)
    v_lshlrev_b32 v16, 7, v1
    s_lshl_b32 s23, s2, 15
    s_lshl_b32 s24, s22, 12
    s_add_u32 s23, s23, s24
    s_mov_b32 exec_hi, 0
    buffer_load_dword v43, v16, s[16:19], s23 offen
    s_mov_b32 exec_hi, -1
    s_mul_i32 s23, s2, 3584
    s_min_u32 s24, s22, 6
    s_lshl_b32 s24, s24, 9
    s_add_u32 s23, s23, s24
    s_mov_b32 s60, s6
    s_and_b32 s61, s7, 0xffff
    s_mov_b32 s62, 0x000e0000
    s_mov_b32 s63, 0x00020000
    s_mov_b64 exec, 15
    buffer_load_dword v43, v16, s[60:63], s23 offen
    s_mov_b64 exec, -1
    s_barrier
    ds_read_b128 v[124:127], v30 offset:16384
    ds_read_b128 v[128:131], v30 offset:20480
    ds_read_b64_tr_b16 v[148:149], v25 offset:8192
    ds_read_b64_tr_b16 v[150:151], v25 offset:10240
    ds_read_b64_tr_b16 v[152:153], v27 offset:8192
    ds_read_b64_tr_b16 v[154:155], v27 offset:10240
    s_waitcnt lgkmcnt(12)
    v_mfma_f32_16x16x32_bf16 v[52:55], v[132:135], v[108:111], v[52:55]
    ds_write_b128 v37, v[180:183] offset:40960
    v_mfma_f32_16x16x32_bf16 v[56:59], v[132:135], v[112:115], v[56:59]
    ds_write_b128 v37, v[184:187] offset:49152
    v_mfma_f32_16x16x32_bf16 v[68:71], v[8:11], v[132:135], v[68:71]
    v_mfma_f32_16x16x32_bf16 v[60:63], v[136:139], v[108:111], v[60:63]
    v_mfma_f32_16x16x32_bf16 v[64:67], v[136:139], v[112:115], v[64:67]
    ds_read_b128 v[108:111], v31 offset:16384
    ds_read_b128 v[112:115], v31 offset:20480
    ds_read_b64_tr_b16 v[132:133], v25 offset:16384
    ds_read_b64_tr_b16 v[134:135], v25 offset:18432
    ds_read_b64_tr_b16 v[136:137], v27 offset:16384
    ds_read_b64_tr_b16 v[138:139], v27 offset:18432
    s_waitcnt lgkmcnt(12)
    v_mfma_f32_16x16x32_bf16 v[52:55], v[140:143], v[116:119], v[52:55]
    v_mfma_f32_16x16x32_bf16 v[56:59], v[140:143], v[120:123], v[56:59]
    v_mfma_f32_16x16x32_bf16 v[68:71], v[8:11], v[140:143], v[68:71]
    v_mfma_f32_16x16x32_bf16 v[60:63], v[144:147], v[116:119], v[60:63]
    v_mfma_f32_16x16x32_bf16 v[64:67], v[144:147], v[120:123], v[64:67]
    s_barrier
    ds_read_b128 v[116:119], v32 offset:16384
    ds_read_b128 v[120:123], v32 offset:20480
    ds_read_b64_tr_b16 v[140:141], v24 offset:0
    ds_read_b64_tr_b16 v[142:143], v24 offset:2048
    ds_read_b64_tr_b16 v[144:145], v26 offset:0
    ds_read_b64_tr_b16 v[146:147], v26 offset:2048
    s_waitcnt lgkmcnt(12)
    v_mfma_f32_16x16x32_bf16 v[52:55], v[148:151], v[124:127], v[52:55]
    ds_write_b128 v37, v[188:191] offset:57344
    v_mfma_f32_16x16x32_bf16 v[56:59], v[148:151], v[128:131], v[56:59]
    ds_write_b128 v38, v[192:195] offset:0
    v_mfma_f32_16x16x32_bf16 v[68:71], v[8:11], v[148:151], v[68:71]
    ds_bpermute_b32 v100, v46, v100
    v_mfma_f32_16x16x32_bf16 v[60:63], v[152:155], v[124:127], v[60:63]
    ds_bpermute_b32 v101, v46, v101
    v_mfma_f32_16x16x32_bf16 v[64:67], v[152:155], v[128:131], v[64:67]
    ds_bpermute_b32 v102, v46, v102
    ds_read_b128 v[124:127], v33 offset:16384
    ds_read_b128 v[128:131], v33 offset:20480
    ds_read_b64_tr_b16 v[148:149], v24 offset:8192
    ds_read_b64_tr_b16 v[150:151], v24 offset:10240
    ds_read_b64_tr_b16 v[152:153], v26 offset:8192
    ds_read_b64_tr_b16 v[154:155], v26 offset:10240
    s_waitcnt lgkmcnt(12)
    v_mfma_f32_16x16x32_bf16 v[52:55], v[132:135], v[108:111], v[52:55]
    ds_bpermute_b32 v103, v46, v103
    v_mfma_f32_16x16x32_bf16 v[56:59], v[132:135], v[112:115], v[56:59]
    v_mfma_f32_16x16x32_bf16 v[68:71], v[8:11], v[132:135], v[68:71]
    v_mfma_f32_16x16x32_bf16 v[60:63], v[136:139], v[108:111], v[60:63]
    v_mfma_f32_16x16x32_bf16 v[64:67], v[136:139], v[112:115], v[64:67]
    s_waitcnt lgkmcnt(0)
    s_barrier
    ds_read_b128 v[108:111], v30 offset:32768
    ds_read_b128 v[112:115], v30 offset:36864
    ds_read_b64_tr_b16 v[132:133], v24 offset:16384
    ds_read_b64_tr_b16 v[134:135], v24 offset:18432
    ds_read_b64_tr_b16 v[136:137], v26 offset:16384
    ds_read_b64_tr_b16 v[138:139], v26 offset:18432
    s_waitcnt lgkmcnt(12)
    v_mfma_f32_16x16x32_bf16 v[52:55], v[140:143], v[116:119], v[52:55]
    ds_write_b128 v38, v[196:199] offset:8192
    v_lshlrev_b32 v92, 16, v100
    v_and_b32 v93, 0xffff0000, v100
    v_mfma_f32_16x16x32_bf16 v[56:59], v[140:143], v[120:123], v[56:59]
    v_lshlrev_b32 v94, 16, v101
    v_and_b32 v95, 0xffff0000, v101
    v_lshlrev_b32 v96, 16, v102
    v_mfma_f32_16x16x32_bf16 v[68:71], v[8:11], v[140:143], v[68:71]
    v_and_b32 v97, 0xffff0000, v102
    v_lshlrev_b32 v98, 16, v103
    v_and_b32 v99, 0xffff0000, v103
    v_mfma_f32_16x16x32_bf16 v[60:63], v[144:147], v[116:119], v[60:63]
    v_add_f32 v92, v92, v76
    v_add_f32 v93, v93, v77
    v_add_f32 v94, v94, v78
    v_mfma_f32_16x16x32_bf16 v[64:67], v[144:147], v[120:123], v[64:67]
    v_add_f32 v95, v95, v79
    v_add_f32 v96, v96, v80
    v_add_f32 v97, v97, v81
    ds_read_b128 v[116:119], v31 offset:32768
    ds_read_b128 v[120:123], v31 offset:36864
    ds_read_b64_tr_b16 v[140:141], v24 offset:24576
    ds_read_b64_tr_b16 v[142:143], v24 offset:26624
    ds_read_b64_tr_b16 v[144:145], v26 offset:24576
    ds_read_b64_tr_b16 v[146:147], v26 offset:26624
    s_waitcnt lgkmcnt(12)
    v_mfma_f32_16x16x32_bf16 v[52:55], v[148:151], v[124:127], v[52:55]
    v_add_f32 v98, v98, v82
    v_add_f32 v99, v99, v83
    v_mul_f32 v92, v92, v84
    v_mfma_f32_16x16x32_bf16 v[56:59], v[148:151], v[128:131], v[56:59]
    v_mul_f32 v93, v93, v85
    v_mul_f32 v94, v94, v86
    v_mul_f32 v95, v95, v87
    v_mfma_f32_16x16x32_bf16 v[68:71], v[8:11], v[148:151], v[68:71]
    v_mul_f32 v96, v96, v88
    v_mul_f32 v97, v97, v89
    v_mul_f32 v98, v98, v90
    v_mfma_f32_16x16x32_bf16 v[60:63], v[152:155], v[124:127], v[60:63]
    v_mul_f32 v99, v99, v91
    v_mfma_f32_16x16x32_bf16 v[64:67], v[152:155], v[128:131], v[64:67]
    s_cmp_lg_u32 s22, 7
    s_cbranch_scc1 P1_S41
    buffer_load_dwordx4 v[208:211], v23, s[12:15], s52 offen offset:0 sc1
    buffer_load_dwordx4 v[212:215], v23, s[12:15], s52 offen offset:1024 sc1
    buffer_load_dwordx4 v[216:219], v23, s[12:15], s52 offen offset:2048 sc1
    buffer_load_dwordx4 v[220:223], v23, s[12:15], s52 offen offset:3072 sc1
    buffer_load_dwordx4 v[224:227], v23, s[12:15], s53 offen offset:0 sc1
    buffer_load_dwordx4 v[228:231], v23, s[12:15], s53 offen offset:1024 sc1
    buffer_load_dwordx4 v[232:235], v23, s[12:15], s53 offen offset:2048 sc1
    buffer_load_dwordx4 v[236:239], v23, s[12:15], s53 offen offset:3072 sc1
P1_S41:
    ds_read_b128 v[124:127], v32 offset:32768
    ds_read_b128 v[128:131], v32 offset:36864
    ds_read_b64_tr_b16 v[148:149], v24 offset:32768
    ds_read_b64_tr_b16 v[150:151], v24 offset:34816
    ds_read_b64_tr_b16 v[152:153], v26 offset:32768
    ds_read_b64_tr_b16 v[154:155], v26 offset:34816
    s_waitcnt lgkmcnt(12)
    v_mfma_f32_16x16x32_bf16 v[52:55], v[132:135], v[108:111], v[52:55]
    v_cvt_pk_bf16_f32 v100, v92, v93
    v_mfma_f32_16x16x32_bf16 v[56:59], v[132:135], v[112:115], v[56:59]
    v_cvt_pk_bf16_f32 v101, v94, v95
    v_mfma_f32_16x16x32_bf16 v[68:71], v[8:11], v[132:135], v[68:71]
    v_cvt_pk_bf16_f32 v102, v96, v97
    v_mfma_f32_16x16x32_bf16 v[60:63], v[136:139], v[108:111], v[60:63]
    v_cvt_pk_bf16_f32 v103, v98, v99
    v_mfma_f32_16x16x32_bf16 v[64:67], v[136:139], v[112:115], v[64:67]
    buffer_store_dwordx4 v[100:103], v47, s[12:15], s51 offen sc1
    ds_read_b128 v[108:111], v33 offset:32768
    ds_read_b128 v[112:115], v33 offset:36864
    ds_read_b64_tr_b16 v[132:133], v24 offset:40960
    ds_read_b64_tr_b16 v[134:135], v24 offset:43008
    ds_read_b64_tr_b16 v[136:137], v26 offset:40960
    ds_read_b64_tr_b16 v[138:139], v26 offset:43008
    s_waitcnt lgkmcnt(12)
    v_mfma_f32_16x16x32_bf16 v[52:55], v[140:143], v[116:119], v[52:55]
    v_mfma_f32_16x16x32_bf16 v[56:59], v[140:143], v[120:123], v[56:59]
    v_mfma_f32_16x16x32_bf16 v[68:71], v[8:11], v[140:143], v[68:71]
    v_mfma_f32_16x16x32_bf16 v[60:63], v[144:147], v[116:119], v[60:63]
    v_mfma_f32_16x16x32_bf16 v[64:67], v[144:147], v[120:123], v[64:67]
    ds_read_b128 v[116:119], v30 offset:49152
    ds_read_b128 v[120:123], v30 offset:53248
    ds_read_b64_tr_b16 v[140:141], v24 offset:49152
    ds_read_b64_tr_b16 v[142:143], v24 offset:51200
    ds_read_b64_tr_b16 v[144:145], v26 offset:49152
    ds_read_b64_tr_b16 v[146:147], v26 offset:51200
    s_waitcnt lgkmcnt(12)
    v_mfma_f32_16x16x32_bf16 v[52:55], v[148:151], v[124:127], v[52:55]
    v_mfma_f32_16x16x32_bf16 v[56:59], v[148:151], v[128:131], v[56:59]
    v_mfma_f32_16x16x32_bf16 v[68:71], v[8:11], v[148:151], v[68:71]
    v_mfma_f32_16x16x32_bf16 v[60:63], v[152:155], v[124:127], v[60:63]
    v_mfma_f32_16x16x32_bf16 v[64:67], v[152:155], v[128:131], v[64:67]
    ds_read_b128 v[124:127], v31 offset:49152
    ds_read_b128 v[128:131], v31 offset:53248
    ds_read_b64_tr_b16 v[148:149], v24 offset:57344
    ds_read_b64_tr_b16 v[150:151], v24 offset:59392
    ds_read_b64_tr_b16 v[152:153], v26 offset:57344
    ds_read_b64_tr_b16 v[154:155], v26 offset:59392
    s_waitcnt lgkmcnt(12)
    v_mfma_f32_16x16x32_bf16 v[52:55], v[132:135], v[108:111], v[52:55]
    v_mfma_f32_16x16x32_bf16 v[56:59], v[132:135], v[112:115], v[56:59]
    v_mfma_f32_16x16x32_bf16 v[68:71], v[8:11], v[132:135], v[68:71]
    v_mfma_f32_16x16x32_bf16 v[60:63], v[136:139], v[108:111], v[60:63]
    v_mfma_f32_16x16x32_bf16 v[64:67], v[136:139], v[112:115], v[64:67]
    s_cmp_lg_u32 s22, 7
    s_cbranch_scc1 P1_S42
    s_waitcnt vmcnt(0)
    s_mov_b32 s25, 0
P1_POLL22:
    v_xor_b32 v209, v250, v209
    v_xor_b32 v211, v250, v211
    v_xor_b32 v213, v250, v213
    v_xor_b32 v215, v250, v215
    v_xor_b32 v217, v250, v217
    v_xor_b32 v219, v250, v219
    v_xor_b32 v221, v250, v221
    v_xor_b32 v223, v250, v223
    v_xor_b32 v225, v250, v225
    v_xor_b32 v227, v250, v227
    v_xor_b32 v229, v250, v229
    v_xor_b32 v231, v250, v231
    v_xor_b32 v233, v250, v233
    v_xor_b32 v235, v250, v235
    v_xor_b32 v237, v250, v237
    v_xor_b32 v239, v250, v239
    v_or3_b32 v209, v209, v211, v213
    v_or3_b32 v209, v209, v215, v217
    v_or3_b32 v209, v209, v219, v221
    v_or3_b32 v209, v209, v223, v225
    v_or3_b32 v209, v209, v227, v229
    v_or3_b32 v209, v209, v231, v233
    v_or3_b32 v209, v209, v235, v237
    v_or3_b32 v209, v209, v239, v239
    v_cmp_ne_u32 vcc, 0, v209
    s_cmp_eq_u64 vcc, 0
    s_cbranch_scc1 P1_GO22
    buffer_load_dwordx4 v[208:211], v23, s[12:15], s52 offen offset:0 sc1
    buffer_load_dwordx4 v[212:215], v23, s[12:15], s52 offen offset:1024 sc1
    buffer_load_dwordx4 v[216:219], v23, s[12:15], s52 offen offset:2048 sc1
    buffer_load_dwordx4 v[220:223], v23, s[12:15], s52 offen offset:3072 sc1
    buffer_load_dwordx4 v[224:227], v23, s[12:15], s53 offen offset:0 sc1
    buffer_load_dwordx4 v[228:231], v23, s[12:15], s53 offen offset:1024 sc1
    buffer_load_dwordx4 v[232:235], v23, s[12:15], s53 offen offset:2048 sc1
    buffer_load_dwordx4 v[236:239], v23, s[12:15], s53 offen offset:3072 sc1
    s_waitcnt vmcnt(0)
    s_add_u32 s25, s25, 1
    s_cmp_lt_u32 s25, 0x20000
    s_cbranch_scc1 P1_POLL22
P1_GO22:
    v_add_f32 v208, v208, v224
    v_add_f32 v210, v210, v226
    v_add_f32 v212, v212, v228
    v_add_f32 v214, v214, v230
    v_add_f32 v216, v216, v232
    v_add_f32 v218, v218, v234
    v_add_f32 v220, v220, v236
    v_add_f32 v222, v222, v238
    v_add_f32 v208, v208, v216
    v_add_f32 v210, v210, v218
    v_add_f32 v212, v212, v220
    v_add_f32 v214, v214, v222
    v_add_f32 v208, v208, v212
    v_add_f32 v210, v210, v214
    v_mul_f32 v208, 0x3a924925, v208
    v_mul_f32 v210, 0x3a924925, v210
    v_fma_f32 v210, -v208, v208, v210
    v_max_f32 v210, 0, v210
    v_cvt_pk_bf16_f32 v214, v208, v210
    v_lshlrev_b32 v212, 16, v214
    v_xor_b32 v212, 0x80000000, v212
    v_and_b32 v214, 0xffff0000, v214
    v_add_f32 v214, 0x3727c5ac, v214
    v_cvt_pk_bf16_f32 v214, v214, v214
    v_and_b32 v214, 0xffff0000, v214
    v_sqrt_f32 v214, v214
    s_nop 0
    v_cvt_pk_bf16_f32 v214, v214, v214
    v_and_b32 v214, 0xffff0000, v214
    v_rcp_f32 v213, v214
    v_lshlrev_b32 v16, 2, v1
    ds_write_b32 v16, v212 offset:2112
    ds_write_b32 v16, v213 offset:2368
    s_waitcnt lgkmcnt(0)
P1_S42:
    s_barrier
    v_lshlrev_b32 v16, 4, v3
    v_lshl_add_u32 v16, s36, 7, v16
    ds_read_b128 v[208:211], v16 offset:2112
    ds_read_b128 v[216:219], v16 offset:2368
    ds_read_b128 v[212:215], v16 offset:2176
    ds_read_b128 v[220:223], v16 offset:2432
    s_add_u32 s23, s44, s42
    s_lshl_b32 s23, s23, 6
    s_lshl_b32 s24, s20, 1
    s_add_u32 s23, s23, s24
    s_add_u32 s23, s23, s36
    s_lshl_b32 s23, s23, 10
    s_add_u32 s23, s23, 5832704
    s_lshl_b32 s25, s36, 16
    s_add_u32 s24, s23, 65536
    s_sub_u32 s24, s24, s25
    s_add_u32 s23, s23, s25
    v_and_b32 v17, 1, v3
    v_lshlrev_b32 v17, 9, v17
    v_lshrrev_b32 v18, 1, v3
    v_lshl_add_u32 v17, v18, 8, v17
    v_lshl_add_u32 v17, v2, 4, v17
    v_lshlrev_b32 v156, 16, v172
    v_and_b32 v164, 0xffff0000, v172
    v_lshlrev_b32 v157, 16, v173
    v_and_b32 v165, 0xffff0000, v173
    v_lshlrev_b32 v158, 16, v174
    v_and_b32 v166, 0xffff0000, v174
    v_lshlrev_b32 v159, 16, v175
    v_and_b32 v167, 0xffff0000, v175
    v_lshlrev_b32 v160, 16, v176
    v_and_b32 v168, 0xffff0000, v176
    v_lshlrev_b32 v161, 16, v177
    v_and_b32 v169, 0xffff0000, v177
    v_lshlrev_b32 v162, 16, v178
    v_and_b32 v170, 0xffff0000, v178
    v_lshlrev_b32 v163, 16, v179
    v_and_b32 v171, 0xffff0000, v179
    s_waitcnt lgkmcnt(0)
    v_pk_add_f32 v[156:157], v[156:157], v[208:209]
    v_pk_add_f32 v[158:159], v[158:159], v[210:211]
    v_pk_add_f32 v[160:161], v[160:161], v[212:213]
    v_pk_add_f32 v[162:163], v[162:163], v[214:215]
    v_pk_mul_f32 v[156:157], v[156:157], v[216:217]
    v_pk_mul_f32 v[158:159], v[158:159], v[218:219]
    v_pk_mul_f32 v[160:161], v[160:161], v[220:221]
    v_pk_mul_f32 v[162:163], v[162:163], v[222:223]
    v_cvt_pk_bf16_f32 v224, v156, v157
    v_cvt_pk_bf16_f32 v225, v158, v159
    v_cvt_pk_bf16_f32 v226, v160, v161
    v_cvt_pk_bf16_f32 v227, v162, v163
    s_nop 0
    v_permlane16_swap_b32 v224, v226
    v_permlane16_swap_b32 v225, v227
    buffer_store_dwordx4 v[224:227], v17, s[12:15], s23 offen sc1
    v_pk_add_f32 v[164:165], v[164:165], v[208:209]
    v_pk_add_f32 v[166:167], v[166:167], v[210:211]
    v_pk_add_f32 v[168:169], v[168:169], v[212:213]
    v_pk_add_f32 v[170:171], v[170:171], v[214:215]
    v_pk_mul_f32 v[164:165], v[164:165], v[216:217]
    v_pk_mul_f32 v[166:167], v[166:167], v[218:219]
    v_pk_mul_f32 v[168:169], v[168:169], v[220:221]
    v_pk_mul_f32 v[170:171], v[170:171], v[222:223]
    v_cvt_pk_bf16_f32 v228, v164, v165
    v_cvt_pk_bf16_f32 v229, v166, v167
    v_cvt_pk_bf16_f32 v230, v168, v169
    v_cvt_pk_bf16_f32 v231, v170, v171
    s_nop 0
    v_permlane16_swap_b32 v228, v230
    v_permlane16_swap_b32 v229, v231
    buffer_store_dwordx4 v[228:231], v17, s[12:15], s24 offen sc1
    ds_read_b128 v[108:111], v32 offset:49152
    ds_read_b128 v[112:115], v32 offset:53248
    ds_read_b64_tr_b16 v[132:133], v25 offset:0
    ds_read_b64_tr_b16 v[134:135], v25 offset:2048
    ds_read_b64_tr_b16 v[136:137], v27 offset:0
    ds_read_b64_tr_b16 v[138:139], v27 offset:2048
    s_waitcnt lgkmcnt(12)
    v_mfma_f32_16x16x32_bf16 v[52:55], v[140:143], v[116:119], v[52:55]
    v_mfma_f32_16x16x32_bf16 v[56:59], v[140:143], v[120:123], v[56:59]
    v_mfma_f32_16x16x32_bf16 v[68:71], v[8:11], v[140:143], v[68:71]
    v_mfma_f32_16x16x32_bf16 v[60:63], v[144:147], v[116:119], v[60:63]
    v_mfma_f32_16x16x32_bf16 v[64:67], v[144:147], v[120:123], v[64:67]
    ds_read_b128 v[116:119], v33 offset:49152
    ds_read_b128 v[120:123], v33 offset:53248
    ds_read_b64_tr_b16 v[140:141], v25 offset:8192
    ds_read_b64_tr_b16 v[142:143], v25 offset:10240
    ds_read_b64_tr_b16 v[144:145], v27 offset:8192
    ds_read_b64_tr_b16 v[146:147], v27 offset:10240
    s_waitcnt lgkmcnt(12)
    v_mfma_f32_16x16x32_bf16 v[52:55], v[148:151], v[124:127], v[52:55]
    v_mfma_f32_16x16x32_bf16 v[56:59], v[148:151], v[128:131], v[56:59]
    v_mfma_f32_16x16x32_bf16 v[68:71], v[8:11], v[148:151], v[68:71]
    v_mfma_f32_16x16x32_bf16 v[60:63], v[152:155], v[124:127], v[60:63]
    v_mfma_f32_16x16x32_bf16 v[64:67], v[152:155], v[128:131], v[64:67]
    s_waitcnt lgkmcnt(6)
    v_mfma_f32_16x16x32_bf16 v[52:55], v[132:135], v[108:111], v[52:55]
    v_mfma_f32_16x16x32_bf16 v[56:59], v[132:135], v[112:115], v[56:59]
    v_mfma_f32_16x16x32_bf16 v[68:71], v[8:11], v[132:135], v[68:71]
    v_mfma_f32_16x16x32_bf16 v[60:63], v[136:139], v[108:111], v[60:63]
    v_mfma_f32_16x16x32_bf16 v[64:67], v[136:139], v[112:115], v[64:67]
    s_waitcnt lgkmcnt(0)
    v_mfma_f32_16x16x32_bf16 v[52:55], v[140:143], v[116:119], v[52:55]
    v_mfma_f32_16x16x32_bf16 v[56:59], v[140:143], v[120:123], v[56:59]
    v_mfma_f32_16x16x32_bf16 v[68:71], v[8:11], v[140:143], v[68:71]
    v_mfma_f32_16x16x32_bf16 v[60:63], v[144:147], v[116:119], v[60:63]
    v_mfma_f32_16x16x32_bf16 v[64:67], v[144:147], v[120:123], v[64:67]
    s_xor_b32 s23, s36, 0
    s_add_u32 s23, s23, s48
    s_lshl_b32 s23, s23, 6
    s_add_u32 s23, s23, 162560
    v_lshl_add_u32 v19, v2, 2, s23
    s_nop 0
    ds_write_b32 v19, v68
    s_xor_b32 s23, s36, 0
    s_add_u32 s23, s23, s48
    s_lshl_b32 s23, s23, 6
    s_add_u32 s23, s23, 162560
    v_lshl_add_u32 v19, v3, 4, s23
    s_xor_b32 s23, s36, 1
    s_add_u32 s23, s23, s48
    s_lshl_b32 s23, s23, 6
    s_add_u32 s23, s23, 162560
    v_lshl_add_u32 v20, v3, 4, s23
    s_waitcnt lgkmcnt(0)
    s_waitcnt vmcnt(0)
    s_barrier
    s_setprio 0
    ds_read_b128 v[68:71], v19
    ds_read_b128 v[72:75], v20
    s_cmp_lg_u32 s22, 0
    s_cbranch_scc1 KF_A34
    s_lshl_b32 s24, s20, 1
    s_and_b32 s25, s21, 1
    s_add_u32 s24, s24, s25
    s_lshl_b32 s24, s24, 2
    s_lshr_b32 s23, s21, 1
    s_lshl_b32 s23, s23, 8
    s_add_u32 s23, s23, s24
    s_add_u32 s23, s23, 15532032
    v_lshlrev_b32 v252, 10, v1
    s_mov_b64 exec, 0xf
    buffer_store_dword v250, v252, s[12:15], s23 offen sc1
    s_mov_b64 exec, -1
KF_A34:
    v_lshlrev_b32 v18, 2, v2
    v_lshl_add_u32 v18, s36, 7, v18
    v_add_u32 v18, 161536, v18
    ds_read_b32 v84, v18 offset:0
    ds_read_b32 v88, v18 offset:256
    ds_read_b32 v86, v18 offset:64
    ds_read_b32 v90, v18 offset:320
    s_lshl_b32 s23, s20, 2
    s_lshl_b32 s24, s36, 1
    s_add_u32 s23, s23, s24
    s_mul_i32 s23, s23, 56
    s_add_u32 s23, s23, s45
    s_add_u32 s23, s23, s43
    s_lshl_b32 s23, s23, 9
    s_add_u32 s46, s23, 2162688
    s_add_u32 s47, s46, 28672
    v_lshl_add_u32 v21, s36, 9, v22
    v_xor_b32 v23, 0x200, v21
    s_cmp_ge_u32 s22, 4
    s_cbranch_scc1 KF_WV35
    s_mul_i32 s28, s21, 458752
    s_lshl_b32 s23, s22, 14
    s_add_u32 s28, s28, s23
    s_add_u32 s28, s28, 5832704
    s_add_u32 s29, s28, 65536
    s_add_u32 s30, s28, 131072
    s_add_u32 s31, s28, 196608
    s_add_u32 s32, s28, 262144
    s_add_u32 s33, s28, 327680
    s_add_u32 s34, s28, 393216
    s_lshl_b32 s23, s20, 18
    s_lshl_b32 s24, s22, 10
    s_add_u32 s23, s23, s24
    s_xor_b32 s24, s22, 0
    s_lshl_b32 s24, s24, 16
    s_add_u32 s36, s23, s24
    s_xor_b32 s24, s22, 1
    s_lshl_b32 s24, s24, 16
    s_add_u32 s37, s23, s24
    s_xor_b32 s24, s22, 2
    s_lshl_b32 s24, s24, 16
    s_add_u32 s38, s23, s24
    s_xor_b32 s24, s22, 3
    s_lshl_b32 s24, s24, 16
    s_add_u32 s39, s23, s24
    s_mul_i32 s40, s22, 24576
    s_add_u32 s40, s40, 63232
    v_lshlrev_b32 v7, 4, v1
    v_and_b32 v124, 7, v1
    v_lshrrev_b32 v125, 3, v1
    v_xor_b32 v126, v124, v3
    v_lshlrev_b32 v8, 12, v125
    v_lshl_add_u32 v8, v126, 4, v8
    v_xor_b32 v240, 64, v8
    v_add_u32 v240, 0x8000, v240
    v_lshrrev_b32 v124, 1, v2
    v_xor_b32 v124, v124, v3
    v_lshlrev_b32 v9, 7, v2
    v_lshl_add_u32 v9, v124, 4, v9
    v_add_u32 v9, s40, v9
    v_xor_b32 v241, 64, v9
    s_and_b32 s41, s20, 7
    s_lshl_b32 s41, s41, 1
    s_mov_b32 s41, 0
    s_add_u32 s23, s41, 0
    s_and_b32 s23, s23, 15
    s_lshl_b32 s23, s23, 6
    s_add_u32 s23, s23, s36
    s_add_u32 m0, s40, 0
    s_nop 0
    buffer_load_dwordx4 v8, s[16:19], s23 offen lds
    s_add_u32 s23, s41, 0
    s_and_b32 s23, s23, 15
    s_lshl_b32 s23, s23, 6
    s_add_u32 s23, s23, s36
    s_add_u32 m0, s40, 1024
    s_nop 0
    buffer_load_dwordx4 v240, s[16:19], s23 offen lds
    s_add_u32 s23, s41, 0
    s_and_b32 s23, s23, 15
    s_lshl_b32 s23, s23, 6
    s_add_u32 s23, s23, s37
    s_add_u32 m0, s40, 2048
    s_nop 0
    buffer_load_dwordx4 v8, s[16:19], s23 offen lds
    s_add_u32 s23, s41, 0
    s_and_b32 s23, s23, 15
    s_lshl_b32 s23, s23, 6
    s_add_u32 s23, s23, s37
    s_add_u32 m0, s40, 3072
    s_nop 0
    buffer_load_dwordx4 v240, s[16:19], s23 offen lds
    s_add_u32 s23, s41, 0
    s_and_b32 s23, s23, 15
    s_lshl_b32 s23, s23, 6
    s_add_u32 s23, s23, s38
    s_add_u32 m0, s40, 4096
    s_nop 0
    buffer_load_dwordx4 v8, s[16:19], s23 offen lds
    s_add_u32 s23, s41, 0
    s_and_b32 s23, s23, 15
    s_lshl_b32 s23, s23, 6
    s_add_u32 s23, s23, s38
    s_add_u32 m0, s40, 5120
    s_nop 0
    buffer_load_dwordx4 v240, s[16:19], s23 offen lds
    s_add_u32 s23, s41, 0
    s_and_b32 s23, s23, 15
    s_lshl_b32 s23, s23, 6
    s_add_u32 s23, s23, s39
    s_add_u32 m0, s40, 6144
    s_nop 0
    buffer_load_dwordx4 v8, s[16:19], s23 offen lds
    s_add_u32 s23, s41, 0
    s_and_b32 s23, s23, 15
    s_lshl_b32 s23, s23, 6
    s_add_u32 s23, s23, s39
    s_add_u32 m0, s40, 7168
    s_nop 0
    buffer_load_dwordx4 v240, s[16:19], s23 offen lds
KF_WV35:
    s_waitcnt lgkmcnt(0)
    v_pk_fma_f32 v[52:53], v[68:69], v[84:85], v[52:53] op_sel_hi:[1,0,1]
    v_pk_fma_f32 v[54:55], v[70:71], v[84:85], v[54:55] op_sel_hi:[1,0,1]
    v_pk_fma_f32 v[56:57], v[68:69], v[86:87], v[56:57] op_sel_hi:[1,0,1]
    v_pk_fma_f32 v[58:59], v[70:71], v[86:87], v[58:59] op_sel_hi:[1,0,1]
    v_pk_fma_f32 v[60:61], v[72:73], v[84:85], v[60:61] op_sel_hi:[1,0,1]
    v_pk_fma_f32 v[62:63], v[74:75], v[84:85], v[62:63] op_sel_hi:[1,0,1]
    s_cmp_ge_u32 s22, 4
    s_cbranch_scc1 KF_WV36
    s_add_u32 s23, s41, 2
    s_and_b32 s23, s23, 15
    s_lshl_b32 s23, s23, 6
    s_add_u32 s23, s23, s36
    s_add_u32 m0, s40, 8192
    s_nop 0
    buffer_load_dwordx4 v8, s[16:19], s23 offen lds
    s_add_u32 s23, s41, 2
    s_and_b32 s23, s23, 15
    s_lshl_b32 s23, s23, 6
    s_add_u32 s23, s23, s36
    s_add_u32 m0, s40, 9216
    s_nop 0
    buffer_load_dwordx4 v240, s[16:19], s23 offen lds
KF_WV36:
    v_pk_fma_f32 v[64:65], v[72:73], v[86:87], v[64:65] op_sel_hi:[1,0,1]
    v_pk_fma_f32 v[66:67], v[74:75], v[86:87], v[66:67] op_sel_hi:[1,0,1]
    v_pk_mul_f32 v[52:53], v[52:53], v[88:89] op_sel_hi:[1,0]
    v_pk_mul_f32 v[54:55], v[54:55], v[88:89] op_sel_hi:[1,0]
    v_pk_mul_f32 v[56:57], v[56:57], v[90:91] op_sel_hi:[1,0]
    v_pk_mul_f32 v[58:59], v[58:59], v[90:91] op_sel_hi:[1,0]
    s_cmp_ge_u32 s22, 4
    s_cbranch_scc1 KF_WV37
    s_add_u32 s23, s41, 2
    s_and_b32 s23, s23, 15
    s_lshl_b32 s23, s23, 6
    s_add_u32 s23, s23, s37
    s_add_u32 m0, s40, 10240
    s_nop 0
    buffer_load_dwordx4 v8, s[16:19], s23 offen lds
    s_add_u32 s23, s41, 2
    s_and_b32 s23, s23, 15
    s_lshl_b32 s23, s23, 6
    s_add_u32 s23, s23, s37
    s_add_u32 m0, s40, 11264
    s_nop 0
    buffer_load_dwordx4 v240, s[16:19], s23 offen lds
KF_WV37:
    v_pk_mul_f32 v[60:61], v[60:61], v[88:89] op_sel_hi:[1,0]
    v_pk_mul_f32 v[62:63], v[62:63], v[88:89] op_sel_hi:[1,0]
    v_pk_mul_f32 v[64:65], v[64:65], v[90:91] op_sel_hi:[1,0]
    v_pk_mul_f32 v[66:67], v[66:67], v[90:91] op_sel_hi:[1,0]
    v_pk_mul_f32 v[92:93], v[52:53], v[52:53]
    v_pk_mul_f32 v[94:95], v[54:55], v[54:55]
    s_cmp_ge_u32 s22, 4
    s_cbranch_scc1 KF_WV38
    s_add_u32 s23, s41, 2
    s_and_b32 s23, s23, 15
    s_lshl_b32 s23, s23, 6
    s_add_u32 s23, s23, s38
    s_add_u32 m0, s40, 12288
    s_nop 0
    buffer_load_dwordx4 v8, s[16:19], s23 offen lds
    s_add_u32 s23, s41, 2
    s_and_b32 s23, s23, 15
    s_lshl_b32 s23, s23, 6
    s_add_u32 s23, s23, s38
    s_add_u32 m0, s40, 13312
    s_nop 0
    buffer_load_dwordx4 v240, s[16:19], s23 offen lds
KF_WV38:
    v_pk_mul_f32 v[96:97], v[56:57], v[56:57]
    v_pk_mul_f32 v[98:99], v[58:59], v[58:59]
    v_pk_mul_f32 v[100:101], v[60:61], v[60:61]
    v_pk_mul_f32 v[102:103], v[62:63], v[62:63]
    v_pk_mul_f32 v[104:105], v[64:65], v[64:65]
    v_pk_mul_f32 v[106:107], v[66:67], v[66:67]
    s_cmp_ge_u32 s22, 4
    s_cbranch_scc1 KF_WV39
    s_add_u32 s23, s41, 2
    s_and_b32 s23, s23, 15
    s_lshl_b32 s23, s23, 6
    s_add_u32 s23, s23, s39
    s_add_u32 m0, s40, 14336
    s_nop 0
    buffer_load_dwordx4 v8, s[16:19], s23 offen lds
    s_add_u32 s23, s41, 2
    s_and_b32 s23, s23, 15
    s_lshl_b32 s23, s23, 6
    s_add_u32 s23, s23, s39
    s_add_u32 m0, s40, 15360
    s_nop 0
    buffer_load_dwordx4 v240, s[16:19], s23 offen lds
KF_WV39:
    v_pk_fma_f32 v[92:93], v[92:93], s[54:55], v[12:13]
    v_pk_fma_f32 v[94:95], v[94:95], s[54:55], v[12:13]
    v_pk_fma_f32 v[96:97], v[96:97], s[54:55], v[12:13]
    v_pk_fma_f32 v[98:99], v[98:99], s[54:55], v[12:13]
    v_pk_fma_f32 v[100:101], v[100:101], s[54:55], v[12:13]
    v_pk_fma_f32 v[102:103], v[102:103], s[54:55], v[12:13]
    s_cmp_ge_u32 s22, 4
    s_cbranch_scc1 KF_WV40
    s_add_u32 s23, s41, 4
    s_and_b32 s23, s23, 15
    s_lshl_b32 s23, s23, 6
    s_add_u32 s23, s23, s36
    s_add_u32 m0, s40, 16384
    s_nop 0
    buffer_load_dwordx4 v8, s[16:19], s23 offen lds
    s_add_u32 s23, s41, 4
    s_and_b32 s23, s23, 15
    s_lshl_b32 s23, s23, 6
    s_add_u32 s23, s23, s36
    s_add_u32 m0, s40, 17408
    s_nop 0
    buffer_load_dwordx4 v240, s[16:19], s23 offen lds
KF_WV40:
    v_pk_fma_f32 v[104:105], v[104:105], s[54:55], v[12:13]
    v_pk_fma_f32 v[106:107], v[106:107], s[54:55], v[12:13]
    v_pk_mul_f32 v[92:93], v[92:93], v[52:53]
    v_pk_mul_f32 v[94:95], v[94:95], v[54:55]
    v_pk_mul_f32 v[96:97], v[96:97], v[56:57]
    v_pk_mul_f32 v[98:99], v[98:99], v[58:59]
    s_cmp_ge_u32 s22, 4
    s_cbranch_scc1 KF_WV41
    s_add_u32 s23, s41, 4
    s_and_b32 s23, s23, 15
    s_lshl_b32 s23, s23, 6
    s_add_u32 s23, s23, s37
    s_add_u32 m0, s40, 18432
    s_nop 0
    buffer_load_dwordx4 v8, s[16:19], s23 offen lds
    s_add_u32 s23, s41, 4
    s_and_b32 s23, s23, 15
    s_lshl_b32 s23, s23, 6
    s_add_u32 s23, s23, s37
    s_add_u32 m0, s40, 19456
    s_nop 0
    buffer_load_dwordx4 v240, s[16:19], s23 offen lds
KF_WV41:
    v_pk_mul_f32 v[100:101], v[100:101], v[60:61]
    v_pk_mul_f32 v[102:103], v[102:103], v[62:63]
    v_pk_mul_f32 v[104:105], v[104:105], v[64:65]
    v_pk_mul_f32 v[106:107], v[106:107], v[66:67]
    v_exp_f32 v92, v92
    v_exp_f32 v93, v93
    s_cmp_ge_u32 s22, 4
    s_cbranch_scc1 KF_WV42
    s_add_u32 s23, s41, 4
    s_and_b32 s23, s23, 15
    s_lshl_b32 s23, s23, 6
    s_add_u32 s23, s23, s38
    s_add_u32 m0, s40, 20480
    s_nop 0
    buffer_load_dwordx4 v8, s[16:19], s23 offen lds
    s_add_u32 s23, s41, 4
    s_and_b32 s23, s23, 15
    s_lshl_b32 s23, s23, 6
    s_add_u32 s23, s23, s38
    s_add_u32 m0, s40, 21504
    s_nop 0
    buffer_load_dwordx4 v240, s[16:19], s23 offen lds
KF_WV42:
    v_exp_f32 v94, v94
    v_exp_f32 v95, v95
    v_exp_f32 v96, v96
    v_exp_f32 v97, v97
    v_exp_f32 v98, v98
    v_exp_f32 v99, v99
    s_cmp_ge_u32 s22, 4
    s_cbranch_scc1 KF_WV43
    s_add_u32 s23, s41, 4
    s_and_b32 s23, s23, 15
    s_lshl_b32 s23, s23, 6
    s_add_u32 s23, s23, s39
    s_add_u32 m0, s40, 22528
    s_nop 0
    buffer_load_dwordx4 v8, s[16:19], s23 offen lds
    s_add_u32 s23, s41, 4
    s_and_b32 s23, s23, 15
    s_lshl_b32 s23, s23, 6
    s_add_u32 s23, s23, s39
    s_add_u32 m0, s40, 23552
    s_nop 0
    buffer_load_dwordx4 v240, s[16:19], s23 offen lds
KF_WV43:
    v_exp_f32 v100, v100
    v_exp_f32 v101, v101
    v_exp_f32 v102, v102
    v_exp_f32 v103, v103
    v_exp_f32 v104, v104
    v_exp_f32 v105, v105
    s_cmp_ge_u32 s22, 4
    s_cbranch_scc1 KF_WV44
    s_waitcnt vmcnt(16)
    ds_read_b128 v[208:211], v9 offset:0
    ds_read_b128 v[212:215], v9 offset:2048
    ds_read_b128 v[216:219], v9 offset:4096
    ds_read_b128 v[220:223], v9 offset:6144
    ds_read_b128 v[224:227], v241 offset:0
    ds_read_b128 v[228:231], v241 offset:2048
    ds_read_b128 v[232:235], v241 offset:4096
    ds_read_b128 v[236:239], v241 offset:6144
KF_WV44:
    v_exp_f32 v106, v106
    v_exp_f32 v107, v107
    v_pk_add_f32 v[92:93], v[92:93], v[14:15]
    v_pk_add_f32 v[94:95], v[94:95], v[14:15]
    v_pk_add_f32 v[96:97], v[96:97], v[14:15]
    v_pk_add_f32 v[98:99], v[98:99], v[14:15]
    s_cmp_ge_u32 s22, 4
    s_cbranch_scc1 KF_WV45
    s_waitcnt lgkmcnt(0)
    s_add_u32 s23, s41, 6
    s_and_b32 s23, s23, 15
    s_lshl_b32 s23, s23, 6
    s_add_u32 s23, s23, s36
    s_add_u32 m0, s40, 0
    s_nop 0
    buffer_load_dwordx4 v8, s[16:19], s23 offen lds
    s_add_u32 s23, s41, 6
    s_and_b32 s23, s23, 15
    s_lshl_b32 s23, s23, 6
    s_add_u32 s23, s23, s36
    s_add_u32 m0, s40, 1024
    s_nop 0
    buffer_load_dwordx4 v240, s[16:19], s23 offen lds
KF_WV45:
    v_pk_add_f32 v[100:101], v[100:101], v[14:15]
    v_pk_add_f32 v[102:103], v[102:103], v[14:15]
    v_pk_add_f32 v[104:105], v[104:105], v[14:15]
    v_pk_add_f32 v[106:107], v[106:107], v[14:15]
    v_rcp_f32 v92, v92
    v_rcp_f32 v93, v93
    s_cmp_ge_u32 s22, 4
    s_cbranch_scc1 KF_WV46
    s_add_u32 s23, s41, 6
    s_and_b32 s23, s23, 15
    s_lshl_b32 s23, s23, 6
    s_add_u32 s23, s23, s37
    s_add_u32 m0, s40, 2048
    s_nop 0
    buffer_load_dwordx4 v8, s[16:19], s23 offen lds
    s_add_u32 s23, s41, 6
    s_and_b32 s23, s23, 15
    s_lshl_b32 s23, s23, 6
    s_add_u32 s23, s23, s37
    s_add_u32 m0, s40, 3072
    s_nop 0
    buffer_load_dwordx4 v240, s[16:19], s23 offen lds
KF_WV46:
    v_rcp_f32 v94, v94
    v_rcp_f32 v95, v95
    v_rcp_f32 v96, v96
    v_rcp_f32 v97, v97
    v_rcp_f32 v98, v98
    v_rcp_f32 v99, v99
    s_cmp_ge_u32 s22, 4
    s_cbranch_scc1 KF_WV47
    s_add_u32 s23, s41, 6
    s_and_b32 s23, s23, 15
    s_lshl_b32 s23, s23, 6
    s_add_u32 s23, s23, s38
    s_add_u32 m0, s40, 4096
    s_nop 0
    buffer_load_dwordx4 v8, s[16:19], s23 offen lds
    s_add_u32 s23, s41, 6
    s_and_b32 s23, s23, 15
    s_lshl_b32 s23, s23, 6
    s_add_u32 s23, s23, s38
    s_add_u32 m0, s40, 5120
    s_nop 0
    buffer_load_dwordx4 v240, s[16:19], s23 offen lds
KF_WV47:
    v_rcp_f32 v100, v100
    v_rcp_f32 v101, v101
    v_rcp_f32 v102, v102
    v_rcp_f32 v103, v103
    v_rcp_f32 v104, v104
    v_rcp_f32 v105, v105
    s_cmp_ge_u32 s22, 4
    s_cbranch_scc1 KF_WV48
    s_add_u32 s23, s41, 6
    s_and_b32 s23, s23, 15
    s_lshl_b32 s23, s23, 6
    s_add_u32 s23, s23, s39
    s_add_u32 m0, s40, 6144
    s_nop 0
    buffer_load_dwordx4 v8, s[16:19], s23 offen lds
    s_add_u32 s23, s41, 6
    s_and_b32 s23, s23, 15
    s_lshl_b32 s23, s23, 6
    s_add_u32 s23, s23, s39
    s_add_u32 m0, s40, 7168
    s_nop 0
    buffer_load_dwordx4 v240, s[16:19], s23 offen lds
KF_WV48:
    v_rcp_f32 v106, v106
    v_rcp_f32 v107, v107
    v_pk_mul_f32 v[52:53], v[52:53], v[92:93]
    v_pk_mul_f32 v[54:55], v[54:55], v[94:95]
    v_pk_mul_f32 v[56:57], v[56:57], v[96:97]
    v_pk_mul_f32 v[58:59], v[58:59], v[98:99]
    v_pk_mul_f32 v[60:61], v[60:61], v[100:101]
    v_pk_mul_f32 v[62:63], v[62:63], v[102:103]
    v_pk_mul_f32 v[64:65], v[64:65], v[104:105]
    v_pk_mul_f32 v[66:67], v[66:67], v[106:107]
    v_cvt_pk_bf16_f32 v76, v52, v53
    v_cvt_pk_bf16_f32 v77, v54, v55
    buffer_store_dwordx2 v[76:77], v21, s[12:15], s46 offen sc1
    v_cvt_pk_bf16_f32 v78, v56, v57
    v_cvt_pk_bf16_f32 v79, v58, v59
    buffer_store_dwordx2 v[78:79], v21, s[12:15], s47 offen sc1
    v_cvt_pk_bf16_f32 v80, v60, v61
    v_cvt_pk_bf16_f32 v81, v62, v63
    buffer_store_dwordx2 v[80:81], v23, s[12:15], s46 offen sc1
    v_cvt_pk_bf16_f32 v82, v64, v65
    v_cvt_pk_bf16_f32 v83, v66, v67
    buffer_store_dwordx2 v[82:83], v23, s[12:15], s47 offen sc1
    s_nop 1
P1_DONE:
    s_cmp_ge_u32 s22, 4
    s_cbranch_scc1 K2_CONV
    s_lshr_b32 s23, s21, 1
    s_lshr_b32 s24, s2, 6
    s_cmp_lt_u32 s22, 4
    s_cselect_b32 s23, s23, s24
    s_lshl_b32 s23, s23, 8
    s_add_u32 s23, s23, 15532032
    s_lshr_b32 s24, s2, 1
    s_and_b32 s24, s24, 3
    s_lshl_b32 s24, s24, 10
    s_add_u32 s23, s23, s24
    s_mov_b32 s25, 0
KF_PL49:
    buffer_load_dword v252, v253, s[12:15], s23 offen sc1
    s_waitcnt vmcnt(0)
KF_PC49:
    v_cmp_ne_u32 vcc, v250, v252
    s_cmp_eq_u64 vcc, 0
    s_cbranch_scc1 KF_PG49
    s_sleep 4
    s_add_u32 s25, s25, 1
    s_cmp_lt_u32 s25, 0x40000
    s_cbranch_scc1 KF_PL49
KF_PG49:
    s_lshl_b32 s23, s20, 8
    s_add_u32 s23, s23, 15564800
    s_lshl_b32 s24, s21, 3
    s_add_u32 s24, s24, s22
    s_lshl_b64 exec, 1, s24
    buffer_store_dword v250, v253, s[12:15], s23 offen sc1
    s_mov_b64 exec, -1
    s_add_u32 s23, s41, 0
    s_and_b32 s23, s23, 15
    s_lshl_b32 s23, s23, 10
    v_add_u32 v242, s23, v7
    buffer_load_dwordx4 v[124:127], v242, s[12:15], s28 offen sc1
    buffer_load_dwordx4 v[128:131], v242, s[12:15], s29 offen sc1
    buffer_load_dwordx4 v[132:135], v242, s[12:15], s30 offen sc1
    buffer_load_dwordx4 v[136:139], v242, s[12:15], s31 offen sc1
    buffer_load_dwordx4 v[140:143], v242, s[12:15], s32 offen sc1
    buffer_load_dwordx4 v[144:147], v242, s[12:15], s33 offen sc1
    buffer_load_dwordx4 v[148:151], v242, s[12:15], s34 offen sc1
    s_add_u32 s23, s41, 1
    s_and_b32 s23, s23, 15
    s_lshl_b32 s23, s23, 10
    v_add_u32 v242, s23, v7
    buffer_load_dwordx4 v[152:155], v242, s[12:15], s28 offen sc1
    buffer_load_dwordx4 v[156:159], v242, s[12:15], s29 offen sc1
    buffer_load_dwordx4 v[160:163], v242, s[12:15], s30 offen sc1
    buffer_load_dwordx4 v[164:167], v242, s[12:15], s31 offen sc1
    buffer_load_dwordx4 v[168:171], v242, s[12:15], s32 offen sc1
    buffer_load_dwordx4 v[172:175], v242, s[12:15], s33 offen sc1
    buffer_load_dwordx4 v[176:179], v242, s[12:15], s34 offen sc1
    s_add_u32 s23, s41, 2
    s_and_b32 s23, s23, 15
    s_lshl_b32 s23, s23, 10
    v_add_u32 v242, s23, v7
    buffer_load_dwordx4 v[180:183], v242, s[12:15], s28 offen sc1
    buffer_load_dwordx4 v[184:187], v242, s[12:15], s29 offen sc1
    buffer_load_dwordx4 v[188:191], v242, s[12:15], s30 offen sc1
    buffer_load_dwordx4 v[192:195], v242, s[12:15], s31 offen sc1
    buffer_load_dwordx4 v[196:199], v242, s[12:15], s32 offen sc1
    buffer_load_dwordx4 v[200:203], v242, s[12:15], s33 offen sc1
    buffer_load_dwordx4 v[204:207], v242, s[12:15], s34 offen sc1
    s_waitcnt lgkmcnt(0)
    s_waitcnt vmcnt(20)
    v_mfma_f32_16x16x32_bf16 v[12:15], v[124:127], v[208:211], 0
    v_mfma_f32_16x16x32_bf16 v[40:43], v[124:127], v[212:215], 0
    v_mfma_f32_16x16x32_bf16 v[68:71], v[124:127], v[216:219], 0
    v_mfma_f32_16x16x32_bf16 v[96:99], v[124:127], v[220:223], 0
    s_add_u32 s23, s41, 3
    s_and_b32 s23, s23, 15
    s_lshl_b32 s23, s23, 10
    v_add_u32 v242, s23, v7
    buffer_load_dwordx4 v[124:127], v242, s[12:15], s28 offen sc1
    s_waitcnt vmcnt(20)
    v_mfma_f32_16x16x32_bf16 v[16:19], v[128:131], v[208:211], 0
    v_mfma_f32_16x16x32_bf16 v[44:47], v[128:131], v[212:215], 0
    v_mfma_f32_16x16x32_bf16 v[72:75], v[128:131], v[216:219], 0
    v_mfma_f32_16x16x32_bf16 v[100:103], v[128:131], v[220:223], 0
    buffer_load_dwordx4 v[128:131], v242, s[12:15], s29 offen sc1
    s_waitcnt vmcnt(20)
    v_mfma_f32_16x16x32_bf16 v[20:23], v[132:135], v[208:211], 0
    v_mfma_f32_16x16x32_bf16 v[48:51], v[132:135], v[212:215], 0
    v_mfma_f32_16x16x32_bf16 v[76:79], v[132:135], v[216:219], 0
    v_mfma_f32_16x16x32_bf16 v[104:107], v[132:135], v[220:223], 0
    buffer_load_dwordx4 v[132:135], v242, s[12:15], s30 offen sc1
    s_waitcnt vmcnt(20)
    v_mfma_f32_16x16x32_bf16 v[24:27], v[136:139], v[208:211], 0
    v_mfma_f32_16x16x32_bf16 v[52:55], v[136:139], v[212:215], 0
    v_mfma_f32_16x16x32_bf16 v[80:83], v[136:139], v[216:219], 0
    v_mfma_f32_16x16x32_bf16 v[108:111], v[136:139], v[220:223], 0
    buffer_load_dwordx4 v[136:139], v242, s[12:15], s31 offen sc1
    s_waitcnt vmcnt(20)
    v_mfma_f32_16x16x32_bf16 v[28:31], v[140:143], v[208:211], 0
    v_mfma_f32_16x16x32_bf16 v[56:59], v[140:143], v[212:215], 0
    v_mfma_f32_16x16x32_bf16 v[84:87], v[140:143], v[216:219], 0
    v_mfma_f32_16x16x32_bf16 v[112:115], v[140:143], v[220:223], 0
    buffer_load_dwordx4 v[140:143], v242, s[12:15], s32 offen sc1
    s_waitcnt vmcnt(20)
    v_mfma_f32_16x16x32_bf16 v[32:35], v[144:147], v[208:211], 0
    v_mfma_f32_16x16x32_bf16 v[60:63], v[144:147], v[212:215], 0
    v_mfma_f32_16x16x32_bf16 v[88:91], v[144:147], v[216:219], 0
    v_mfma_f32_16x16x32_bf16 v[116:119], v[144:147], v[220:223], 0
    buffer_load_dwordx4 v[144:147], v242, s[12:15], s33 offen sc1
    s_waitcnt vmcnt(20)
    v_mfma_f32_16x16x32_bf16 v[36:39], v[148:151], v[208:211], 0
    v_mfma_f32_16x16x32_bf16 v[64:67], v[148:151], v[212:215], 0
    v_mfma_f32_16x16x32_bf16 v[92:95], v[148:151], v[216:219], 0
    v_mfma_f32_16x16x32_bf16 v[120:123], v[148:151], v[220:223], 0
    buffer_load_dwordx4 v[148:151], v242, s[12:15], s34 offen sc1
    s_waitcnt lgkmcnt(0)
    ds_read_b128 v[208:211], v9 offset:8192
    ds_read_b128 v[212:215], v9 offset:10240
    ds_read_b128 v[216:219], v9 offset:12288
    ds_read_b128 v[220:223], v9 offset:14336
    s_waitcnt vmcnt(20)
    v_mfma_f32_16x16x32_bf16 v[12:15], v[152:155], v[224:227], v[12:15]
    v_mfma_f32_16x16x32_bf16 v[40:43], v[152:155], v[228:231], v[40:43]
    v_mfma_f32_16x16x32_bf16 v[68:71], v[152:155], v[232:235], v[68:71]
    v_mfma_f32_16x16x32_bf16 v[96:99], v[152:155], v[236:239], v[96:99]
    s_add_u32 s23, s41, 4
    s_and_b32 s23, s23, 15
    s_lshl_b32 s23, s23, 10
    v_add_u32 v242, s23, v7
    buffer_load_dwordx4 v[152:155], v242, s[12:15], s28 offen sc1
    s_waitcnt vmcnt(20)
    v_mfma_f32_16x16x32_bf16 v[16:19], v[156:159], v[224:227], v[16:19]
    v_mfma_f32_16x16x32_bf16 v[44:47], v[156:159], v[228:231], v[44:47]
    v_mfma_f32_16x16x32_bf16 v[72:75], v[156:159], v[232:235], v[72:75]
    v_mfma_f32_16x16x32_bf16 v[100:103], v[156:159], v[236:239], v[100:103]
    buffer_load_dwordx4 v[156:159], v242, s[12:15], s29 offen sc1
    s_waitcnt vmcnt(20)
    v_mfma_f32_16x16x32_bf16 v[20:23], v[160:163], v[224:227], v[20:23]
    v_mfma_f32_16x16x32_bf16 v[48:51], v[160:163], v[228:231], v[48:51]
    v_mfma_f32_16x16x32_bf16 v[76:79], v[160:163], v[232:235], v[76:79]
    v_mfma_f32_16x16x32_bf16 v[104:107], v[160:163], v[236:239], v[104:107]
    buffer_load_dwordx4 v[160:163], v242, s[12:15], s30 offen sc1
    s_waitcnt vmcnt(20)
    v_mfma_f32_16x16x32_bf16 v[24:27], v[164:167], v[224:227], v[24:27]
    v_mfma_f32_16x16x32_bf16 v[52:55], v[164:167], v[228:231], v[52:55]
    v_mfma_f32_16x16x32_bf16 v[80:83], v[164:167], v[232:235], v[80:83]
    v_mfma_f32_16x16x32_bf16 v[108:111], v[164:167], v[236:239], v[108:111]
    buffer_load_dwordx4 v[164:167], v242, s[12:15], s31 offen sc1
    s_waitcnt vmcnt(20)
    v_mfma_f32_16x16x32_bf16 v[28:31], v[168:171], v[224:227], v[28:31]
    v_mfma_f32_16x16x32_bf16 v[56:59], v[168:171], v[228:231], v[56:59]
    v_mfma_f32_16x16x32_bf16 v[84:87], v[168:171], v[232:235], v[84:87]
    v_mfma_f32_16x16x32_bf16 v[112:115], v[168:171], v[236:239], v[112:115]
    buffer_load_dwordx4 v[168:171], v242, s[12:15], s32 offen sc1
    s_waitcnt vmcnt(20)
    v_mfma_f32_16x16x32_bf16 v[32:35], v[172:175], v[224:227], v[32:35]
    v_mfma_f32_16x16x32_bf16 v[60:63], v[172:175], v[228:231], v[60:63]
    v_mfma_f32_16x16x32_bf16 v[88:91], v[172:175], v[232:235], v[88:91]
    v_mfma_f32_16x16x32_bf16 v[116:119], v[172:175], v[236:239], v[116:119]
    buffer_load_dwordx4 v[172:175], v242, s[12:15], s33 offen sc1
    s_waitcnt vmcnt(20)
    v_mfma_f32_16x16x32_bf16 v[36:39], v[176:179], v[224:227], v[36:39]
    v_mfma_f32_16x16x32_bf16 v[64:67], v[176:179], v[228:231], v[64:67]
    v_mfma_f32_16x16x32_bf16 v[92:95], v[176:179], v[232:235], v[92:95]
    v_mfma_f32_16x16x32_bf16 v[120:123], v[176:179], v[236:239], v[120:123]
    buffer_load_dwordx4 v[176:179], v242, s[12:15], s34 offen sc1
    s_waitcnt lgkmcnt(0)
    ds_read_b128 v[224:227], v241 offset:8192
    ds_read_b128 v[228:231], v241 offset:10240
    ds_read_b128 v[232:235], v241 offset:12288
    ds_read_b128 v[236:239], v241 offset:14336
    s_waitcnt vmcnt(20)
    v_mfma_f32_16x16x32_bf16 v[12:15], v[180:183], v[208:211], v[12:15]
    v_mfma_f32_16x16x32_bf16 v[40:43], v[180:183], v[212:215], v[40:43]
    v_mfma_f32_16x16x32_bf16 v[68:71], v[180:183], v[216:219], v[68:71]
    v_mfma_f32_16x16x32_bf16 v[96:99], v[180:183], v[220:223], v[96:99]
    s_add_u32 s23, s41, 5
    s_and_b32 s23, s23, 15
    s_lshl_b32 s23, s23, 10
    v_add_u32 v242, s23, v7
    buffer_load_dwordx4 v[180:183], v242, s[12:15], s28 offen sc1
    s_waitcnt vmcnt(20)
    v_mfma_f32_16x16x32_bf16 v[16:19], v[184:187], v[208:211], v[16:19]
    v_mfma_f32_16x16x32_bf16 v[44:47], v[184:187], v[212:215], v[44:47]
    v_mfma_f32_16x16x32_bf16 v[72:75], v[184:187], v[216:219], v[72:75]
    v_mfma_f32_16x16x32_bf16 v[100:103], v[184:187], v[220:223], v[100:103]
    buffer_load_dwordx4 v[184:187], v242, s[12:15], s29 offen sc1
    s_waitcnt vmcnt(20)
    v_mfma_f32_16x16x32_bf16 v[20:23], v[188:191], v[208:211], v[20:23]
    v_mfma_f32_16x16x32_bf16 v[48:51], v[188:191], v[212:215], v[48:51]
    v_mfma_f32_16x16x32_bf16 v[76:79], v[188:191], v[216:219], v[76:79]
    v_mfma_f32_16x16x32_bf16 v[104:107], v[188:191], v[220:223], v[104:107]
    buffer_load_dwordx4 v[188:191], v242, s[12:15], s30 offen sc1
    s_waitcnt vmcnt(20)
    v_mfma_f32_16x16x32_bf16 v[24:27], v[192:195], v[208:211], v[24:27]
    v_mfma_f32_16x16x32_bf16 v[52:55], v[192:195], v[212:215], v[52:55]
    v_mfma_f32_16x16x32_bf16 v[80:83], v[192:195], v[216:219], v[80:83]
    v_mfma_f32_16x16x32_bf16 v[108:111], v[192:195], v[220:223], v[108:111]
    buffer_load_dwordx4 v[192:195], v242, s[12:15], s31 offen sc1
    s_waitcnt vmcnt(20)
    v_mfma_f32_16x16x32_bf16 v[28:31], v[196:199], v[208:211], v[28:31]
    v_mfma_f32_16x16x32_bf16 v[56:59], v[196:199], v[212:215], v[56:59]
    v_mfma_f32_16x16x32_bf16 v[84:87], v[196:199], v[216:219], v[84:87]
    v_mfma_f32_16x16x32_bf16 v[112:115], v[196:199], v[220:223], v[112:115]
    buffer_load_dwordx4 v[196:199], v242, s[12:15], s32 offen sc1
    s_waitcnt vmcnt(20)
    v_mfma_f32_16x16x32_bf16 v[32:35], v[200:203], v[208:211], v[32:35]
    v_mfma_f32_16x16x32_bf16 v[60:63], v[200:203], v[212:215], v[60:63]
    v_mfma_f32_16x16x32_bf16 v[88:91], v[200:203], v[216:219], v[88:91]
    v_mfma_f32_16x16x32_bf16 v[116:119], v[200:203], v[220:223], v[116:119]
    buffer_load_dwordx4 v[200:203], v242, s[12:15], s33 offen sc1
    s_waitcnt vmcnt(20)
    v_mfma_f32_16x16x32_bf16 v[36:39], v[204:207], v[208:211], v[36:39]
    v_mfma_f32_16x16x32_bf16 v[64:67], v[204:207], v[212:215], v[64:67]
    v_mfma_f32_16x16x32_bf16 v[92:95], v[204:207], v[216:219], v[92:95]
    v_mfma_f32_16x16x32_bf16 v[120:123], v[204:207], v[220:223], v[120:123]
    buffer_load_dwordx4 v[204:207], v242, s[12:15], s34 offen sc1
    s_waitcnt lgkmcnt(0)
    ds_read_b128 v[208:211], v9 offset:16384
    ds_read_b128 v[212:215], v9 offset:18432
    ds_read_b128 v[216:219], v9 offset:20480
    ds_read_b128 v[220:223], v9 offset:22528
    s_waitcnt vmcnt(20)
    v_mfma_f32_16x16x32_bf16 v[12:15], v[124:127], v[224:227], v[12:15]
    v_mfma_f32_16x16x32_bf16 v[40:43], v[124:127], v[228:231], v[40:43]
    v_mfma_f32_16x16x32_bf16 v[68:71], v[124:127], v[232:235], v[68:71]
    v_mfma_f32_16x16x32_bf16 v[96:99], v[124:127], v[236:239], v[96:99]
    s_add_u32 s23, s41, 6
    s_and_b32 s23, s23, 15
    s_lshl_b32 s23, s23, 10
    v_add_u32 v242, s23, v7
    buffer_load_dwordx4 v[124:127], v242, s[12:15], s28 offen sc1
    s_add_u32 s23, s41, 8
    s_and_b32 s23, s23, 15
    s_lshl_b32 s23, s23, 6
    s_add_u32 s23, s23, s36
    s_add_u32 m0, s40, 8192
    s_nop 0
    buffer_load_dwordx4 v8, s[16:19], s23 offen lds
    s_waitcnt vmcnt(21)
    v_mfma_f32_16x16x32_bf16 v[16:19], v[128:131], v[224:227], v[16:19]
    v_mfma_f32_16x16x32_bf16 v[44:47], v[128:131], v[228:231], v[44:47]
    v_mfma_f32_16x16x32_bf16 v[72:75], v[128:131], v[232:235], v[72:75]
    v_mfma_f32_16x16x32_bf16 v[100:103], v[128:131], v[236:239], v[100:103]
    buffer_load_dwordx4 v[128:131], v242, s[12:15], s29 offen sc1
    s_waitcnt vmcnt(21)
    v_mfma_f32_16x16x32_bf16 v[20:23], v[132:135], v[224:227], v[20:23]
    v_mfma_f32_16x16x32_bf16 v[48:51], v[132:135], v[228:231], v[48:51]
    v_mfma_f32_16x16x32_bf16 v[76:79], v[132:135], v[232:235], v[76:79]
    v_mfma_f32_16x16x32_bf16 v[104:107], v[132:135], v[236:239], v[104:107]
    buffer_load_dwordx4 v[132:135], v242, s[12:15], s30 offen sc1
    s_add_u32 s23, s41, 8
    s_and_b32 s23, s23, 15
    s_lshl_b32 s23, s23, 6
    s_add_u32 s23, s23, s36
    s_add_u32 m0, s40, 9216
    s_nop 0
    buffer_load_dwordx4 v240, s[16:19], s23 offen lds
    s_waitcnt vmcnt(22)
    v_mfma_f32_16x16x32_bf16 v[24:27], v[136:139], v[224:227], v[24:27]
    v_mfma_f32_16x16x32_bf16 v[52:55], v[136:139], v[228:231], v[52:55]
    v_mfma_f32_16x16x32_bf16 v[80:83], v[136:139], v[232:235], v[80:83]
    v_mfma_f32_16x16x32_bf16 v[108:111], v[136:139], v[236:239], v[108:111]
    buffer_load_dwordx4 v[136:139], v242, s[12:15], s31 offen sc1
    s_waitcnt vmcnt(22)
    v_mfma_f32_16x16x32_bf16 v[28:31], v[140:143], v[224:227], v[28:31]
    v_mfma_f32_16x16x32_bf16 v[56:59], v[140:143], v[228:231], v[56:59]
    v_mfma_f32_16x16x32_bf16 v[84:87], v[140:143], v[232:235], v[84:87]
    v_mfma_f32_16x16x32_bf16 v[112:115], v[140:143], v[236:239], v[112:115]
    buffer_load_dwordx4 v[140:143], v242, s[12:15], s32 offen sc1
    s_add_u32 s23, s41, 8
    s_and_b32 s23, s23, 15
    s_lshl_b32 s23, s23, 6
    s_add_u32 s23, s23, s37
    s_add_u32 m0, s40, 10240
    s_nop 0
    buffer_load_dwordx4 v8, s[16:19], s23 offen lds
    s_waitcnt vmcnt(23)
    v_mfma_f32_16x16x32_bf16 v[32:35], v[144:147], v[224:227], v[32:35]
    v_mfma_f32_16x16x32_bf16 v[60:63], v[144:147], v[228:231], v[60:63]
    v_mfma_f32_16x16x32_bf16 v[88:91], v[144:147], v[232:235], v[88:91]
    v_mfma_f32_16x16x32_bf16 v[116:119], v[144:147], v[236:239], v[116:119]
    buffer_load_dwordx4 v[144:147], v242, s[12:15], s33 offen sc1
    s_waitcnt vmcnt(23)
    v_mfma_f32_16x16x32_bf16 v[36:39], v[148:151], v[224:227], v[36:39]
    v_mfma_f32_16x16x32_bf16 v[64:67], v[148:151], v[228:231], v[64:67]
    v_mfma_f32_16x16x32_bf16 v[92:95], v[148:151], v[232:235], v[92:95]
    v_mfma_f32_16x16x32_bf16 v[120:123], v[148:151], v[236:239], v[120:123]
    buffer_load_dwordx4 v[148:151], v242, s[12:15], s34 offen sc1
    s_add_u32 s23, s41, 8
    s_and_b32 s23, s23, 15
    s_lshl_b32 s23, s23, 6
    s_add_u32 s23, s23, s37
    s_add_u32 m0, s40, 11264
    s_nop 0
    buffer_load_dwordx4 v240, s[16:19], s23 offen lds
    s_waitcnt lgkmcnt(0)
    ds_read_b128 v[224:227], v241 offset:16384
    ds_read_b128 v[228:231], v241 offset:18432
    ds_read_b128 v[232:235], v241 offset:20480
    ds_read_b128 v[236:239], v241 offset:22528
    s_waitcnt vmcnt(24)
    v_mfma_f32_16x16x32_bf16 v[12:15], v[152:155], v[208:211], v[12:15]
    v_mfma_f32_16x16x32_bf16 v[40:43], v[152:155], v[212:215], v[40:43]
    v_mfma_f32_16x16x32_bf16 v[68:71], v[152:155], v[216:219], v[68:71]
    v_mfma_f32_16x16x32_bf16 v[96:99], v[152:155], v[220:223], v[96:99]
    s_add_u32 s23, s41, 7
    s_and_b32 s23, s23, 15
    s_lshl_b32 s23, s23, 10
    v_add_u32 v242, s23, v7
    buffer_load_dwordx4 v[152:155], v242, s[12:15], s28 offen sc1
    s_add_u32 s23, s41, 8
    s_and_b32 s23, s23, 15
    s_lshl_b32 s23, s23, 6
    s_add_u32 s23, s23, s38
    s_add_u32 m0, s40, 12288
    s_nop 0
    buffer_load_dwordx4 v8, s[16:19], s23 offen lds
    s_waitcnt vmcnt(25)
    v_mfma_f32_16x16x32_bf16 v[16:19], v[156:159], v[208:211], v[16:19]
    v_mfma_f32_16x16x32_bf16 v[44:47], v[156:159], v[212:215], v[44:47]
    v_mfma_f32_16x16x32_bf16 v[72:75], v[156:159], v[216:219], v[72:75]
    v_mfma_f32_16x16x32_bf16 v[100:103], v[156:159], v[220:223], v[100:103]
    buffer_load_dwordx4 v[156:159], v242, s[12:15], s29 offen sc1
    s_waitcnt vmcnt(25)
    v_mfma_f32_16x16x32_bf16 v[20:23], v[160:163], v[208:211], v[20:23]
    v_mfma_f32_16x16x32_bf16 v[48:51], v[160:163], v[212:215], v[48:51]
    v_mfma_f32_16x16x32_bf16 v[76:79], v[160:163], v[216:219], v[76:79]
    v_mfma_f32_16x16x32_bf16 v[104:107], v[160:163], v[220:223], v[104:107]
    buffer_load_dwordx4 v[160:163], v242, s[12:15], s30 offen sc1
    s_add_u32 s23, s41, 8
    s_and_b32 s23, s23, 15
    s_lshl_b32 s23, s23, 6
    s_add_u32 s23, s23, s38
    s_add_u32 m0, s40, 13312
    s_nop 0
    buffer_load_dwordx4 v240, s[16:19], s23 offen lds
    s_waitcnt vmcnt(26)
    v_mfma_f32_16x16x32_bf16 v[24:27], v[164:167], v[208:211], v[24:27]
    v_mfma_f32_16x16x32_bf16 v[52:55], v[164:167], v[212:215], v[52:55]
    v_mfma_f32_16x16x32_bf16 v[80:83], v[164:167], v[216:219], v[80:83]
    v_mfma_f32_16x16x32_bf16 v[108:111], v[164:167], v[220:223], v[108:111]
    buffer_load_dwordx4 v[164:167], v242, s[12:15], s31 offen sc1
    s_waitcnt vmcnt(26)
    v_mfma_f32_16x16x32_bf16 v[28:31], v[168:171], v[208:211], v[28:31]
    v_mfma_f32_16x16x32_bf16 v[56:59], v[168:171], v[212:215], v[56:59]
    v_mfma_f32_16x16x32_bf16 v[84:87], v[168:171], v[216:219], v[84:87]
    v_mfma_f32_16x16x32_bf16 v[112:115], v[168:171], v[220:223], v[112:115]
    buffer_load_dwordx4 v[168:171], v242, s[12:15], s32 offen sc1
    s_add_u32 s23, s41, 8
    s_and_b32 s23, s23, 15
    s_lshl_b32 s23, s23, 6
    s_add_u32 s23, s23, s39
    s_add_u32 m0, s40, 14336
    s_nop 0
    buffer_load_dwordx4 v8, s[16:19], s23 offen lds
    s_waitcnt vmcnt(27)
    v_mfma_f32_16x16x32_bf16 v[32:35], v[172:175], v[208:211], v[32:35]
    v_mfma_f32_16x16x32_bf16 v[60:63], v[172:175], v[212:215], v[60:63]
    v_mfma_f32_16x16x32_bf16 v[88:91], v[172:175], v[216:219], v[88:91]
    v_mfma_f32_16x16x32_bf16 v[116:119], v[172:175], v[220:223], v[116:119]
    buffer_load_dwordx4 v[172:175], v242, s[12:15], s33 offen sc1
    s_waitcnt vmcnt(27)
    v_mfma_f32_16x16x32_bf16 v[36:39], v[176:179], v[208:211], v[36:39]
    v_mfma_f32_16x16x32_bf16 v[64:67], v[176:179], v[212:215], v[64:67]
    v_mfma_f32_16x16x32_bf16 v[92:95], v[176:179], v[216:219], v[92:95]
    v_mfma_f32_16x16x32_bf16 v[120:123], v[176:179], v[220:223], v[120:123]
    buffer_load_dwordx4 v[176:179], v242, s[12:15], s34 offen sc1
    s_add_u32 s23, s41, 8
    s_and_b32 s23, s23, 15
    s_lshl_b32 s23, s23, 6
    s_add_u32 s23, s23, s39
    s_add_u32 m0, s40, 15360
    s_nop 0
    buffer_load_dwordx4 v240, s[16:19], s23 offen lds
    s_waitcnt lgkmcnt(0)
    ds_read_b128 v[208:211], v9 offset:0
    ds_read_b128 v[212:215], v9 offset:2048
    ds_read_b128 v[216:219], v9 offset:4096
    ds_read_b128 v[220:223], v9 offset:6144
    s_waitcnt vmcnt(28)
    v_mfma_f32_16x16x32_bf16 v[12:15], v[180:183], v[224:227], v[12:15]
    v_mfma_f32_16x16x32_bf16 v[40:43], v[180:183], v[228:231], v[40:43]
    v_mfma_f32_16x16x32_bf16 v[68:71], v[180:183], v[232:235], v[68:71]
    v_mfma_f32_16x16x32_bf16 v[96:99], v[180:183], v[236:239], v[96:99]
    s_add_u32 s23, s41, 8
    s_and_b32 s23, s23, 15
    s_lshl_b32 s23, s23, 10
    v_add_u32 v242, s23, v7
    buffer_load_dwordx4 v[180:183], v242, s[12:15], s28 offen sc1
    s_add_u32 s23, s41, 10
    s_and_b32 s23, s23, 15
    s_lshl_b32 s23, s23, 6
    s_add_u32 s23, s23, s36
    s_add_u32 m0, s40, 16384
    s_nop 0
    buffer_load_dwordx4 v8, s[16:19], s23 offen lds
    s_waitcnt vmcnt(29)
    v_mfma_f32_16x16x32_bf16 v[16:19], v[184:187], v[224:227], v[16:19]
    v_mfma_f32_16x16x32_bf16 v[44:47], v[184:187], v[228:231], v[44:47]
    v_mfma_f32_16x16x32_bf16 v[72:75], v[184:187], v[232:235], v[72:75]
    v_mfma_f32_16x16x32_bf16 v[100:103], v[184:187], v[236:239], v[100:103]
    buffer_load_dwordx4 v[184:187], v242, s[12:15], s29 offen sc1
    s_waitcnt vmcnt(29)
    v_mfma_f32_16x16x32_bf16 v[20:23], v[188:191], v[224:227], v[20:23]
    v_mfma_f32_16x16x32_bf16 v[48:51], v[188:191], v[228:231], v[48:51]
    v_mfma_f32_16x16x32_bf16 v[76:79], v[188:191], v[232:235], v[76:79]
    v_mfma_f32_16x16x32_bf16 v[104:107], v[188:191], v[236:239], v[104:107]
    buffer_load_dwordx4 v[188:191], v242, s[12:15], s30 offen sc1
    s_add_u32 s23, s41, 10
    s_and_b32 s23, s23, 15
    s_lshl_b32 s23, s23, 6
    s_add_u32 s23, s23, s36
    s_add_u32 m0, s40, 17408
    s_nop 0
    buffer_load_dwordx4 v240, s[16:19], s23 offen lds
    s_waitcnt vmcnt(30)
    v_mfma_f32_16x16x32_bf16 v[24:27], v[192:195], v[224:227], v[24:27]
    v_mfma_f32_16x16x32_bf16 v[52:55], v[192:195], v[228:231], v[52:55]
    v_mfma_f32_16x16x32_bf16 v[80:83], v[192:195], v[232:235], v[80:83]
    v_mfma_f32_16x16x32_bf16 v[108:111], v[192:195], v[236:239], v[108:111]
    buffer_load_dwordx4 v[192:195], v242, s[12:15], s31 offen sc1
    s_waitcnt vmcnt(30)
    v_mfma_f32_16x16x32_bf16 v[28:31], v[196:199], v[224:227], v[28:31]
    v_mfma_f32_16x16x32_bf16 v[56:59], v[196:199], v[228:231], v[56:59]
    v_mfma_f32_16x16x32_bf16 v[84:87], v[196:199], v[232:235], v[84:87]
    v_mfma_f32_16x16x32_bf16 v[112:115], v[196:199], v[236:239], v[112:115]
    buffer_load_dwordx4 v[196:199], v242, s[12:15], s32 offen sc1
    s_add_u32 s23, s41, 10
    s_and_b32 s23, s23, 15
    s_lshl_b32 s23, s23, 6
    s_add_u32 s23, s23, s37
    s_add_u32 m0, s40, 18432
    s_nop 0
    buffer_load_dwordx4 v8, s[16:19], s23 offen lds
    s_waitcnt vmcnt(31)
    v_mfma_f32_16x16x32_bf16 v[32:35], v[200:203], v[224:227], v[32:35]
    v_mfma_f32_16x16x32_bf16 v[60:63], v[200:203], v[228:231], v[60:63]
    v_mfma_f32_16x16x32_bf16 v[88:91], v[200:203], v[232:235], v[88:91]
    v_mfma_f32_16x16x32_bf16 v[116:119], v[200:203], v[236:239], v[116:119]
    buffer_load_dwordx4 v[200:203], v242, s[12:15], s33 offen sc1
    s_waitcnt vmcnt(31)
    v_mfma_f32_16x16x32_bf16 v[36:39], v[204:207], v[224:227], v[36:39]
    v_mfma_f32_16x16x32_bf16 v[64:67], v[204:207], v[228:231], v[64:67]
    v_mfma_f32_16x16x32_bf16 v[92:95], v[204:207], v[232:235], v[92:95]
    v_mfma_f32_16x16x32_bf16 v[120:123], v[204:207], v[236:239], v[120:123]
    buffer_load_dwordx4 v[204:207], v242, s[12:15], s34 offen sc1
    s_add_u32 s23, s41, 10
    s_and_b32 s23, s23, 15
    s_lshl_b32 s23, s23, 6
    s_add_u32 s23, s23, s37
    s_add_u32 m0, s40, 19456
    s_nop 0
    buffer_load_dwordx4 v240, s[16:19], s23 offen lds
    s_waitcnt lgkmcnt(0)
    ds_read_b128 v[224:227], v241 offset:0
    ds_read_b128 v[228:231], v241 offset:2048
    ds_read_b128 v[232:235], v241 offset:4096
    ds_read_b128 v[236:239], v241 offset:6144
    s_waitcnt vmcnt(32)
    v_mfma_f32_16x16x32_bf16 v[12:15], v[124:127], v[208:211], v[12:15]
    v_mfma_f32_16x16x32_bf16 v[40:43], v[124:127], v[212:215], v[40:43]
    v_mfma_f32_16x16x32_bf16 v[68:71], v[124:127], v[216:219], v[68:71]
    v_mfma_f32_16x16x32_bf16 v[96:99], v[124:127], v[220:223], v[96:99]
    s_add_u32 s23, s41, 9
    s_and_b32 s23, s23, 15
    s_lshl_b32 s23, s23, 10
    v_add_u32 v242, s23, v7
    buffer_load_dwordx4 v[124:127], v242, s[12:15], s28 offen sc1
    s_add_u32 s23, s41, 10
    s_and_b32 s23, s23, 15
    s_lshl_b32 s23, s23, 6
    s_add_u32 s23, s23, s38
    s_add_u32 m0, s40, 20480
    s_nop 0
    buffer_load_dwordx4 v8, s[16:19], s23 offen lds
    s_waitcnt vmcnt(32)
    v_mfma_f32_16x16x32_bf16 v[16:19], v[128:131], v[208:211], v[16:19]
    v_mfma_f32_16x16x32_bf16 v[44:47], v[128:131], v[212:215], v[44:47]
    v_mfma_f32_16x16x32_bf16 v[72:75], v[128:131], v[216:219], v[72:75]
    v_mfma_f32_16x16x32_bf16 v[100:103], v[128:131], v[220:223], v[100:103]
    buffer_load_dwordx4 v[128:131], v242, s[12:15], s29 offen sc1
    s_waitcnt vmcnt(32)
    v_mfma_f32_16x16x32_bf16 v[20:23], v[132:135], v[208:211], v[20:23]
    v_mfma_f32_16x16x32_bf16 v[48:51], v[132:135], v[212:215], v[48:51]
    v_mfma_f32_16x16x32_bf16 v[76:79], v[132:135], v[216:219], v[76:79]
    v_mfma_f32_16x16x32_bf16 v[104:107], v[132:135], v[220:223], v[104:107]
    buffer_load_dwordx4 v[132:135], v242, s[12:15], s30 offen sc1
    s_add_u32 s23, s41, 10
    s_and_b32 s23, s23, 15
    s_lshl_b32 s23, s23, 6
    s_add_u32 s23, s23, s38
    s_add_u32 m0, s40, 21504
    s_nop 0
    buffer_load_dwordx4 v240, s[16:19], s23 offen lds
    s_waitcnt vmcnt(32)
    v_mfma_f32_16x16x32_bf16 v[24:27], v[136:139], v[208:211], v[24:27]
    v_mfma_f32_16x16x32_bf16 v[52:55], v[136:139], v[212:215], v[52:55]
    v_mfma_f32_16x16x32_bf16 v[80:83], v[136:139], v[216:219], v[80:83]
    v_mfma_f32_16x16x32_bf16 v[108:111], v[136:139], v[220:223], v[108:111]
    buffer_load_dwordx4 v[136:139], v242, s[12:15], s31 offen sc1
    s_waitcnt vmcnt(32)
    v_mfma_f32_16x16x32_bf16 v[28:31], v[140:143], v[208:211], v[28:31]
    v_mfma_f32_16x16x32_bf16 v[56:59], v[140:143], v[212:215], v[56:59]
    v_mfma_f32_16x16x32_bf16 v[84:87], v[140:143], v[216:219], v[84:87]
    v_mfma_f32_16x16x32_bf16 v[112:115], v[140:143], v[220:223], v[112:115]
    buffer_load_dwordx4 v[140:143], v242, s[12:15], s32 offen sc1
    s_add_u32 s23, s41, 10
    s_and_b32 s23, s23, 15
    s_lshl_b32 s23, s23, 6
    s_add_u32 s23, s23, s39
    s_add_u32 m0, s40, 22528
    s_nop 0
    buffer_load_dwordx4 v8, s[16:19], s23 offen lds
    s_waitcnt vmcnt(32)
    v_mfma_f32_16x16x32_bf16 v[32:35], v[144:147], v[208:211], v[32:35]
    v_mfma_f32_16x16x32_bf16 v[60:63], v[144:147], v[212:215], v[60:63]
    v_mfma_f32_16x16x32_bf16 v[88:91], v[144:147], v[216:219], v[88:91]
    v_mfma_f32_16x16x32_bf16 v[116:119], v[144:147], v[220:223], v[116:119]
    buffer_load_dwordx4 v[144:147], v242, s[12:15], s33 offen sc1
    s_waitcnt vmcnt(32)
    v_mfma_f32_16x16x32_bf16 v[36:39], v[148:151], v[208:211], v[36:39]
    v_mfma_f32_16x16x32_bf16 v[64:67], v[148:151], v[212:215], v[64:67]
    v_mfma_f32_16x16x32_bf16 v[92:95], v[148:151], v[216:219], v[92:95]
    v_mfma_f32_16x16x32_bf16 v[120:123], v[148:151], v[220:223], v[120:123]
    buffer_load_dwordx4 v[148:151], v242, s[12:15], s34 offen sc1
    s_add_u32 s23, s41, 10
    s_and_b32 s23, s23, 15
    s_lshl_b32 s23, s23, 6
    s_add_u32 s23, s23, s39
    s_add_u32 m0, s40, 23552
    s_nop 0
    buffer_load_dwordx4 v240, s[16:19], s23 offen lds
    s_waitcnt vmcnt(22)
    s_waitcnt lgkmcnt(0)
    ds_read_b128 v[208:211], v9 offset:8192
    ds_read_b128 v[212:215], v9 offset:10240
    ds_read_b128 v[216:219], v9 offset:12288
    ds_read_b128 v[220:223], v9 offset:14336
    v_mfma_f32_16x16x32_bf16 v[12:15], v[152:155], v[224:227], v[12:15]
    v_mfma_f32_16x16x32_bf16 v[40:43], v[152:155], v[228:231], v[40:43]
    v_mfma_f32_16x16x32_bf16 v[68:71], v[152:155], v[232:235], v[68:71]
    v_mfma_f32_16x16x32_bf16 v[96:99], v[152:155], v[236:239], v[96:99]
    s_add_u32 s23, s41, 10
    s_and_b32 s23, s23, 15
    s_lshl_b32 s23, s23, 10
    v_add_u32 v242, s23, v7
    buffer_load_dwordx4 v[152:155], v242, s[12:15], s28 offen sc1
    s_add_u32 s23, s41, 12
    s_and_b32 s23, s23, 15
    s_lshl_b32 s23, s23, 6
    s_add_u32 s23, s23, s36
    s_add_u32 m0, s40, 0
    s_nop 0
    buffer_load_dwordx4 v8, s[16:19], s23 offen lds
    v_mfma_f32_16x16x32_bf16 v[16:19], v[156:159], v[224:227], v[16:19]
    v_mfma_f32_16x16x32_bf16 v[44:47], v[156:159], v[228:231], v[44:47]
    v_mfma_f32_16x16x32_bf16 v[72:75], v[156:159], v[232:235], v[72:75]
    v_mfma_f32_16x16x32_bf16 v[100:103], v[156:159], v[236:239], v[100:103]
    buffer_load_dwordx4 v[156:159], v242, s[12:15], s29 offen sc1
    v_mfma_f32_16x16x32_bf16 v[20:23], v[160:163], v[224:227], v[20:23]
    v_mfma_f32_16x16x32_bf16 v[48:51], v[160:163], v[228:231], v[48:51]
    v_mfma_f32_16x16x32_bf16 v[76:79], v[160:163], v[232:235], v[76:79]
    v_mfma_f32_16x16x32_bf16 v[104:107], v[160:163], v[236:239], v[104:107]
    buffer_load_dwordx4 v[160:163], v242, s[12:15], s30 offen sc1
    s_add_u32 s23, s41, 12
    s_and_b32 s23, s23, 15
    s_lshl_b32 s23, s23, 6
    s_add_u32 s23, s23, s36
    s_add_u32 m0, s40, 1024
    s_nop 0
    buffer_load_dwordx4 v240, s[16:19], s23 offen lds
    v_mfma_f32_16x16x32_bf16 v[24:27], v[164:167], v[224:227], v[24:27]
    v_mfma_f32_16x16x32_bf16 v[52:55], v[164:167], v[228:231], v[52:55]
    v_mfma_f32_16x16x32_bf16 v[80:83], v[164:167], v[232:235], v[80:83]
    v_mfma_f32_16x16x32_bf16 v[108:111], v[164:167], v[236:239], v[108:111]
    buffer_load_dwordx4 v[164:167], v242, s[12:15], s31 offen sc1
    v_mfma_f32_16x16x32_bf16 v[28:31], v[168:171], v[224:227], v[28:31]
    v_mfma_f32_16x16x32_bf16 v[56:59], v[168:171], v[228:231], v[56:59]
    v_mfma_f32_16x16x32_bf16 v[84:87], v[168:171], v[232:235], v[84:87]
    v_mfma_f32_16x16x32_bf16 v[112:115], v[168:171], v[236:239], v[112:115]
    buffer_load_dwordx4 v[168:171], v242, s[12:15], s32 offen sc1
    s_add_u32 s23, s41, 12
    s_and_b32 s23, s23, 15
    s_lshl_b32 s23, s23, 6
    s_add_u32 s23, s23, s37
    s_add_u32 m0, s40, 2048
    s_nop 0
    buffer_load_dwordx4 v8, s[16:19], s23 offen lds
    v_mfma_f32_16x16x32_bf16 v[32:35], v[172:175], v[224:227], v[32:35]
    v_mfma_f32_16x16x32_bf16 v[60:63], v[172:175], v[228:231], v[60:63]
    v_mfma_f32_16x16x32_bf16 v[88:91], v[172:175], v[232:235], v[88:91]
    v_mfma_f32_16x16x32_bf16 v[116:119], v[172:175], v[236:239], v[116:119]
    buffer_load_dwordx4 v[172:175], v242, s[12:15], s33 offen sc1
    v_mfma_f32_16x16x32_bf16 v[36:39], v[176:179], v[224:227], v[36:39]
    v_mfma_f32_16x16x32_bf16 v[64:67], v[176:179], v[228:231], v[64:67]
    v_mfma_f32_16x16x32_bf16 v[92:95], v[176:179], v[232:235], v[92:95]
    v_mfma_f32_16x16x32_bf16 v[120:123], v[176:179], v[236:239], v[120:123]
    buffer_load_dwordx4 v[176:179], v242, s[12:15], s34 offen sc1
    s_add_u32 s23, s41, 12
    s_and_b32 s23, s23, 15
    s_lshl_b32 s23, s23, 6
    s_add_u32 s23, s23, s37
    s_add_u32 m0, s40, 3072
    s_nop 0
    buffer_load_dwordx4 v240, s[16:19], s23 offen lds
    s_waitcnt lgkmcnt(0)
    ds_read_b128 v[224:227], v241 offset:8192
    ds_read_b128 v[228:231], v241 offset:10240
    ds_read_b128 v[232:235], v241 offset:12288
    ds_read_b128 v[236:239], v241 offset:14336
    s_lshl_b32 s23, s20, 8
    s_lshr_b32 s24, s21, 1
    s_lshl_b32 s24, s24, 6
    s_add_u32 s23, s23, s24
    s_add_u32 s23, s23, 15564800
    buffer_load_dword v252, v253, s[12:15], s23 offen sc1
    s_waitcnt vmcnt(33)
    v_mfma_f32_16x16x32_bf16 v[12:15], v[180:183], v[208:211], v[12:15]
    v_mfma_f32_16x16x32_bf16 v[40:43], v[180:183], v[212:215], v[40:43]
    v_mfma_f32_16x16x32_bf16 v[68:71], v[180:183], v[216:219], v[68:71]
    v_mfma_f32_16x16x32_bf16 v[96:99], v[180:183], v[220:223], v[96:99]
    s_add_u32 s23, s41, 11
    s_and_b32 s23, s23, 15
    s_lshl_b32 s23, s23, 10
    v_add_u32 v242, s23, v7
    buffer_load_dwordx4 v[180:183], v242, s[12:15], s28 offen sc1
    s_add_u32 s23, s41, 12
    s_and_b32 s23, s23, 15
    s_lshl_b32 s23, s23, 6
    s_add_u32 s23, s23, s38
    s_add_u32 m0, s40, 4096
    s_nop 0
    buffer_load_dwordx4 v8, s[16:19], s23 offen lds
    s_waitcnt vmcnt(33)
    v_mfma_f32_16x16x32_bf16 v[16:19], v[184:187], v[208:211], v[16:19]
    v_mfma_f32_16x16x32_bf16 v[44:47], v[184:187], v[212:215], v[44:47]
    v_mfma_f32_16x16x32_bf16 v[72:75], v[184:187], v[216:219], v[72:75]
    v_mfma_f32_16x16x32_bf16 v[100:103], v[184:187], v[220:223], v[100:103]
    buffer_load_dwordx4 v[184:187], v242, s[12:15], s29 offen sc1
    s_waitcnt vmcnt(33)
    v_mfma_f32_16x16x32_bf16 v[20:23], v[188:191], v[208:211], v[20:23]
    v_mfma_f32_16x16x32_bf16 v[48:51], v[188:191], v[212:215], v[48:51]
    v_mfma_f32_16x16x32_bf16 v[76:79], v[188:191], v[216:219], v[76:79]
    v_mfma_f32_16x16x32_bf16 v[104:107], v[188:191], v[220:223], v[104:107]
    buffer_load_dwordx4 v[188:191], v242, s[12:15], s30 offen sc1
    s_add_u32 s23, s41, 12
    s_and_b32 s23, s23, 15
    s_lshl_b32 s23, s23, 6
    s_add_u32 s23, s23, s38
    s_add_u32 m0, s40, 5120
    s_nop 0
    buffer_load_dwordx4 v240, s[16:19], s23 offen lds
    s_waitcnt vmcnt(33)
    v_mfma_f32_16x16x32_bf16 v[24:27], v[192:195], v[208:211], v[24:27]
    v_mfma_f32_16x16x32_bf16 v[52:55], v[192:195], v[212:215], v[52:55]
    v_mfma_f32_16x16x32_bf16 v[80:83], v[192:195], v[216:219], v[80:83]
    v_mfma_f32_16x16x32_bf16 v[108:111], v[192:195], v[220:223], v[108:111]
    buffer_load_dwordx4 v[192:195], v242, s[12:15], s31 offen sc1
    s_waitcnt vmcnt(33)
    v_mfma_f32_16x16x32_bf16 v[28:31], v[196:199], v[208:211], v[28:31]
    v_mfma_f32_16x16x32_bf16 v[56:59], v[196:199], v[212:215], v[56:59]
    v_mfma_f32_16x16x32_bf16 v[84:87], v[196:199], v[216:219], v[84:87]
    v_mfma_f32_16x16x32_bf16 v[112:115], v[196:199], v[220:223], v[112:115]
    buffer_load_dwordx4 v[196:199], v242, s[12:15], s32 offen sc1
    s_add_u32 s23, s41, 12
    s_and_b32 s23, s23, 15
    s_lshl_b32 s23, s23, 6
    s_add_u32 s23, s23, s39
    s_add_u32 m0, s40, 6144
    s_nop 0
    buffer_load_dwordx4 v8, s[16:19], s23 offen lds
    s_waitcnt vmcnt(33)
    v_mfma_f32_16x16x32_bf16 v[32:35], v[200:203], v[208:211], v[32:35]
    v_mfma_f32_16x16x32_bf16 v[60:63], v[200:203], v[212:215], v[60:63]
    v_mfma_f32_16x16x32_bf16 v[88:91], v[200:203], v[216:219], v[88:91]
    v_mfma_f32_16x16x32_bf16 v[116:119], v[200:203], v[220:223], v[116:119]
    buffer_load_dwordx4 v[200:203], v242, s[12:15], s33 offen sc1
    s_waitcnt vmcnt(33)
    v_mfma_f32_16x16x32_bf16 v[36:39], v[204:207], v[208:211], v[36:39]
    v_mfma_f32_16x16x32_bf16 v[64:67], v[204:207], v[212:215], v[64:67]
    v_mfma_f32_16x16x32_bf16 v[92:95], v[204:207], v[216:219], v[92:95]
    v_mfma_f32_16x16x32_bf16 v[120:123], v[204:207], v[220:223], v[120:123]
    buffer_load_dwordx4 v[204:207], v242, s[12:15], s34 offen sc1
    s_add_u32 s23, s41, 12
    s_and_b32 s23, s23, 15
    s_lshl_b32 s23, s23, 6
    s_add_u32 s23, s23, s39
    s_add_u32 m0, s40, 7168
    s_nop 0
    buffer_load_dwordx4 v240, s[16:19], s23 offen lds
    s_waitcnt vmcnt(23)
    s_waitcnt lgkmcnt(0)
    ds_read_b128 v[208:211], v9 offset:16384
    ds_read_b128 v[212:215], v9 offset:18432
    ds_read_b128 v[216:219], v9 offset:20480
    ds_read_b128 v[220:223], v9 offset:22528
    v_mfma_f32_16x16x32_bf16 v[12:15], v[124:127], v[224:227], v[12:15]
    v_mfma_f32_16x16x32_bf16 v[40:43], v[124:127], v[228:231], v[40:43]
    v_mfma_f32_16x16x32_bf16 v[68:71], v[124:127], v[232:235], v[68:71]
    v_mfma_f32_16x16x32_bf16 v[96:99], v[124:127], v[236:239], v[96:99]
    s_add_u32 s23, s41, 12
    s_and_b32 s23, s23, 15
    s_lshl_b32 s23, s23, 10
    v_add_u32 v242, s23, v7
    buffer_load_dwordx4 v[124:127], v242, s[12:15], s28 offen sc1
    s_add_u32 s23, s41, 14
    s_and_b32 s23, s23, 15
    s_lshl_b32 s23, s23, 6
    s_add_u32 s23, s23, s36
    s_add_u32 m0, s40, 8192
    s_nop 0
    buffer_load_dwordx4 v8, s[16:19], s23 offen lds
    v_mfma_f32_16x16x32_bf16 v[16:19], v[128:131], v[224:227], v[16:19]
    v_mfma_f32_16x16x32_bf16 v[44:47], v[128:131], v[228:231], v[44:47]
    v_mfma_f32_16x16x32_bf16 v[72:75], v[128:131], v[232:235], v[72:75]
    v_mfma_f32_16x16x32_bf16 v[100:103], v[128:131], v[236:239], v[100:103]
    buffer_load_dwordx4 v[128:131], v242, s[12:15], s29 offen sc1
    v_mfma_f32_16x16x32_bf16 v[20:23], v[132:135], v[224:227], v[20:23]
    v_mfma_f32_16x16x32_bf16 v[48:51], v[132:135], v[228:231], v[48:51]
    v_mfma_f32_16x16x32_bf16 v[76:79], v[132:135], v[232:235], v[76:79]
    v_mfma_f32_16x16x32_bf16 v[104:107], v[132:135], v[236:239], v[104:107]
    buffer_load_dwordx4 v[132:135], v242, s[12:15], s30 offen sc1
    s_add_u32 s23, s41, 14
    s_and_b32 s23, s23, 15
    s_lshl_b32 s23, s23, 6
    s_add_u32 s23, s23, s36
    s_add_u32 m0, s40, 9216
    s_nop 0
    buffer_load_dwordx4 v240, s[16:19], s23 offen lds
    v_mfma_f32_16x16x32_bf16 v[24:27], v[136:139], v[224:227], v[24:27]
    v_mfma_f32_16x16x32_bf16 v[52:55], v[136:139], v[228:231], v[52:55]
    v_mfma_f32_16x16x32_bf16 v[80:83], v[136:139], v[232:235], v[80:83]
    v_mfma_f32_16x16x32_bf16 v[108:111], v[136:139], v[236:239], v[108:111]
    buffer_load_dwordx4 v[136:139], v242, s[12:15], s31 offen sc1
    v_mfma_f32_16x16x32_bf16 v[28:31], v[140:143], v[224:227], v[28:31]
    v_mfma_f32_16x16x32_bf16 v[56:59], v[140:143], v[228:231], v[56:59]
    v_mfma_f32_16x16x32_bf16 v[84:87], v[140:143], v[232:235], v[84:87]
    v_mfma_f32_16x16x32_bf16 v[112:115], v[140:143], v[236:239], v[112:115]
    buffer_load_dwordx4 v[140:143], v242, s[12:15], s32 offen sc1
    s_add_u32 s23, s41, 14
    s_and_b32 s23, s23, 15
    s_lshl_b32 s23, s23, 6
    s_add_u32 s23, s23, s37
    s_add_u32 m0, s40, 10240
    s_nop 0
    buffer_load_dwordx4 v8, s[16:19], s23 offen lds
    v_mfma_f32_16x16x32_bf16 v[32:35], v[144:147], v[224:227], v[32:35]
    v_mfma_f32_16x16x32_bf16 v[60:63], v[144:147], v[228:231], v[60:63]
    v_mfma_f32_16x16x32_bf16 v[88:91], v[144:147], v[232:235], v[88:91]
    v_mfma_f32_16x16x32_bf16 v[116:119], v[144:147], v[236:239], v[116:119]
    buffer_load_dwordx4 v[144:147], v242, s[12:15], s33 offen sc1
    v_mfma_f32_16x16x32_bf16 v[36:39], v[148:151], v[224:227], v[36:39]
    v_mfma_f32_16x16x32_bf16 v[64:67], v[148:151], v[228:231], v[64:67]
    v_mfma_f32_16x16x32_bf16 v[92:95], v[148:151], v[232:235], v[92:95]
    v_mfma_f32_16x16x32_bf16 v[120:123], v[148:151], v[236:239], v[120:123]
    buffer_load_dwordx4 v[148:151], v242, s[12:15], s34 offen sc1
    s_add_u32 s23, s41, 14
    s_and_b32 s23, s23, 15
    s_lshl_b32 s23, s23, 6
    s_add_u32 s23, s23, s37
    s_add_u32 m0, s40, 11264
    s_nop 0
    buffer_load_dwordx4 v240, s[16:19], s23 offen lds
    s_waitcnt lgkmcnt(0)
    ds_read_b128 v[224:227], v241 offset:16384
    ds_read_b128 v[228:231], v241 offset:18432
    ds_read_b128 v[232:235], v241 offset:20480
    ds_read_b128 v[236:239], v241 offset:22528
    s_waitcnt vmcnt(33)
    v_mfma_f32_16x16x32_bf16 v[12:15], v[152:155], v[208:211], v[12:15]
    v_mfma_f32_16x16x32_bf16 v[40:43], v[152:155], v[212:215], v[40:43]
    v_mfma_f32_16x16x32_bf16 v[68:71], v[152:155], v[216:219], v[68:71]
    v_mfma_f32_16x16x32_bf16 v[96:99], v[152:155], v[220:223], v[96:99]
    s_add_u32 s23, s41, 13
    s_and_b32 s23, s23, 15
    s_lshl_b32 s23, s23, 10
    v_add_u32 v242, s23, v7
    buffer_load_dwordx4 v[152:155], v242, s[12:15], s28 offen sc1
    s_add_u32 s23, s41, 14
    s_and_b32 s23, s23, 15
    s_lshl_b32 s23, s23, 6
    s_add_u32 s23, s23, s38
    s_add_u32 m0, s40, 12288
    s_nop 0
    buffer_load_dwordx4 v8, s[16:19], s23 offen lds
    s_waitcnt vmcnt(33)
    v_mfma_f32_16x16x32_bf16 v[16:19], v[156:159], v[208:211], v[16:19]
    v_mfma_f32_16x16x32_bf16 v[44:47], v[156:159], v[212:215], v[44:47]
    v_mfma_f32_16x16x32_bf16 v[72:75], v[156:159], v[216:219], v[72:75]
    v_mfma_f32_16x16x32_bf16 v[100:103], v[156:159], v[220:223], v[100:103]
    buffer_load_dwordx4 v[156:159], v242, s[12:15], s29 offen sc1
    s_waitcnt vmcnt(33)
    v_mfma_f32_16x16x32_bf16 v[20:23], v[160:163], v[208:211], v[20:23]
    v_mfma_f32_16x16x32_bf16 v[48:51], v[160:163], v[212:215], v[48:51]
    v_mfma_f32_16x16x32_bf16 v[76:79], v[160:163], v[216:219], v[76:79]
    v_mfma_f32_16x16x32_bf16 v[104:107], v[160:163], v[220:223], v[104:107]
    buffer_load_dwordx4 v[160:163], v242, s[12:15], s30 offen sc1
    s_add_u32 s23, s41, 14
    s_and_b32 s23, s23, 15
    s_lshl_b32 s23, s23, 6
    s_add_u32 s23, s23, s38
    s_add_u32 m0, s40, 13312
    s_nop 0
    buffer_load_dwordx4 v240, s[16:19], s23 offen lds
    s_waitcnt vmcnt(33)
    v_mfma_f32_16x16x32_bf16 v[24:27], v[164:167], v[208:211], v[24:27]
    v_mfma_f32_16x16x32_bf16 v[52:55], v[164:167], v[212:215], v[52:55]
    v_mfma_f32_16x16x32_bf16 v[80:83], v[164:167], v[216:219], v[80:83]
    v_mfma_f32_16x16x32_bf16 v[108:111], v[164:167], v[220:223], v[108:111]
    buffer_load_dwordx4 v[164:167], v242, s[12:15], s31 offen sc1
    s_waitcnt vmcnt(33)
    v_mfma_f32_16x16x32_bf16 v[28:31], v[168:171], v[208:211], v[28:31]
    v_mfma_f32_16x16x32_bf16 v[56:59], v[168:171], v[212:215], v[56:59]
    v_mfma_f32_16x16x32_bf16 v[84:87], v[168:171], v[216:219], v[84:87]
    v_mfma_f32_16x16x32_bf16 v[112:115], v[168:171], v[220:223], v[112:115]
    buffer_load_dwordx4 v[168:171], v242, s[12:15], s32 offen sc1
    s_add_u32 s23, s41, 14
    s_and_b32 s23, s23, 15
    s_lshl_b32 s23, s23, 6
    s_add_u32 s23, s23, s39
    s_add_u32 m0, s40, 14336
    s_nop 0
    buffer_load_dwordx4 v8, s[16:19], s23 offen lds
    s_waitcnt vmcnt(33)
    v_mfma_f32_16x16x32_bf16 v[32:35], v[172:175], v[208:211], v[32:35]
    v_mfma_f32_16x16x32_bf16 v[60:63], v[172:175], v[212:215], v[60:63]
    v_mfma_f32_16x16x32_bf16 v[88:91], v[172:175], v[216:219], v[88:91]
    v_mfma_f32_16x16x32_bf16 v[116:119], v[172:175], v[220:223], v[116:119]
    buffer_load_dwordx4 v[172:175], v242, s[12:15], s33 offen sc1
    s_waitcnt vmcnt(33)
    v_mfma_f32_16x16x32_bf16 v[36:39], v[176:179], v[208:211], v[36:39]
    v_mfma_f32_16x16x32_bf16 v[64:67], v[176:179], v[212:215], v[64:67]
    v_mfma_f32_16x16x32_bf16 v[92:95], v[176:179], v[216:219], v[92:95]
    v_mfma_f32_16x16x32_bf16 v[120:123], v[176:179], v[220:223], v[120:123]
    buffer_load_dwordx4 v[176:179], v242, s[12:15], s34 offen sc1
    s_add_u32 s23, s41, 14
    s_and_b32 s23, s23, 15
    s_lshl_b32 s23, s23, 6
    s_add_u32 s23, s23, s39
    s_add_u32 m0, s40, 15360
    s_nop 0
    buffer_load_dwordx4 v240, s[16:19], s23 offen lds
    s_waitcnt vmcnt(22)
    s_waitcnt lgkmcnt(0)
    ds_read_b128 v[208:211], v9 offset:0
    ds_read_b128 v[212:215], v9 offset:2048
    ds_read_b128 v[216:219], v9 offset:4096
    ds_read_b128 v[220:223], v9 offset:6144
    v_mfma_f32_16x16x32_bf16 v[12:15], v[180:183], v[224:227], v[12:15]
    v_mfma_f32_16x16x32_bf16 v[40:43], v[180:183], v[228:231], v[40:43]
    v_mfma_f32_16x16x32_bf16 v[68:71], v[180:183], v[232:235], v[68:71]
    v_mfma_f32_16x16x32_bf16 v[96:99], v[180:183], v[236:239], v[96:99]
    s_add_u32 s23, s41, 14
    s_and_b32 s23, s23, 15
    s_lshl_b32 s23, s23, 10
    v_add_u32 v242, s23, v7
    buffer_load_dwordx4 v[180:183], v242, s[12:15], s28 offen sc1
    v_mfma_f32_16x16x32_bf16 v[16:19], v[184:187], v[224:227], v[16:19]
    v_mfma_f32_16x16x32_bf16 v[44:47], v[184:187], v[228:231], v[44:47]
    v_mfma_f32_16x16x32_bf16 v[72:75], v[184:187], v[232:235], v[72:75]
    v_mfma_f32_16x16x32_bf16 v[100:103], v[184:187], v[236:239], v[100:103]
    buffer_load_dwordx4 v[184:187], v242, s[12:15], s29 offen sc1
    v_mfma_f32_16x16x32_bf16 v[20:23], v[188:191], v[224:227], v[20:23]
    v_mfma_f32_16x16x32_bf16 v[48:51], v[188:191], v[228:231], v[48:51]
    v_mfma_f32_16x16x32_bf16 v[76:79], v[188:191], v[232:235], v[76:79]
    v_mfma_f32_16x16x32_bf16 v[104:107], v[188:191], v[236:239], v[104:107]
    buffer_load_dwordx4 v[188:191], v242, s[12:15], s30 offen sc1
    v_mfma_f32_16x16x32_bf16 v[24:27], v[192:195], v[224:227], v[24:27]
    v_mfma_f32_16x16x32_bf16 v[52:55], v[192:195], v[228:231], v[52:55]
    v_mfma_f32_16x16x32_bf16 v[80:83], v[192:195], v[232:235], v[80:83]
    v_mfma_f32_16x16x32_bf16 v[108:111], v[192:195], v[236:239], v[108:111]
    buffer_load_dwordx4 v[192:195], v242, s[12:15], s31 offen sc1
    v_mfma_f32_16x16x32_bf16 v[28:31], v[196:199], v[224:227], v[28:31]
    v_mfma_f32_16x16x32_bf16 v[56:59], v[196:199], v[228:231], v[56:59]
    v_mfma_f32_16x16x32_bf16 v[84:87], v[196:199], v[232:235], v[84:87]
    v_mfma_f32_16x16x32_bf16 v[112:115], v[196:199], v[236:239], v[112:115]
    buffer_load_dwordx4 v[196:199], v242, s[12:15], s32 offen sc1
    v_mfma_f32_16x16x32_bf16 v[32:35], v[200:203], v[224:227], v[32:35]
    v_mfma_f32_16x16x32_bf16 v[60:63], v[200:203], v[228:231], v[60:63]
    v_mfma_f32_16x16x32_bf16 v[88:91], v[200:203], v[232:235], v[88:91]
    v_mfma_f32_16x16x32_bf16 v[116:119], v[200:203], v[236:239], v[116:119]
    buffer_load_dwordx4 v[200:203], v242, s[12:15], s33 offen sc1
    v_mfma_f32_16x16x32_bf16 v[36:39], v[204:207], v[224:227], v[36:39]
    v_mfma_f32_16x16x32_bf16 v[64:67], v[204:207], v[228:231], v[64:67]
    v_mfma_f32_16x16x32_bf16 v[92:95], v[204:207], v[232:235], v[92:95]
    v_mfma_f32_16x16x32_bf16 v[120:123], v[204:207], v[236:239], v[120:123]
    buffer_load_dwordx4 v[204:207], v242, s[12:15], s34 offen sc1
    s_waitcnt lgkmcnt(0)
    ds_read_b128 v[224:227], v241 offset:0
    ds_read_b128 v[228:231], v241 offset:2048
    ds_read_b128 v[232:235], v241 offset:4096
    ds_read_b128 v[236:239], v241 offset:6144
    s_waitcnt vmcnt(28)
    v_mfma_f32_16x16x32_bf16 v[12:15], v[124:127], v[208:211], v[12:15]
    v_mfma_f32_16x16x32_bf16 v[40:43], v[124:127], v[212:215], v[40:43]
    v_mfma_f32_16x16x32_bf16 v[68:71], v[124:127], v[216:219], v[68:71]
    v_mfma_f32_16x16x32_bf16 v[96:99], v[124:127], v[220:223], v[96:99]
    s_add_u32 s23, s41, 15
    s_and_b32 s23, s23, 15
    s_lshl_b32 s23, s23, 10
    v_add_u32 v242, s23, v7
    buffer_load_dwordx4 v[124:127], v242, s[12:15], s28 offen sc1
    s_waitcnt vmcnt(27)
    v_mfma_f32_16x16x32_bf16 v[16:19], v[128:131], v[208:211], v[16:19]
    v_mfma_f32_16x16x32_bf16 v[44:47], v[128:131], v[212:215], v[44:47]
    v_mfma_f32_16x16x32_bf16 v[72:75], v[128:131], v[216:219], v[72:75]
    v_mfma_f32_16x16x32_bf16 v[100:103], v[128:131], v[220:223], v[100:103]
    buffer_load_dwordx4 v[128:131], v242, s[12:15], s29 offen sc1
    s_waitcnt vmcnt(27)
    v_mfma_f32_16x16x32_bf16 v[20:23], v[132:135], v[208:211], v[20:23]
    v_mfma_f32_16x16x32_bf16 v[48:51], v[132:135], v[212:215], v[48:51]
    v_mfma_f32_16x16x32_bf16 v[76:79], v[132:135], v[216:219], v[76:79]
    v_mfma_f32_16x16x32_bf16 v[104:107], v[132:135], v[220:223], v[104:107]
    buffer_load_dwordx4 v[132:135], v242, s[12:15], s30 offen sc1
    s_waitcnt vmcnt(26)
    v_mfma_f32_16x16x32_bf16 v[24:27], v[136:139], v[208:211], v[24:27]
    v_mfma_f32_16x16x32_bf16 v[52:55], v[136:139], v[212:215], v[52:55]
    v_mfma_f32_16x16x32_bf16 v[80:83], v[136:139], v[216:219], v[80:83]
    v_mfma_f32_16x16x32_bf16 v[108:111], v[136:139], v[220:223], v[108:111]
    buffer_load_dwordx4 v[136:139], v242, s[12:15], s31 offen sc1
    s_waitcnt vmcnt(26)
    v_mfma_f32_16x16x32_bf16 v[28:31], v[140:143], v[208:211], v[28:31]
    v_mfma_f32_16x16x32_bf16 v[56:59], v[140:143], v[212:215], v[56:59]
    v_mfma_f32_16x16x32_bf16 v[84:87], v[140:143], v[216:219], v[84:87]
    v_mfma_f32_16x16x32_bf16 v[112:115], v[140:143], v[220:223], v[112:115]
    buffer_load_dwordx4 v[140:143], v242, s[12:15], s32 offen sc1
    s_waitcnt vmcnt(25)
    v_mfma_f32_16x16x32_bf16 v[32:35], v[144:147], v[208:211], v[32:35]
    v_mfma_f32_16x16x32_bf16 v[60:63], v[144:147], v[212:215], v[60:63]
    v_mfma_f32_16x16x32_bf16 v[88:91], v[144:147], v[216:219], v[88:91]
    v_mfma_f32_16x16x32_bf16 v[116:119], v[144:147], v[220:223], v[116:119]
    buffer_load_dwordx4 v[144:147], v242, s[12:15], s33 offen sc1
    s_waitcnt vmcnt(25)
    v_mfma_f32_16x16x32_bf16 v[36:39], v[148:151], v[208:211], v[36:39]
    v_mfma_f32_16x16x32_bf16 v[64:67], v[148:151], v[212:215], v[64:67]
    v_mfma_f32_16x16x32_bf16 v[92:95], v[148:151], v[216:219], v[92:95]
    v_mfma_f32_16x16x32_bf16 v[120:123], v[148:151], v[220:223], v[120:123]
    buffer_load_dwordx4 v[148:151], v242, s[12:15], s34 offen sc1
    s_waitcnt vmcnt(14)
    s_waitcnt lgkmcnt(0)
    ds_read_b128 v[208:211], v9 offset:8192
    ds_read_b128 v[212:215], v9 offset:10240
    ds_read_b128 v[216:219], v9 offset:12288
    ds_read_b128 v[220:223], v9 offset:14336
    v_mfma_f32_16x16x32_bf16 v[12:15], v[152:155], v[224:227], v[12:15]
    v_mfma_f32_16x16x32_bf16 v[40:43], v[152:155], v[228:231], v[40:43]
    v_mfma_f32_16x16x32_bf16 v[68:71], v[152:155], v[232:235], v[68:71]
    v_mfma_f32_16x16x32_bf16 v[96:99], v[152:155], v[236:239], v[96:99]
    v_mfma_f32_16x16x32_bf16 v[16:19], v[156:159], v[224:227], v[16:19]
    v_mfma_f32_16x16x32_bf16 v[44:47], v[156:159], v[228:231], v[44:47]
    v_mfma_f32_16x16x32_bf16 v[72:75], v[156:159], v[232:235], v[72:75]
    v_mfma_f32_16x16x32_bf16 v[100:103], v[156:159], v[236:239], v[100:103]
    v_mfma_f32_16x16x32_bf16 v[20:23], v[160:163], v[224:227], v[20:23]
    v_mfma_f32_16x16x32_bf16 v[48:51], v[160:163], v[228:231], v[48:51]
    v_mfma_f32_16x16x32_bf16 v[76:79], v[160:163], v[232:235], v[76:79]
    v_mfma_f32_16x16x32_bf16 v[104:107], v[160:163], v[236:239], v[104:107]
    v_mfma_f32_16x16x32_bf16 v[24:27], v[164:167], v[224:227], v[24:27]
    v_mfma_f32_16x16x32_bf16 v[52:55], v[164:167], v[228:231], v[52:55]
    v_mfma_f32_16x16x32_bf16 v[80:83], v[164:167], v[232:235], v[80:83]
    v_mfma_f32_16x16x32_bf16 v[108:111], v[164:167], v[236:239], v[108:111]
    v_mfma_f32_16x16x32_bf16 v[28:31], v[168:171], v[224:227], v[28:31]
    v_mfma_f32_16x16x32_bf16 v[56:59], v[168:171], v[228:231], v[56:59]
    v_mfma_f32_16x16x32_bf16 v[84:87], v[168:171], v[232:235], v[84:87]
    v_mfma_f32_16x16x32_bf16 v[112:115], v[168:171], v[236:239], v[112:115]
    v_mfma_f32_16x16x32_bf16 v[32:35], v[172:175], v[224:227], v[32:35]
    v_mfma_f32_16x16x32_bf16 v[60:63], v[172:175], v[228:231], v[60:63]
    v_mfma_f32_16x16x32_bf16 v[88:91], v[172:175], v[232:235], v[88:91]
    v_mfma_f32_16x16x32_bf16 v[116:119], v[172:175], v[236:239], v[116:119]
    v_mfma_f32_16x16x32_bf16 v[36:39], v[176:179], v[224:227], v[36:39]
    v_mfma_f32_16x16x32_bf16 v[64:67], v[176:179], v[228:231], v[64:67]
    v_mfma_f32_16x16x32_bf16 v[92:95], v[176:179], v[232:235], v[92:95]
    v_mfma_f32_16x16x32_bf16 v[120:123], v[176:179], v[236:239], v[120:123]
    v_cmp_ne_u32 vcc, v250, v252
    s_and_b64 vcc, vcc, 0xffff
    s_cmp_eq_u64 vcc, 0
    s_cbranch_scc1 KF_ZOK
    s_lshl_b32 s23, s20, 8
    s_lshr_b32 s24, s21, 1
    s_lshl_b32 s24, s24, 6
    s_add_u32 s23, s23, s24
    s_add_u32 s23, s23, 15564800
    s_mov_b32 s25, 0
KF_PL50:
    buffer_load_dword v252, v253, s[12:15], s23 offen sc1
    s_waitcnt vmcnt(0)
KF_PC50:
    v_cmp_ne_u32 vcc, v250, v252
    s_and_b64 vcc, vcc, 0xffff
    s_cmp_eq_u64 vcc, 0
    s_cbranch_scc1 KF_PG50
    s_sleep 4
    s_add_u32 s25, s25, 1
    s_cmp_lt_u32 s25, 0x40000
    s_cbranch_scc1 KF_PL50
KF_PG50:
KF_ZOK:
    s_lshl_b32 s23, s20, 6
    s_lshl_b32 s24, s22, 4
    s_add_u32 s23, s23, s24
    v_add_u32 v168, s23, v2
    v_lshlrev_b32 v168, 1, v168
    global_load_ushort v168, v168, s[10:11]
    s_lshl_b32 s23, s20, 2
    s_add_u32 s23, s23, s22
    s_mul_i32 s24, s23, 56
    s_mul_i32 s25, s21, 7
    s_add_u32 s24, s24, s25
    s_lshl_b32 s24, s24, 9
    s_add_u32 s25, s24, 9502720
    s_add_u32 s24, s24, 2162688
    v_lshlrev_b32 v170, 3, v1
    buffer_load_dwordx2 v[152:153], v170, s[12:15], s24 offen offset:0 sc1
    buffer_load_dwordx2 v[154:155], v170, s[12:15], s24 offen offset:512 sc1
    buffer_load_dwordx2 v[156:157], v170, s[12:15], s24 offen offset:1024 sc1
    buffer_load_dwordx2 v[158:159], v170, s[12:15], s24 offen offset:1536 sc1
    buffer_load_dwordx2 v[160:161], v170, s[12:15], s24 offen offset:2048 sc1
    buffer_load_dwordx2 v[162:163], v170, s[12:15], s24 offen offset:2560 sc1
    buffer_load_dwordx2 v[164:165], v170, s[12:15], s24 offen offset:3072 sc1
    v_lshrrev_b32 v170, 1, v3
    v_lshl_add_u32 v170, v170, 4, v2
    v_lshlrev_b32 v170, 4, v170
    v_and_b32 v172, 1, v3
    v_lshl_add_u32 v170, v172, 9, v170
    s_xor_b32 s23, s22, 0
    s_mul_i32 s23, s23, 24576
    s_add_u32 s23, s23, 63232
    v_lshl_add_u32 v172, v1, 4, s23
    s_xor_b32 s23, s22, 1
    s_mul_i32 s23, s23, 24576
    s_add_u32 s23, s23, 63232
    v_lshl_add_u32 v173, v1, 4, s23
    s_xor_b32 s23, s22, 2
    s_mul_i32 s23, s23, 24576
    s_add_u32 s23, s23, 63232
    v_lshl_add_u32 v174, v1, 4, s23
    s_xor_b32 s23, s22, 3
    s_mul_i32 s23, s23, 24576
    s_add_u32 s23, s23, 63232
    v_lshl_add_u32 v175, v1, 4, s23
    s_waitcnt lgkmcnt(0)
    ds_read_b128 v[224:227], v241 offset:8192
    ds_read_b128 v[228:231], v241 offset:10240
    ds_read_b128 v[232:235], v241 offset:12288
    ds_read_b128 v[236:239], v241 offset:14336
    s_waitcnt lgkmcnt(0)
    s_waitcnt vmcnt(8)
    v_mfma_f32_16x16x32_bf16 v[40:43], v[180:183], v[212:215], v[40:43]
    v_mfma_f32_16x16x32_bf16 v[40:43], v[124:127], v[228:231], v[40:43]
    v_mfma_f32_16x16x32_bf16 v[44:47], v[184:187], v[212:215], v[44:47]
    v_mfma_f32_16x16x32_bf16 v[44:47], v[128:131], v[228:231], v[44:47]
    v_mfma_f32_16x16x32_bf16 v[48:51], v[188:191], v[212:215], v[48:51]
    v_mfma_f32_16x16x32_bf16 v[48:51], v[132:135], v[228:231], v[48:51]
    s_nop 3
    ds_write_b128 v172, v[40:43] offset:0
    v_mfma_f32_16x16x32_bf16 v[52:55], v[192:195], v[212:215], v[52:55]
    v_mfma_f32_16x16x32_bf16 v[52:55], v[136:139], v[228:231], v[52:55]
    ds_write_b128 v172, v[44:47] offset:1024
    v_mfma_f32_16x16x32_bf16 v[56:59], v[196:199], v[212:215], v[56:59]
    v_mfma_f32_16x16x32_bf16 v[56:59], v[140:143], v[228:231], v[56:59]
    ds_write_b128 v172, v[48:51] offset:2048
    v_mfma_f32_16x16x32_bf16 v[60:63], v[200:203], v[212:215], v[60:63]
    v_mfma_f32_16x16x32_bf16 v[60:63], v[144:147], v[228:231], v[60:63]
    s_nop 1
    ds_write_b128 v172, v[52:55] offset:3072
    v_mfma_f32_16x16x32_bf16 v[64:67], v[204:207], v[212:215], v[64:67]
    v_mfma_f32_16x16x32_bf16 v[64:67], v[148:151], v[228:231], v[64:67]
    ds_write_b128 v172, v[56:59] offset:4096
    v_mfma_f32_16x16x32_bf16 v[68:71], v[180:183], v[216:219], v[68:71]
    v_mfma_f32_16x16x32_bf16 v[68:71], v[124:127], v[232:235], v[68:71]
    ds_write_b128 v172, v[60:63] offset:5120
    v_mfma_f32_16x16x32_bf16 v[72:75], v[184:187], v[216:219], v[72:75]
    v_mfma_f32_16x16x32_bf16 v[72:75], v[128:131], v[232:235], v[72:75]
    s_nop 1
    ds_write_b128 v172, v[64:67] offset:6144
    v_mfma_f32_16x16x32_bf16 v[76:79], v[188:191], v[216:219], v[76:79]
    v_mfma_f32_16x16x32_bf16 v[76:79], v[132:135], v[232:235], v[76:79]
    ds_write_b128 v172, v[68:71] offset:7168
    v_mfma_f32_16x16x32_bf16 v[80:83], v[192:195], v[216:219], v[80:83]
    v_mfma_f32_16x16x32_bf16 v[80:83], v[136:139], v[232:235], v[80:83]
    ds_write_b128 v172, v[72:75] offset:8192
    v_mfma_f32_16x16x32_bf16 v[84:87], v[196:199], v[216:219], v[84:87]
    v_mfma_f32_16x16x32_bf16 v[84:87], v[140:143], v[232:235], v[84:87]
    s_nop 1
    ds_write_b128 v172, v[76:79] offset:9216
    v_mfma_f32_16x16x32_bf16 v[88:91], v[200:203], v[216:219], v[88:91]
    v_mfma_f32_16x16x32_bf16 v[88:91], v[144:147], v[232:235], v[88:91]
    ds_write_b128 v172, v[80:83] offset:10240
    v_mfma_f32_16x16x32_bf16 v[92:95], v[204:207], v[216:219], v[92:95]
    v_mfma_f32_16x16x32_bf16 v[92:95], v[148:151], v[232:235], v[92:95]
    ds_write_b128 v172, v[84:87] offset:11264
    v_mfma_f32_16x16x32_bf16 v[96:99], v[180:183], v[220:223], v[96:99]
    v_mfma_f32_16x16x32_bf16 v[96:99], v[124:127], v[236:239], v[96:99]
    s_nop 1
    ds_write_b128 v172, v[88:91] offset:12288
    v_mfma_f32_16x16x32_bf16 v[100:103], v[184:187], v[220:223], v[100:103]
    v_mfma_f32_16x16x32_bf16 v[100:103], v[128:131], v[236:239], v[100:103]
    ds_write_b128 v172, v[92:95] offset:13312
    v_mfma_f32_16x16x32_bf16 v[104:107], v[188:191], v[220:223], v[104:107]
    v_mfma_f32_16x16x32_bf16 v[104:107], v[132:135], v[236:239], v[104:107]
    ds_write_b128 v172, v[96:99] offset:14336
    v_mfma_f32_16x16x32_bf16 v[108:111], v[192:195], v[220:223], v[108:111]
    v_mfma_f32_16x16x32_bf16 v[108:111], v[136:139], v[236:239], v[108:111]
    s_nop 1
    ds_write_b128 v172, v[100:103] offset:15360
    v_mfma_f32_16x16x32_bf16 v[112:115], v[196:199], v[220:223], v[112:115]
    v_mfma_f32_16x16x32_bf16 v[112:115], v[140:143], v[236:239], v[112:115]
    ds_write_b128 v172, v[104:107] offset:16384
    v_mfma_f32_16x16x32_bf16 v[116:119], v[200:203], v[220:223], v[116:119]
    v_mfma_f32_16x16x32_bf16 v[116:119], v[144:147], v[236:239], v[116:119]
    ds_write_b128 v172, v[108:111] offset:17408
    v_mfma_f32_16x16x32_bf16 v[120:123], v[204:207], v[220:223], v[120:123]
    v_mfma_f32_16x16x32_bf16 v[120:123], v[148:151], v[236:239], v[120:123]
    s_nop 1
    ds_write_b128 v172, v[112:115] offset:18432
    v_mfma_f32_16x16x32_bf16 v[12:15], v[180:183], v[208:211], v[12:15]
    v_mfma_f32_16x16x32_bf16 v[12:15], v[124:127], v[224:227], v[12:15]
    ds_write_b128 v172, v[116:119] offset:19456
    v_mfma_f32_16x16x32_bf16 v[16:19], v[184:187], v[208:211], v[16:19]
    v_mfma_f32_16x16x32_bf16 v[16:19], v[128:131], v[224:227], v[16:19]
    ds_write_b128 v172, v[120:123] offset:20480
    v_mfma_f32_16x16x32_bf16 v[20:23], v[188:191], v[208:211], v[20:23]
    v_mfma_f32_16x16x32_bf16 v[20:23], v[132:135], v[224:227], v[20:23]
    v_mfma_f32_16x16x32_bf16 v[24:27], v[192:195], v[208:211], v[24:27]
    v_mfma_f32_16x16x32_bf16 v[24:27], v[136:139], v[224:227], v[24:27]
    v_mfma_f32_16x16x32_bf16 v[28:31], v[196:199], v[208:211], v[28:31]
    v_mfma_f32_16x16x32_bf16 v[28:31], v[140:143], v[224:227], v[28:31]
    v_mfma_f32_16x16x32_bf16 v[32:35], v[200:203], v[208:211], v[32:35]
    v_mfma_f32_16x16x32_bf16 v[32:35], v[144:147], v[224:227], v[32:35]
    v_mfma_f32_16x16x32_bf16 v[36:39], v[204:207], v[208:211], v[36:39]
    v_mfma_f32_16x16x32_bf16 v[36:39], v[148:151], v[224:227], v[36:39]
    v_mov_b32 v6, 1
    s_waitcnt lgkmcnt(0)
    ds_write_b32 v4, v6
    s_load_dwordx2 s[44:45], s[0:1], 0
    s_load_dwordx4 s[48:51], s[0:1], 104
    s_waitcnt vmcnt(0)
    v_lshlrev_b32 v168, 16, v168
    v_lshlrev_b32 v180, 16, v152
    v_and_b32 v181, 0xffff0000, v152
    v_lshlrev_b32 v182, 16, v153
    v_and_b32 v183, 0xffff0000, v153
    v_lshlrev_b32 v184, 16, v154
    v_and_b32 v185, 0xffff0000, v154
    v_lshlrev_b32 v186, 16, v155
    v_and_b32 v187, 0xffff0000, v155
    v_lshlrev_b32 v188, 16, v156
    v_and_b32 v189, 0xffff0000, v156
    v_lshlrev_b32 v190, 16, v157
    v_and_b32 v191, 0xffff0000, v157
    v_lshlrev_b32 v192, 16, v158
    v_and_b32 v193, 0xffff0000, v158
    v_lshlrev_b32 v194, 16, v159
    v_and_b32 v195, 0xffff0000, v159
    v_lshlrev_b32 v196, 16, v160
    v_and_b32 v197, 0xffff0000, v160
    v_lshlrev_b32 v198, 16, v161
    v_and_b32 v199, 0xffff0000, v161
    v_lshlrev_b32 v200, 16, v162
    v_and_b32 v201, 0xffff0000, v162
    v_lshlrev_b32 v202, 16, v163
    v_and_b32 v203, 0xffff0000, v163
    v_lshlrev_b32 v204, 16, v164
    v_and_b32 v205, 0xffff0000, v164
    v_lshlrev_b32 v206, 16, v165
    v_and_b32 v207, 0xffff0000, v165
    v_pk_add_f32 v[12:13], v[12:13], v[168:169] op_sel_hi:[1,0]
    v_pk_add_f32 v[14:15], v[14:15], v[168:169] op_sel_hi:[1,0]
    v_pk_add_f32 v[16:17], v[16:17], v[168:169] op_sel_hi:[1,0]
    v_pk_add_f32 v[18:19], v[18:19], v[168:169] op_sel_hi:[1,0]
    v_pk_add_f32 v[20:21], v[20:21], v[168:169] op_sel_hi:[1,0]
    v_pk_add_f32 v[22:23], v[22:23], v[168:169] op_sel_hi:[1,0]
    v_pk_add_f32 v[24:25], v[24:25], v[168:169] op_sel_hi:[1,0]
    v_pk_add_f32 v[26:27], v[26:27], v[168:169] op_sel_hi:[1,0]
    v_pk_add_f32 v[28:29], v[28:29], v[168:169] op_sel_hi:[1,0]
    v_pk_add_f32 v[30:31], v[30:31], v[168:169] op_sel_hi:[1,0]
    v_pk_add_f32 v[32:33], v[32:33], v[168:169] op_sel_hi:[1,0]
    v_pk_add_f32 v[34:35], v[34:35], v[168:169] op_sel_hi:[1,0]
    v_pk_add_f32 v[36:37], v[36:37], v[168:169] op_sel_hi:[1,0]
    v_pk_add_f32 v[38:39], v[38:39], v[168:169] op_sel_hi:[1,0]
    v_xor_b32 v5, 4, v4
    s_mov_b32 s27, 0
K2_W51:
    ds_read_b32 v6, v5
    s_waitcnt lgkmcnt(0)
    v_readfirstlane_b32 s26, v6
    s_cmp_ge_u32 s26, 1
    s_cbranch_scc1 K2_G51
    s_sleep 1
    s_add_u32 s27, s27, 1
    s_cmp_lt_u32 s27, 0x200000
    s_cbranch_scc1 K2_W51
K2_G51:
    ds_read_b128 v[40:43], v173 offset:0
    ds_read_b128 v[44:47], v173 offset:1024
    ds_read_b128 v[48:51], v173 offset:2048
    ds_read_b128 v[52:55], v173 offset:3072
    ds_read_b128 v[56:59], v173 offset:4096
    ds_read_b128 v[60:63], v173 offset:5120
    ds_read_b128 v[64:67], v173 offset:6144
    v_xor_b32 v5, 8, v4
    s_mov_b32 s27, 0
K2_W52:
    ds_read_b32 v6, v5
    s_waitcnt lgkmcnt(0)
    v_readfirstlane_b32 s26, v6
    s_cmp_ge_u32 s26, 1
    s_cbranch_scc1 K2_G52
    s_sleep 1
    s_add_u32 s27, s27, 1
    s_cmp_lt_u32 s27, 0x200000
    s_cbranch_scc1 K2_W52
K2_G52:
    ds_read_b128 v[68:71], v174 offset:7168
    ds_read_b128 v[72:75], v174 offset:8192
    ds_read_b128 v[76:79], v174 offset:9216
    ds_read_b128 v[80:83], v174 offset:10240
    ds_read_b128 v[84:87], v174 offset:11264
    ds_read_b128 v[88:91], v174 offset:12288
    ds_read_b128 v[92:95], v174 offset:13312
    v_pk_add_f32 v[12:13], v[12:13], v[40:41]
    v_pk_add_f32 v[14:15], v[14:15], v[42:43]
    v_pk_add_f32 v[16:17], v[16:17], v[44:45]
    v_pk_add_f32 v[18:19], v[18:19], v[46:47]
    v_pk_add_f32 v[20:21], v[20:21], v[48:49]
    v_pk_add_f32 v[22:23], v[22:23], v[50:51]
    v_pk_add_f32 v[24:25], v[24:25], v[52:53]
    v_pk_add_f32 v[26:27], v[26:27], v[54:55]
    v_pk_add_f32 v[28:29], v[28:29], v[56:57]
    v_pk_add_f32 v[30:31], v[30:31], v[58:59]
    v_pk_add_f32 v[32:33], v[32:33], v[60:61]
    v_pk_add_f32 v[34:35], v[34:35], v[62:63]
    v_pk_add_f32 v[36:37], v[36:37], v[64:65]
    v_pk_add_f32 v[38:39], v[38:39], v[66:67]
    v_xor_b32 v5, 12, v4
    s_mov_b32 s27, 0
K2_W53:
    ds_read_b32 v6, v5
    s_waitcnt lgkmcnt(0)
    v_readfirstlane_b32 s26, v6
    s_cmp_ge_u32 s26, 1
    s_cbranch_scc1 K2_G53
    s_sleep 1
    s_add_u32 s27, s27, 1
    s_cmp_lt_u32 s27, 0x200000
    s_cbranch_scc1 K2_W53
K2_G53:
    ds_read_b128 v[96:99], v175 offset:14336
    ds_read_b128 v[100:103], v175 offset:15360
    ds_read_b128 v[104:107], v175 offset:16384
    ds_read_b128 v[108:111], v175 offset:17408
    ds_read_b128 v[112:115], v175 offset:18432
    ds_read_b128 v[116:119], v175 offset:19456
    ds_read_b128 v[120:123], v175 offset:20480
    v_pk_add_f32 v[12:13], v[12:13], v[68:69]
    v_pk_add_f32 v[14:15], v[14:15], v[70:71]
    v_pk_add_f32 v[16:17], v[16:17], v[72:73]
    v_pk_add_f32 v[18:19], v[18:19], v[74:75]
    v_pk_add_f32 v[20:21], v[20:21], v[76:77]
    v_pk_add_f32 v[22:23], v[22:23], v[78:79]
    v_pk_add_f32 v[24:25], v[24:25], v[80:81]
    v_pk_add_f32 v[26:27], v[26:27], v[82:83]
    v_pk_add_f32 v[28:29], v[28:29], v[84:85]
    v_pk_add_f32 v[30:31], v[30:31], v[86:87]
    v_pk_add_f32 v[32:33], v[32:33], v[88:89]
    v_pk_add_f32 v[34:35], v[34:35], v[90:91]
    v_pk_add_f32 v[36:37], v[36:37], v[92:93]
    v_pk_add_f32 v[38:39], v[38:39], v[94:95]
    s_waitcnt lgkmcnt(6)
    v_pk_add_f32 v[12:13], v[12:13], v[96:97]
    v_pk_add_f32 v[14:15], v[14:15], v[98:99]
    v_pk_mul_f32 v[12:13], v[12:13], v[180:181]
    v_pk_mul_f32 v[14:15], v[14:15], v[182:183]
    v_cvt_pk_bf16_f32 v152, v12, v13
    v_cvt_pk_bf16_f32 v153, v14, v15
    s_waitcnt lgkmcnt(5)
    v_pk_add_f32 v[16:17], v[16:17], v[100:101]
    v_pk_add_f32 v[18:19], v[18:19], v[102:103]
    v_pk_mul_f32 v[16:17], v[16:17], v[184:185]
    v_pk_mul_f32 v[18:19], v[18:19], v[186:187]
    v_cvt_pk_bf16_f32 v154, v16, v17
    v_cvt_pk_bf16_f32 v155, v18, v19
    s_nop 0
    v_permlane16_swap_b32 v152, v154
    v_permlane16_swap_b32 v153, v155
    buffer_store_dwordx4 v[152:155], v170, s[12:15], s25 offen offset:0 sc1
    s_waitcnt lgkmcnt(4)
    v_pk_add_f32 v[20:21], v[20:21], v[104:105]
    v_pk_add_f32 v[22:23], v[22:23], v[106:107]
    v_pk_mul_f32 v[20:21], v[20:21], v[188:189]
    v_pk_mul_f32 v[22:23], v[22:23], v[190:191]
    v_cvt_pk_bf16_f32 v156, v20, v21
    v_cvt_pk_bf16_f32 v157, v22, v23
    s_waitcnt lgkmcnt(3)
    v_pk_add_f32 v[24:25], v[24:25], v[108:109]
    v_pk_add_f32 v[26:27], v[26:27], v[110:111]
    v_pk_mul_f32 v[24:25], v[24:25], v[192:193]
    v_pk_mul_f32 v[26:27], v[26:27], v[194:195]
    v_cvt_pk_bf16_f32 v158, v24, v25
    v_cvt_pk_bf16_f32 v159, v26, v27
    s_nop 0
    v_permlane16_swap_b32 v156, v158
    v_permlane16_swap_b32 v157, v159
    buffer_store_dwordx4 v[156:159], v170, s[12:15], s25 offen offset:1024 sc1
    s_waitcnt lgkmcnt(2)
    v_pk_add_f32 v[28:29], v[28:29], v[112:113]
    v_pk_add_f32 v[30:31], v[30:31], v[114:115]
    v_pk_mul_f32 v[28:29], v[28:29], v[196:197]
    v_pk_mul_f32 v[30:31], v[30:31], v[198:199]
    v_cvt_pk_bf16_f32 v160, v28, v29
    v_cvt_pk_bf16_f32 v161, v30, v31
    s_waitcnt lgkmcnt(1)
    v_pk_add_f32 v[32:33], v[32:33], v[116:117]
    v_pk_add_f32 v[34:35], v[34:35], v[118:119]
    v_pk_mul_f32 v[32:33], v[32:33], v[200:201]
    v_pk_mul_f32 v[34:35], v[34:35], v[202:203]
    v_cvt_pk_bf16_f32 v162, v32, v33
    v_cvt_pk_bf16_f32 v163, v34, v35
    s_nop 0
    v_permlane16_swap_b32 v160, v162
    v_permlane16_swap_b32 v161, v163
    buffer_store_dwordx4 v[160:163], v170, s[12:15], s25 offen offset:2048 sc1
    s_waitcnt lgkmcnt(0)
    v_pk_add_f32 v[36:37], v[36:37], v[120:121]
    v_pk_add_f32 v[38:39], v[38:39], v[122:123]
    v_pk_mul_f32 v[36:37], v[36:37], v[204:205]
    v_pk_mul_f32 v[38:39], v[38:39], v[206:207]
    v_cvt_pk_bf16_f32 v164, v36, v37
    v_cvt_pk_bf16_f32 v165, v38, v39
    v_mov_b32 v166, v164
    v_mov_b32 v167, v165
    s_nop 0
    v_permlane16_swap_b32 v164, v166
    v_permlane16_swap_b32 v165, v167
    s_mov_b32 exec_lo, 0xffff
    s_mov_b32 exec_hi, 0xffff
    buffer_store_dwordx4 v[164:167], v170, s[12:15], s25 offen offset:3072 sc1
    s_mov_b64 exec, -1
    s_waitcnt lgkmcnt(0)
    s_mov_b32 s28, s44
    s_and_b32 s29, s45, 0xffff
    s_mov_b32 s30, 0x00200000
    s_mov_b32 s31, 0x00020000
    s_mov_b32 s32, s48
    s_and_b32 s33, s49, 0xffff
    s_mov_b32 s34, 0x000e0000
    s_mov_b32 s35, 0x00020000
    s_mov_b32 s36, s50
    s_and_b32 s37, s51, 0xffff
    s_mov_b32 s38, 0x00200000
    s_mov_b32 s39, 0x00020000
    s_and_b32 s40, s22, 3
    s_lshr_b32 s41, s22, 2
    s_lshl_b32 s23, s20, 2
    s_add_u32 s23, s23, s40
    s_mul_i32 s23, s23, 28
    s_add_u32 s23, s23, s41
    s_lshl_b32 s42, s23, 10
    s_add_u32 s42, s42, 9502720
    s_lshl_b32 s43, s41, 15
    s_lshl_b32 s23, s21, 7
    s_add_u32 s43, s43, s23
    s_lshl_b32 s52, s22, 10
    v_lshlrev_b32 v52, 4, v1
    v_lshrrev_b32 v40, 3, v1
    v_and_b32 v41, 3, v40
    v_and_b32 v42, 4, v40
    v_lshl_add_u32 v41, v42, 1, v41
    s_and_b32 s23, s40, 1
    s_lshl_b32 s23, s23, 2
    s_and_b32 s24, s40, 2
    s_lshl_b32 s24, s24, 3
    s_or_b32 s23, s23, s24
    v_or_b32 v41, s23, v41
    v_lshrrev_b32 v42, 1, v40
    v_lshrrev_b32 v43, 1, v1
    v_xor_b32 v42, v42, v43
    v_and_b32 v42, 3, v42
    v_lshlrev_b32 v42, 5, v42
    v_and_b32 v43, 1, v1
    v_lshl_add_u32 v42, v43, 4, v42
    v_lshl_add_u32 v53, v41, 10, v42
    v_lshl_add_u32 v55, v40, 12, v42
    s_lshl_b32 s23, s21, 6
    s_lshl_b32 s24, s22, 3
    s_add_u32 s23, s23, s24
    s_lshl_b32 s23, s23, 12
    s_lshl_b32 s24, s20, 7
    s_add_u32 s23, s23, s24
    s_add_u32 s54, s23, 13172736
    s_lshl_b32 s53, s20, 16
    s_lshl_b32 s23, s22, 13
    s_add_u32 s53, s53, s23
    s_lshl_b32 s23, s21, 7
    s_add_u32 s53, s53, s23
    v_and_b32 v45, 7, v1
    v_lshlrev_b32 v54, 10, v40
    v_lshl_add_u32 v54, v45, 4, v54
    s_lshl_b32 s23, s22, 3
    v_add_u32 v56, s23, v40
    v_mul_u32_u24 v56, 272, v56
    v_lshl_add_u32 v56, v45, 5, v56
    v_add_u32 v56, 123136, v56
    s_lshl_b32 s23, s22, 4
    v_add_u32 v57, s23, v2
    v_mul_u32_u24 v57, 272, v57
    v_lshl_add_u32 v57, v3, 4, v57
    v_add_u32 v57, 123136, v57
    v_lshrrev_b32 v40, 2, v2
    v_lshl_add_u32 v40, v3, 2, v40
    v_bfe_u32 v41, v40, 1, 2
    v_xor_b32 v41, s40, v41
    v_lshlrev_b32 v58, 7, v40
    v_lshl_add_u32 v58, v41, 5, v58
    v_and_b32 v41, 3, v2
    v_lshl_add_u32 v58, v41, 3, v58
    s_lshl_b32 s23, s41, 12
    s_add_u32 s23, s23, 114944
    v_add_u32 v58, s23, v58
    v_lshrrev_b32 v40, 2, v2
    v_and_b32 v41, 1, v3
    v_lshl_add_u32 v40, v41, 2, v40
    v_lshrrev_b32 v42, 1, v40
    v_lshrrev_b32 v41, 1, v3
    v_lshl_add_u32 v40, v41, 4, v40
    v_lshlrev_b32 v40, 7, v40
    v_and_b32 v41, 3, v2
    v_lshl_add_u32 v40, v41, 3, v40
    s_lshl_b32 s23, s41, 12
    s_add_u32 s23, s23, 256
    v_add_u32 v40, s23, v40
    v_xor_b32 v43, 0, v42
    v_lshl_add_u32 v48, v43, 5, v40
    v_xor_b32 v43, 1, v42
    v_lshl_add_u32 v49, v43, 5, v40
    v_xor_b32 v43, 2, v42
    v_lshl_add_u32 v50, v43, 5, v40
    v_xor_b32 v43, 3, v42
    v_lshl_add_u32 v51, v43, 5, v40
    v_lshlrev_b32 v59, 2, v1
    s_waitcnt vmcnt(0)
    s_lshl_b32 s23, s20, 9
    s_and_b32 s24, s22, 3
    s_lshl_b32 s24, s24, 7
    s_add_u32 s23, s23, s24
    s_add_u32 s23, s23, 15548416
    s_mov_b32 s24, s21
    s_lshl_b64 exec, 1, s24
    buffer_store_dword v250, v253, s[12:15], s23 offen sc1
    s_mov_b64 exec, -1
    s_branch K2_P3
K2_CONV:
    s_lshr_b32 s28, s22, 1
    s_and_b32 s28, s28, 1
    s_and_b32 s29, s22, 1
    s_lshl_b32 s30, s2, 1
    s_add_u32 s30, s30, s28
    v_readfirstlane_b32 s24, v254
    v_readfirstlane_b32 s34, v255
    v_mov_b32 v8, v244
    v_mov_b32 v9, v245
    v_mov_b32 v10, v246
    v_mov_b32 v11, v247
    v_mov_b32 v12, v248
    v_mov_b32 v13, v249
    s_mul_i32 s31, s28, 16640
    s_add_u32 s31, s31, 64
    s_mul_i32 s32, s28, 4608
    s_add_u32 s32, s32, 33344
    s_sub_u32 s33, s22, 4
    s_mul_i32 s33, s33, 5120
    s_add_u32 s33, s33, 42560
    s_mul_i32 s25, s30, 4224
    s_add_u32 s25, s25, 128
    s_mul_i32 s23, s29, 8320
    s_add_u32 s23, s23, s31
    v_lshlrev_b32 v14, 4, v1
    s_mov_b32 s35, s25
    v_mov_b32 v68, 0
    v_mov_b32 v69, 0
    v_mov_b32 v70, 0
    v_mov_b32 v71, 0
    v_lshrrev_b32 v6, 1, v1
    v_mul_u32_u24 v6, 4160, v6
    v_and_b32 v15, 1, v1
    v_lshl_add_u32 v6, v15, 4, v6
    v_add_u32 v6, s31, v6
    s_mov_b64 exec, 0xff
    ds_write_b128 v6, v[68:71]
    s_mov_b32 exec_lo, -1
    v_add_u32 v6, s32, v14
    ds_write_b128 v6, v[68:71] offset:4096
    s_mov_b64 exec, -1
    v_lshl_add_u32 v14, v1, 2, s33
    v_mul_u32_u24 v15, 288, v2
    v_lshl_add_u32 v15, v3, 4, v15
    v_add_u32 v15, s33, v15
    s_waitcnt lgkmcnt(0)
    s_lshl_b32 s24, s24, 16
    s_lshl_b32 s34, s34, 16
    v_mov_b32 v68, s24
    v_mul_f32 v69, 0x3fb8aa3b, v68
    v_mov_b32 v71, 0x3fb8aa3b
    v_fma_f32 v70, v68, v71, -v69
    v_fmamk_f32 v70, v68, 0x32a57060, v70
    v_exp_f32 v69, v69
    v_mul_f32 v70, 0x3f317218, v70
    v_fma_f32 v69, v69, v70, v69
    v_cvt_pk_bf16_f32 v69, v69, v69
    v_and_b32 v69, 0xffff0000, v69
    v_lshlrev_b32 v8, 16, v8
    v_lshlrev_b32 v9, 16, v9
    v_lshlrev_b32 v10, 16, v10
    v_lshlrev_b32 v11, 16, v11
    v_lshlrev_b32 v12, 16, v12
    v_lshlrev_b32 v13, 16, v13
    v_mul_f32 v8, v69, v8
    v_mul_f32 v9, v69, v9
    v_mul_f32 v10, v69, v10
    v_mul_f32 v11, v69, v11
    v_mul_f32 v16, 0x3fb8aa3b, v8
    v_mul_f32 v17, 0.15915494, v9
    v_mul_f32 v68, v13, v11
    v_mul_f32 v69, v13, v10
    v_fma_f32 v44, v12, v10, -v68
    v_fma_f32 v46, v12, v11, v69
    v_mul_f32 v68, 0x40800000, v16
    v_mul_f32 v69, 0x40800000, v17
    v_mul_f32 v70, 0x3f800000, v16
    v_mul_f32 v71, 0x3f800000, v17
    v_mul_f32 v72, 0x43000000, v16
    v_mul_f32 v73, 0x43000000, v17
    v_exp_f32 v68, v68
    v_fract_f32 v69, v69
    v_exp_f32 v70, v70
    v_fract_f32 v71, v71
    v_exp_f32 v72, v72
    v_fract_f32 v73, v73
    v_cos_f32 v24, v69
    v_sin_f32 v26, v69
    v_cos_f32 v20, v71
    v_sin_f32 v22, v71
    v_cos_f32 v36, v73
    v_sin_f32 v38, v73
    v_mul_f32 v24, v24, v68
    v_mul_f32 v26, v26, v68
    v_mul_f32 v20, v20, v70
    v_mul_f32 v22, v22, v70
    v_mul_f32 v36, v36, v72
    v_mul_f32 v38, v38, v72
    v_mul_f32 v68, v26, v26
    v_add_f32 v69, v24, v24
    v_fma_f32 v28, v24, v24, -v68
    v_mul_f32 v30, v69, v26
    v_mul_f32 v68, v38, v38
    v_add_f32 v69, v36, v36
    v_fma_f32 v40, v36, v36, -v68
    v_mul_f32 v42, v69, v38
    v_mul_f32 v68, v30, v30
    v_add_f32 v69, v28, v28
    v_fma_f32 v32, v28, v28, -v68
    v_mul_f32 v34, v69, v30
    v_mul_f32 v68, v46, v26
    v_mul_f32 v69, v46, v24
    v_fma_f32 v45, v44, v24, -v68
    v_fma_f32 v47, v44, v26, v69
    v_mov_b32 v60, v28
    v_mov_b32 v61, v32
    v_mov_b32 v62, v30
    v_mov_b32 v63, v34
    v_mov_b32 v155, 0x3f80
    ds_write_b32 v14, v155
    v_cvt_pk_bf16_f32 v144, v60, v62
    ds_write_b32 v14, v144 offset:288
    v_cvt_pk_bf16_f32 v145, v61, v63
    ds_write_b32 v14, v145 offset:576
    v_pk_mul_f32 v[68:69], v[62:63], v[34:35] op_sel_hi:[1,0]
    v_pk_mul_f32 v[70:71], v[62:63], v[32:33] op_sel_hi:[1,0]
    v_pk_fma_f32 v[62:63], v[60:61], v[34:35], v[70:71] op_sel_hi:[1,0,1]
    v_pk_fma_f32 v[60:61], v[60:61], v[32:33], v[68:69] op_sel_hi:[1,0,1] neg_lo:[0,0,1] neg_hi:[0,0,1]
    v_pk_mul_f32 v[72:73], v[46:47], v[22:23] op_sel_hi:[1,0]
    v_pk_mul_f32 v[74:75], v[46:47], v[20:21] op_sel_hi:[1,0]
    v_pk_fma_f32 v[50:51], v[44:45], v[22:23], v[74:75] op_sel_hi:[1,0,1]
    v_pk_fma_f32 v[48:49], v[44:45], v[20:21], v[72:73] op_sel_hi:[1,0,1] neg_lo:[0,0,1] neg_hi:[0,0,1]
    v_cvt_pk_bf16_f32 v146, v60, v62
    ds_write_b32 v14, v146 offset:864
    v_cvt_pk_bf16_f32 v147, v61, v63
    ds_write_b32 v14, v147 offset:1152
    v_pk_mul_f32 v[68:69], v[62:63], v[34:35] op_sel_hi:[1,0]
    v_pk_mul_f32 v[70:71], v[62:63], v[32:33] op_sel_hi:[1,0]
    v_pk_fma_f32 v[62:63], v[60:61], v[34:35], v[70:71] op_sel_hi:[1,0,1]
    v_pk_fma_f32 v[60:61], v[60:61], v[32:33], v[68:69] op_sel_hi:[1,0,1] neg_lo:[0,0,1] neg_hi:[0,0,1]
    v_pk_mul_f32 v[72:73], v[50:51], v[22:23] op_sel_hi:[1,0]
    v_pk_mul_f32 v[74:75], v[50:51], v[20:21] op_sel_hi:[1,0]
    v_pk_fma_f32 v[54:55], v[48:49], v[22:23], v[74:75] op_sel_hi:[1,0,1]
    v_pk_fma_f32 v[52:53], v[48:49], v[20:21], v[72:73] op_sel_hi:[1,0,1] neg_lo:[0,0,1] neg_hi:[0,0,1]
    v_cvt_pk_bf16_f32 v148, v60, v62
    ds_write_b32 v14, v148 offset:1440
    v_cvt_pk_bf16_f32 v149, v61, v63
    ds_write_b32 v14, v149 offset:1728
    v_pk_mul_f32 v[68:69], v[62:63], v[34:35] op_sel_hi:[1,0]
    v_pk_mul_f32 v[70:71], v[62:63], v[32:33] op_sel_hi:[1,0]
    v_pk_fma_f32 v[62:63], v[60:61], v[34:35], v[70:71] op_sel_hi:[1,0,1]
    v_pk_fma_f32 v[60:61], v[60:61], v[32:33], v[68:69] op_sel_hi:[1,0,1] neg_lo:[0,0,1] neg_hi:[0,0,1]
    v_pk_mul_f32 v[72:73], v[54:55], v[22:23] op_sel_hi:[1,0]
    v_pk_mul_f32 v[74:75], v[54:55], v[20:21] op_sel_hi:[1,0]
    v_pk_fma_f32 v[58:59], v[52:53], v[22:23], v[74:75] op_sel_hi:[1,0,1]
    v_pk_fma_f32 v[56:57], v[52:53], v[20:21], v[72:73] op_sel_hi:[1,0,1] neg_lo:[0,0,1] neg_hi:[0,0,1]
    v_cvt_pk_bf16_f32 v150, v60, v62
    ds_write_b32 v14, v150 offset:2016
    v_cvt_pk_bf16_f32 v151, v61, v63
    ds_write_b32 v14, v151 offset:2304
    v_pk_mul_f32 v[68:69], v[62:63], v[34:35] op_sel_hi:[1,0]
    v_pk_mul_f32 v[70:71], v[62:63], v[32:33] op_sel_hi:[1,0]
    v_pk_fma_f32 v[62:63], v[60:61], v[34:35], v[70:71] op_sel_hi:[1,0,1]
    v_pk_fma_f32 v[60:61], v[60:61], v[32:33], v[68:69] op_sel_hi:[1,0,1] neg_lo:[0,0,1] neg_hi:[0,0,1]
    v_cvt_pk_bf16_f32 v152, v60, v62
    ds_write_b32 v14, v152 offset:2592
    v_cvt_pk_bf16_f32 v153, v61, v63
    ds_write_b32 v14, v153 offset:2880
    v_pk_mul_f32 v[72:73], v[62:63], v[34:35] op_sel_hi:[1,0]
    v_pk_mul_f32 v[74:75], v[62:63], v[32:33] op_sel_hi:[1,0]
    v_pk_fma_f32 v[62:63], v[60:61], v[34:35], v[74:75] op_sel_hi:[1,0,1]
    v_pk_fma_f32 v[60:61], v[60:61], v[32:33], v[72:73] op_sel_hi:[1,0,1] neg_lo:[0,0,1] neg_hi:[0,0,1]
    v_cvt_pk_bf16_f32 v154, v60, v62
    ds_write_b32 v14, v154 offset:3168
    v_cvt_pk_bf16_f32 v155, v61, v63
    ds_write_b32 v14, v155 offset:3456
    v_pk_mul_f32 v[68:69], v[62:63], v[34:35] op_sel_hi:[1,0]
    v_pk_mul_f32 v[70:71], v[62:63], v[32:33] op_sel_hi:[1,0]
    v_pk_fma_f32 v[62:63], v[60:61], v[34:35], v[70:71] op_sel_hi:[1,0,1]
    v_pk_fma_f32 v[60:61], v[60:61], v[32:33], v[68:69] op_sel_hi:[1,0,1] neg_lo:[0,0,1] neg_hi:[0,0,1]
    v_cvt_pk_bf16_f32 v144, v60, v62
    ds_write_b32 v14, v144 offset:3744
    v_cvt_pk_bf16_f32 v145, v61, v63
    ds_write_b32 v14, v145 offset:4032
    v_pk_mul_f32 v[72:73], v[62:63], v[34:35] op_sel_hi:[1,0]
    v_pk_mul_f32 v[74:75], v[62:63], v[32:33] op_sel_hi:[1,0]
    v_pk_fma_f32 v[62:63], v[60:61], v[34:35], v[74:75] op_sel_hi:[1,0,1]
    v_pk_fma_f32 v[60:61], v[60:61], v[32:33], v[72:73] op_sel_hi:[1,0,1] neg_lo:[0,0,1] neg_hi:[0,0,1]
    v_cvt_pk_bf16_f32 v146, v60, v62
    ds_write_b32 v14, v146 offset:4320
    v_cvt_pk_bf16_f32 v147, v61, v63
    ds_write_b32 v14, v147 offset:4608
    ds_read_b128 v[76:79], v15 offset:0
    ds_read_b128 v[92:95], v15 offset:288
    ds_read_b128 v[80:83], v15 offset:64
    ds_read_b128 v[96:99], v15 offset:352
    ds_read_b128 v[84:87], v15 offset:128
    ds_read_b128 v[100:103], v15 offset:416
    ds_read_b128 v[88:91], v15 offset:192
    ds_read_b128 v[104:107], v15 offset:480
    v_cvt_pk_bf16_f32 v148, v44, -v46
    ds_write_b32 v14, v148 offset:0
    v_cvt_pk_bf16_f32 v149, v48, -v50
    ds_write_b32 v14, v149 offset:288
    v_cvt_pk_bf16_f32 v150, v52, -v54
    ds_write_b32 v14, v150 offset:576
    v_cvt_pk_bf16_f32 v151, v56, -v58
    ds_write_b32 v14, v151 offset:864
    v_cvt_pk_bf16_f32 v152, v45, -v47
    ds_write_b32 v14, v152 offset:1152
    v_cvt_pk_bf16_f32 v153, v49, -v51
    ds_write_b32 v14, v153 offset:1440
    v_cvt_pk_bf16_f32 v154, v53, -v55
    ds_write_b32 v14, v154 offset:1728
    v_cvt_pk_bf16_f32 v155, v57, -v59
    ds_write_b32 v14, v155 offset:2016
    v_pk_mul_f32 v[68:69], v[46:47], v[38:39] op_sel_hi:[1,0]
    v_pk_mul_f32 v[70:71], v[46:47], v[36:37] op_sel_hi:[1,0]
    v_pk_fma_f32 v[46:47], v[44:45], v[38:39], v[70:71] op_sel_hi:[1,0,1]
    v_pk_fma_f32 v[44:45], v[44:45], v[36:37], v[68:69] op_sel_hi:[1,0,1] neg_lo:[0,0,1] neg_hi:[0,0,1]
    v_cvt_pk_bf16_f32 v144, v44, -v46
    ds_write_b32 v14, v144 offset:2304
    v_cvt_pk_bf16_f32 v145, v45, -v47
    ds_write_b32 v14, v145 offset:3456
    v_pk_mul_f32 v[72:73], v[50:51], v[38:39] op_sel_hi:[1,0]
    v_pk_mul_f32 v[74:75], v[50:51], v[36:37] op_sel_hi:[1,0]
    v_pk_fma_f32 v[50:51], v[48:49], v[38:39], v[74:75] op_sel_hi:[1,0,1]
    v_pk_fma_f32 v[48:49], v[48:49], v[36:37], v[72:73] op_sel_hi:[1,0,1] neg_lo:[0,0,1] neg_hi:[0,0,1]
    v_cvt_pk_bf16_f32 v146, v48, -v50
    ds_write_b32 v14, v146 offset:2592
    v_cvt_pk_bf16_f32 v147, v49, -v51
    ds_write_b32 v14, v147 offset:3744
    v_pk_mul_f32 v[68:69], v[54:55], v[38:39] op_sel_hi:[1,0]
    v_pk_mul_f32 v[70:71], v[54:55], v[36:37] op_sel_hi:[1,0]
    v_pk_fma_f32 v[54:55], v[52:53], v[38:39], v[70:71] op_sel_hi:[1,0,1]
    v_pk_fma_f32 v[52:53], v[52:53], v[36:37], v[68:69] op_sel_hi:[1,0,1] neg_lo:[0,0,1] neg_hi:[0,0,1]
    v_cvt_pk_bf16_f32 v148, v52, -v54
    ds_write_b32 v14, v148 offset:2880
    v_cvt_pk_bf16_f32 v149, v53, -v55
    ds_write_b32 v14, v149 offset:4032
    v_pk_mul_f32 v[72:73], v[58:59], v[38:39] op_sel_hi:[1,0]
    v_pk_mul_f32 v[74:75], v[58:59], v[36:37] op_sel_hi:[1,0]
    v_pk_fma_f32 v[58:59], v[56:57], v[38:39], v[74:75] op_sel_hi:[1,0,1]
    v_pk_fma_f32 v[56:57], v[56:57], v[36:37], v[72:73] op_sel_hi:[1,0,1] neg_lo:[0,0,1] neg_hi:[0,0,1]
    v_cvt_pk_bf16_f32 v150, v56, -v58
    ds_write_b32 v14, v150 offset:3168
    v_cvt_pk_bf16_f32 v151, v57, -v59
    ds_write_b32 v14, v151 offset:4320
    ds_read_b128 v[108:111], v15 offset:0
    ds_read_b128 v[112:115], v15 offset:64
    ds_read_b128 v[116:119], v15 offset:128
    ds_read_b128 v[120:123], v15 offset:192
    v_pk_mul_f32 v[68:69], v[46:47], v[38:39] op_sel_hi:[1,0]
    v_pk_mul_f32 v[70:71], v[46:47], v[36:37] op_sel_hi:[1,0]
    v_pk_fma_f32 v[46:47], v[44:45], v[38:39], v[70:71] op_sel_hi:[1,0,1]
    v_pk_fma_f32 v[44:45], v[44:45], v[36:37], v[68:69] op_sel_hi:[1,0,1] neg_lo:[0,0,1] neg_hi:[0,0,1]
    v_pk_mul_f32 v[72:73], v[54:55], v[38:39] op_sel_hi:[1,0]
    v_pk_mul_f32 v[74:75], v[54:55], v[36:37] op_sel_hi:[1,0]
    v_pk_fma_f32 v[54:55], v[52:53], v[38:39], v[74:75] op_sel_hi:[1,0,1]
    v_pk_fma_f32 v[52:53], v[52:53], v[36:37], v[72:73] op_sel_hi:[1,0,1] neg_lo:[0,0,1] neg_hi:[0,0,1]
    v_cvt_pk_bf16_f32 v152, v44, -v46
    ds_write_b32 v14, v152 offset:0
    v_cvt_pk_bf16_f32 v153, v52, -v54
    ds_write_b32 v14, v153 offset:288
    v_cvt_pk_bf16_f32 v154, v45, -v47
    ds_write_b32 v14, v154 offset:576
    v_cvt_pk_bf16_f32 v155, v53, -v55
    ds_write_b32 v14, v155 offset:864
    v_pk_mul_f32 v[68:69], v[46:47], v[38:39] op_sel_hi:[1,0]
    v_pk_mul_f32 v[70:71], v[46:47], v[36:37] op_sel_hi:[1,0]
    v_pk_fma_f32 v[46:47], v[44:45], v[38:39], v[70:71] op_sel_hi:[1,0,1]
    v_pk_fma_f32 v[44:45], v[44:45], v[36:37], v[68:69] op_sel_hi:[1,0,1] neg_lo:[0,0,1] neg_hi:[0,0,1]
    v_pk_mul_f32 v[72:73], v[54:55], v[38:39] op_sel_hi:[1,0]
    v_pk_mul_f32 v[74:75], v[54:55], v[36:37] op_sel_hi:[1,0]
    v_pk_fma_f32 v[54:55], v[52:53], v[38:39], v[74:75] op_sel_hi:[1,0,1]
    v_pk_fma_f32 v[52:53], v[52:53], v[36:37], v[72:73] op_sel_hi:[1,0,1] neg_lo:[0,0,1] neg_hi:[0,0,1]
    v_cvt_pk_bf16_f32 v144, v44, -v46
    ds_write_b32 v14, v144 offset:1152
    v_cvt_pk_bf16_f32 v145, v52, -v54
    ds_write_b32 v14, v145 offset:1440
    v_cvt_pk_bf16_f32 v146, v45, -v47
    ds_write_b32 v14, v146 offset:1728
    v_cvt_pk_bf16_f32 v147, v53, -v55
    ds_write_b32 v14, v147 offset:2016
    s_waitcnt lgkmcnt(8)
    v_mfma_f32_16x16x32_bf16 v[124:127], v[108:111], v[76:79], 0
    v_mfma_f32_16x16x32_bf16 v[124:127], v[112:115], v[80:83], v[124:127]
    v_mfma_f32_16x16x32_bf16 v[124:127], v[116:119], v[84:87], v[124:127]
    v_mfma_f32_16x16x32_bf16 v[124:127], v[120:123], v[88:91], v[124:127]
    v_pk_mul_f32 v[68:69], v[46:47], v[38:39] op_sel_hi:[1,0]
    v_pk_mul_f32 v[70:71], v[46:47], v[36:37] op_sel_hi:[1,0]
    v_pk_fma_f32 v[46:47], v[44:45], v[38:39], v[70:71] op_sel_hi:[1,0,1]
    v_pk_fma_f32 v[44:45], v[44:45], v[36:37], v[68:69] op_sel_hi:[1,0,1] neg_lo:[0,0,1] neg_hi:[0,0,1]
    v_cvt_pk_bf16_f32 v148, v44, -v46
    ds_write_b32 v14, v148 offset:2304
    v_cvt_pk_bf16_f32 v149, v45, -v47
    ds_write_b32 v14, v149 offset:2592
    v_pk_mul_f32 v[72:73], v[46:47], v[38:39] op_sel_hi:[1,0]
    v_pk_mul_f32 v[74:75], v[46:47], v[36:37] op_sel_hi:[1,0]
    v_pk_fma_f32 v[46:47], v[44:45], v[38:39], v[74:75] op_sel_hi:[1,0,1]
    v_pk_fma_f32 v[44:45], v[44:45], v[36:37], v[72:73] op_sel_hi:[1,0,1] neg_lo:[0,0,1] neg_hi:[0,0,1]
    v_cvt_pk_bf16_f32 v150, v44, -v46
    ds_write_b32 v14, v150 offset:2880
    v_cvt_pk_bf16_f32 v151, v45, -v47
    ds_write_b32 v14, v151 offset:3168
    v_pk_mul_f32 v[68:69], v[46:47], v[38:39] op_sel_hi:[1,0]
    v_pk_mul_f32 v[70:71], v[46:47], v[36:37] op_sel_hi:[1,0]
    v_pk_fma_f32 v[46:47], v[44:45], v[38:39], v[70:71] op_sel_hi:[1,0,1]
    v_pk_fma_f32 v[44:45], v[44:45], v[36:37], v[68:69] op_sel_hi:[1,0,1] neg_lo:[0,0,1] neg_hi:[0,0,1]
    v_cvt_pk_bf16_f32 v152, v44, -v46
    ds_write_b32 v14, v152 offset:3456
    v_cvt_pk_bf16_f32 v153, v45, -v47
    ds_write_b32 v14, v153 offset:3744
    v_mov_b32 v64, v44
    v_mov_b32 v66, v46
    v_pk_mul_f32 v[72:73], v[46:47], v[38:39] op_sel_hi:[1,0]
    v_pk_mul_f32 v[74:75], v[46:47], v[36:37] op_sel_hi:[1,0]
    v_pk_fma_f32 v[46:47], v[44:45], v[38:39], v[74:75] op_sel_hi:[1,0,1]
    v_pk_fma_f32 v[44:45], v[44:45], v[36:37], v[72:73] op_sel_hi:[1,0,1] neg_lo:[0,0,1] neg_hi:[0,0,1]
    v_cvt_pk_bf16_f32 v154, v44, -v46
    ds_write_b32 v14, v154 offset:4032
    v_cvt_pk_bf16_f32 v155, v45, -v47
    ds_write_b32 v14, v155 offset:4320
    v_mov_b32 v65, v44
    v_mov_b32 v67, v46
    ds_read_b128 v[108:111], v15 offset:0
    ds_read_b128 v[112:115], v15 offset:64
    ds_read_b128 v[116:119], v15 offset:128
    ds_read_b128 v[120:123], v15 offset:192
    v_pk_mul_f32 v[68:69], v[66:67], v[42:43] op_sel_hi:[1,0]
    v_pk_mul_f32 v[70:71], v[66:67], v[40:41] op_sel_hi:[1,0]
    v_pk_fma_f32 v[66:67], v[64:65], v[42:43], v[70:71] op_sel_hi:[1,0,1]
    v_pk_fma_f32 v[64:65], v[64:65], v[40:41], v[68:69] op_sel_hi:[1,0,1] neg_lo:[0,0,1] neg_hi:[0,0,1]
    v_cvt_pk_bf16_f32 v144, v64, -v66
    ds_write_b32 v14, v144 offset:0
    v_cvt_pk_bf16_f32 v145, v65, -v67
    ds_write_b32 v14, v145 offset:288
    v_pk_mul_f32 v[72:73], v[66:67], v[42:43] op_sel_hi:[1,0]
    v_pk_mul_f32 v[74:75], v[66:67], v[40:41] op_sel_hi:[1,0]
    v_pk_fma_f32 v[66:67], v[64:65], v[42:43], v[74:75] op_sel_hi:[1,0,1]
    v_pk_fma_f32 v[64:65], v[64:65], v[40:41], v[72:73] op_sel_hi:[1,0,1] neg_lo:[0,0,1] neg_hi:[0,0,1]
    v_cvt_pk_bf16_f32 v146, v64, -v66
    ds_write_b32 v14, v146 offset:1152
    v_cvt_pk_bf16_f32 v147, v65, -v67
    ds_write_b32 v14, v147 offset:1440
    v_pk_mul_f32 v[68:69], v[66:67], v[42:43] op_sel_hi:[1,0]
    v_pk_mul_f32 v[70:71], v[66:67], v[40:41] op_sel_hi:[1,0]
    v_pk_fma_f32 v[66:67], v[64:65], v[42:43], v[70:71] op_sel_hi:[1,0,1]
    v_pk_fma_f32 v[64:65], v[64:65], v[40:41], v[68:69] op_sel_hi:[1,0,1] neg_lo:[0,0,1] neg_hi:[0,0,1]
    v_cvt_pk_bf16_f32 v148, v64, -v66
    ds_write_b32 v14, v148 offset:2304
    v_cvt_pk_bf16_f32 v149, v65, -v67
    ds_write_b32 v14, v149 offset:2592
    v_pk_mul_f32 v[72:73], v[66:67], v[42:43] op_sel_hi:[1,0]
    v_pk_mul_f32 v[74:75], v[66:67], v[40:41] op_sel_hi:[1,0]
    v_pk_fma_f32 v[66:67], v[64:65], v[42:43], v[74:75] op_sel_hi:[1,0,1]
    v_pk_fma_f32 v[64:65], v[64:65], v[40:41], v[72:73] op_sel_hi:[1,0,1] neg_lo:[0,0,1] neg_hi:[0,0,1]
    v_cvt_pk_bf16_f32 v150, v64, -v66
    ds_write_b32 v14, v150 offset:3456
    v_cvt_pk_bf16_f32 v151, v65, -v67
    ds_write_b32 v14, v151 offset:3744
    s_lshr_b32 s23, s21, 1
    s_lshr_b32 s24, s2, 6
    s_cmp_lt_u32 s22, 4
    s_cselect_b32 s23, s23, s24
    s_lshl_b32 s23, s23, 8
    s_add_u32 s23, s23, 15532032
    s_lshr_b32 s24, s2, 1
    s_and_b32 s24, s24, 3
    s_lshl_b32 s24, s24, 10
    s_add_u32 s23, s23, s24
    s_mov_b32 s25, 0
KF_PL54:
    buffer_load_dword v17, v253, s[12:15], s23 offen sc1
    s_waitcnt vmcnt(0)
KF_PC54:
    v_cmp_ne_u32 vcc, v250, v17
    s_cmp_eq_u64 vcc, 0
    s_cbranch_scc1 KF_PG54
    s_sleep 4
    s_add_u32 s25, s25, 1
    s_cmp_lt_u32 s25, 0x40000
    s_cbranch_scc1 KF_PL54
KF_PG54:
    s_lshl_b32 s23, s20, 8
    s_add_u32 s23, s23, 15564800
    s_lshl_b32 s24, s21, 3
    s_add_u32 s24, s24, s22
    s_lshl_b64 exec, 1, s24
    buffer_store_dword v250, v253, s[12:15], s23 offen sc1
    s_mov_b64 exec, -1
    v_lshlrev_b32 v16, 4, v1
    s_add_u32 m0, s31, 12512
    s_nop 0
    buffer_load_dwordx4 v16, s[12:15], s35 offen offset:0 sc1 lds
    buffer_load_dwordx4 v16, s[12:15], s35 offen offset:1024 sc1 lds
    buffer_load_dwordx4 v16, s[12:15], s35 offen offset:2048 sc1 lds
    buffer_load_dwordx4 v16, s[12:15], s35 offen offset:3072 sc1 lds
    s_waitcnt lgkmcnt(8)
    v_mfma_f32_16x16x32_bf16 v[128:131], v[108:111], v[76:79], 0
    v_mfma_f32_16x16x32_bf16 v[132:135], v[108:111], v[92:95], 0
    v_mfma_f32_16x16x32_bf16 v[128:131], v[112:115], v[80:83], v[128:131]
    v_mfma_f32_16x16x32_bf16 v[132:135], v[112:115], v[96:99], v[132:135]
    v_mfma_f32_16x16x32_bf16 v[128:131], v[116:119], v[84:87], v[128:131]
    v_mfma_f32_16x16x32_bf16 v[132:135], v[116:119], v[100:103], v[132:135]
    v_mfma_f32_16x16x32_bf16 v[128:131], v[120:123], v[88:91], v[128:131]
    v_mfma_f32_16x16x32_bf16 v[132:135], v[120:123], v[104:107], v[132:135]
    ds_read_b128 v[108:111], v15 offset:0
    ds_read_b128 v[112:115], v15 offset:64
    ds_read_b128 v[116:119], v15 offset:128
    ds_read_b128 v[120:123], v15 offset:192
    s_waitcnt lgkmcnt(0)
    v_mfma_f32_16x16x32_bf16 v[136:139], v[108:111], v[76:79], 0
    v_mfma_f32_16x16x32_bf16 v[140:143], v[108:111], v[92:95], 0
    v_mfma_f32_16x16x32_bf16 v[136:139], v[112:115], v[80:83], v[136:139]
    v_mfma_f32_16x16x32_bf16 v[140:143], v[112:115], v[96:99], v[140:143]
    v_mfma_f32_16x16x32_bf16 v[136:139], v[116:119], v[84:87], v[136:139]
    v_mfma_f32_16x16x32_bf16 v[140:143], v[116:119], v[100:103], v[140:143]
    v_mfma_f32_16x16x32_bf16 v[136:139], v[120:123], v[88:91], v[136:139]
    v_mfma_f32_16x16x32_bf16 v[140:143], v[120:123], v[104:107], v[140:143]
    v_lshl_add_u32 v14, v1, 4, s33
    s_xor_b32 s23, s22, 1
    s_sub_u32 s23, s23, 4
    s_mul_i32 s23, s23, 5120
    s_add_u32 s23, s23, 42560
    v_lshl_add_u32 v15, v1, 4, s23
    ds_write_b128 v14, v[124:127] offset:0
    ds_write_b128 v14, v[128:131] offset:1024
    ds_write_b128 v14, v[132:135] offset:2048
    ds_write_b128 v14, v[136:139] offset:3072
    ds_write_b128 v14, v[140:143] offset:4096
    v_mov_b32 v6, 1
    s_waitcnt lgkmcnt(0)
    ds_write_b32 v4, v6
    s_waitcnt vmcnt(0)
    s_lshl_b32 s23, s29, 11
    s_add_u32 s23, s23, s31
    v_lshl_add_u32 v16, v1, 4, s23
    ds_read_b64 v[76:77], v16 offset:12504
    ds_read_b128 v[80:83], v16 offset:12512
    ds_read_b64 v[84:85], v16 offset:13528
    ds_read_b128 v[88:91], v16 offset:13536
    s_waitcnt lgkmcnt(2)
    v_alignbit_b32 v108, v77, v76, 16
    v_alignbit_b32 v109, v80, v77, 16
    v_alignbit_b32 v110, v81, v80, 16
    v_alignbit_b32 v111, v82, v81, 16
    v_alignbit_b32 v112, v80, v77, 16
    v_alignbit_b32 v113, v81, v80, 16
    v_alignbit_b32 v114, v82, v81, 16
    v_alignbit_b32 v115, v83, v82, 16
    v_mov_b32 v116, v77
    v_mov_b32 v117, v80
    v_mov_b32 v118, v81
    v_mov_b32 v119, v82
    ds_write_b128 v16, v[108:111] offset:32
    ds_write_b128 v16, v[116:119] offset:4192
    ds_write_b128 v16, v[112:115] offset:8352
    s_waitcnt lgkmcnt(0)
    s_waitcnt lgkmcnt(3)
    v_alignbit_b32 v108, v85, v84, 16
    v_alignbit_b32 v109, v88, v85, 16
    v_alignbit_b32 v110, v89, v88, 16
    v_alignbit_b32 v111, v90, v89, 16
    v_alignbit_b32 v112, v88, v85, 16
    v_alignbit_b32 v113, v89, v88, 16
    v_alignbit_b32 v114, v90, v89, 16
    v_alignbit_b32 v115, v91, v90, 16
    v_mov_b32 v116, v85
    v_mov_b32 v117, v88
    v_mov_b32 v118, v89
    v_mov_b32 v119, v90
    ds_write_b128 v16, v[108:111] offset:1056
    ds_write_b128 v16, v[116:119] offset:5216
    ds_write_b128 v16, v[112:115] offset:9376
    v_xor_b32 v5, 4, v4
    s_mov_b32 s27, 0
K2_W55:
    ds_read_b32 v6, v5
    s_waitcnt lgkmcnt(0)
    v_readfirstlane_b32 s26, v6
    s_cmp_ge_u32 s26, 1
    s_cbranch_scc1 K2_G55
    s_sleep 1
    s_add_u32 s27, s27, 1
    s_cmp_lt_u32 s27, 0x200000
    s_cbranch_scc1 K2_W55
K2_G55:
    ds_read_b128 v[76:79], v15 offset:0
    ds_read_b128 v[80:83], v15 offset:1024
    ds_read_b128 v[84:87], v15 offset:2048
    ds_read_b128 v[88:91], v15 offset:3072
    ds_read_b128 v[92:95], v15 offset:4096
    v_lshlrev_b32 v16, 4, v2
    v_sub_u32 v16, s32, v16
    s_waitcnt lgkmcnt(0)
    v_add_f32 v124, v124, v76
    v_add_f32 v125, v125, v77
    v_add_f32 v126, v126, v78
    v_add_f32 v127, v127, v79
    v_add_f32 v128, v128, v80
    v_add_f32 v129, v129, v81
    v_add_f32 v130, v130, v82
    v_add_f32 v131, v131, v83
    v_add_f32 v132, v132, v84
    v_add_f32 v133, v133, v85
    v_add_f32 v134, v134, v86
    v_add_f32 v135, v135, v87
    v_add_f32 v136, v136, v88
    v_add_f32 v137, v137, v89
    v_add_f32 v138, v138, v90
    v_add_f32 v139, v139, v91
    v_add_f32 v140, v140, v92
    v_add_f32 v141, v141, v93
    v_add_f32 v142, v142, v94
    v_add_f32 v143, v143, v95
    s_cmp_eq_u32 s29, 0
    s_nop 1
    s_cbranch_scc0 K2_EXP1
    v_lshrrev_b32 v68, 1, v3
    v_lshlrev_b32 v68, 8, v68
    v_and_b32 v69, 1, v3
    v_lshl_add_u32 v68, v69, 3, v68
    v_sub_u32 v68, v16, v68
    v_cvt_pk_bf16_f32 v144, v127, v126
    v_cvt_pk_bf16_f32 v145, v125, v124
    ds_write_b64 v68, v[144:145] offset:4088
    v_lshlrev_b32 v70, 8, v3
    v_sub_u32 v70, v16, v70
    v_cvt_pk_bf16_f32 v148, v132, v131
    v_cvt_pk_bf16_f32 v149, v130, v130
    v_cvt_pk_bf16_f32 v150, v130, v129
    v_cvt_pk_bf16_f32 v151, v128, v128
    s_mov_b32 exec_hi, 0
    ds_write_b128 v70, v[148:151] offset:3568
    s_mov_b32 exec_hi, -1
    v_lshlrev_b32 v71, 9, v3
    v_sub_u32 v71, v16, v71
    v_cvt_pk_bf16_f32 v108, v132, v132
    v_cvt_pk_bf16_f32 v109, v129, v129
    v_cvt_pk_bf16_f32 v110, v129, v128
    v_cvt_pk_bf16_f32 v111, v128, v128
    v_cvt_pk_bf16_f32 v112, v134, v134
    v_cvt_pk_bf16_f32 v113, v131, v131
    v_cvt_pk_bf16_f32 v114, v131, v130
    v_cvt_pk_bf16_f32 v115, v130, v130
    s_mov_b32 exec_lo, 0
    ds_write_b128 v71, v[108:111] offset:4080
    ds_write_b128 v71, v[112:115] offset:3824
    s_mov_b32 exec_lo, -1
    s_branch K2_EXPD
K2_EXP1:
    v_lshlrev_b32 v71, 9, v3
    v_sub_u32 v71, v16, v71
    v_and_b32 v68, 1, v2
    v_cmp_eq_u32 vcc, 1, v68
    s_nop 1
    v_cndmask_b32 v69, v136, v140, vcc
    v_cvt_pk_bf16_f32 v108, v140, v140
    v_cvt_pk_bf16_f32 v109, v140, v69
    v_cvt_pk_bf16_f32 v110, v136, v136
    v_cvt_pk_bf16_f32 v111, v136, v136
    ds_write_b128 v71, v[108:111] offset:2032
    v_cndmask_b32 v69, v137, v141, vcc
    v_cvt_pk_bf16_f32 v112, v141, v141
    v_cvt_pk_bf16_f32 v113, v141, v69
    v_cvt_pk_bf16_f32 v114, v137, v137
    v_cvt_pk_bf16_f32 v115, v137, v137
    ds_write_b128 v71, v[112:115] offset:1776
    s_nop 1
K2_EXPD:
    s_waitcnt vmcnt(0)
    v_mov_b32 v6, 2
    s_waitcnt lgkmcnt(0)
    ds_write_b32 v4, v6
    v_xor_b32 v5, 4, v4
    s_mov_b32 s27, 0
K2_W56:
    ds_read_b32 v6, v5
    s_waitcnt lgkmcnt(0)
    v_readfirstlane_b32 s26, v6
    s_cmp_ge_u32 s26, 2
    s_cbranch_scc1 K2_G56
    s_sleep 1
    s_add_u32 s27, s27, 1
    s_cmp_lt_u32 s27, 0x200000
    s_cbranch_scc1 K2_W56
K2_G56:
    v_mov_b32 v9, v14
    v_mov_b32 v10, v15
    v_and_b32 v172, 3, v2
    v_mul_u32_u24 v172, 4160, v172
    v_and_b32 v173, 12, v2
    v_lshl_add_u32 v172, v173, 1, v172
    v_lshl_add_u32 v172, v3, 4, v172
    v_add_u32 v172, 8, v172
    s_lshl_b32 s23, s29, 8
    s_add_u32 s24, s23, s31
    v_add_u32 v7, s24, v172
    v_lshlrev_b32 v172, 1, v2
    v_sub_u32 v172, v3, v172
    v_lshlrev_b32 v172, 4, v172
    s_add_u32 s24, s23, s32
    s_add_u32 s24, s24, 480
    v_add_u32 v8, s24, v172
    ds_read_b64 v[44:45], v7 offset:0
    ds_read_b64 v[46:47], v7 offset:8
    ds_read_b128 v[108:111], v8 offset:3584
    ds_read_b64 v[48:49], v7 offset:512
    ds_read_b64 v[50:51], v7 offset:520
    ds_read_b128 v[112:115], v8 offset:3072
    ds_read_b64 v[52:53], v7 offset:1024
    ds_read_b64 v[54:55], v7 offset:1032
    ds_read_b128 v[116:119], v8 offset:2560
    ds_read_b64 v[56:57], v7 offset:1536
    ds_read_b64 v[58:59], v7 offset:1544
    ds_read_b128 v[120:123], v8 offset:2048
    ds_read_b64 v[60:61], v7 offset:2048
    ds_read_b64 v[62:63], v7 offset:2056
    ds_read_b128 v[124:127], v8 offset:1536
    ds_read_b64 v[64:65], v7 offset:2560
    ds_read_b64 v[66:67], v7 offset:2568
    ds_read_b128 v[128:131], v8 offset:1024
    ds_read_b64 v[68:69], v7 offset:3072
    ds_read_b64 v[70:71], v7 offset:3080
    ds_read_b128 v[132:135], v8 offset:512
    ds_read_b64 v[72:73], v7 offset:3584
    ds_read_b64 v[74:75], v7 offset:3592
    ds_read_b128 v[136:139], v8 offset:0
    s_waitcnt lgkmcnt(15)
    v_mfma_f32_16x16x32_bf16 v[12:15], v[44:47], v[108:111], 0
    ds_read_b64 v[76:77], v7 offset:64
    ds_read_b64 v[78:79], v7 offset:72
    ds_read_b128 v[140:143], v8 offset:3648
    s_waitcnt lgkmcnt(15)
    v_mfma_f32_16x16x32_bf16 v[16:19], v[44:47], v[112:115], 0
    v_mfma_f32_16x16x32_bf16 v[16:19], v[48:51], v[108:111], v[16:19]
    v_mfma_f32_16x16x32_bf16 v[20:23], v[48:51], v[112:115], 0
    ds_read_b64 v[80:81], v7 offset:576
    ds_read_b64 v[82:83], v7 offset:584
    ds_read_b128 v[144:147], v8 offset:3136
    s_waitcnt lgkmcnt(15)
    v_mfma_f32_16x16x32_bf16 v[20:23], v[44:47], v[116:119], v[20:23]
    v_mfma_f32_16x16x32_bf16 v[24:27], v[48:51], v[116:119], 0
    v_mfma_f32_16x16x32_bf16 v[20:23], v[52:55], v[108:111], v[20:23]
    v_mfma_f32_16x16x32_bf16 v[24:27], v[52:55], v[112:115], v[24:27]
    v_mfma_f32_16x16x32_bf16 v[28:31], v[52:55], v[116:119], 0
    ds_read_b64 v[84:85], v7 offset:1088
    ds_read_b64 v[86:87], v7 offset:1096
    ds_read_b128 v[148:151], v8 offset:2624
    s_waitcnt lgkmcnt(15)
    v_mfma_f32_16x16x32_bf16 v[24:27], v[44:47], v[120:123], v[24:27]
    v_mfma_f32_16x16x32_bf16 v[28:31], v[48:51], v[120:123], v[28:31]
    v_mfma_f32_16x16x32_bf16 v[32:35], v[52:55], v[120:123], 0
    v_mfma_f32_16x16x32_bf16 v[24:27], v[56:59], v[108:111], v[24:27]
    v_mfma_f32_16x16x32_bf16 v[28:31], v[56:59], v[112:115], v[28:31]
    v_mfma_f32_16x16x32_bf16 v[32:35], v[56:59], v[116:119], v[32:35]
    v_mfma_f32_16x16x32_bf16 v[36:39], v[56:59], v[120:123], 0
    ds_read_b64 v[88:89], v7 offset:1600
    ds_read_b64 v[90:91], v7 offset:1608
    ds_read_b128 v[152:155], v8 offset:2112
    s_waitcnt lgkmcnt(15)
    v_mfma_f32_16x16x32_bf16 v[28:31], v[44:47], v[124:127], v[28:31]
    v_mfma_f32_16x16x32_bf16 v[32:35], v[48:51], v[124:127], v[32:35]
    v_mfma_f32_16x16x32_bf16 v[36:39], v[52:55], v[124:127], v[36:39]
    v_mfma_f32_16x16x32_bf16 v[40:43], v[56:59], v[124:127], 0
    v_mfma_f32_16x16x32_bf16 v[28:31], v[60:63], v[108:111], v[28:31]
    v_mfma_f32_16x16x32_bf16 v[32:35], v[60:63], v[112:115], v[32:35]
    v_mfma_f32_16x16x32_bf16 v[36:39], v[60:63], v[116:119], v[36:39]
    v_mfma_f32_16x16x32_bf16 v[40:43], v[60:63], v[120:123], v[40:43]
    ds_read_b64 v[92:93], v7 offset:2112
    ds_read_b64 v[94:95], v7 offset:2120
    ds_read_b128 v[156:159], v8 offset:1600
    s_waitcnt lgkmcnt(15)
    v_mfma_f32_16x16x32_bf16 v[32:35], v[44:47], v[128:131], v[32:35]
    v_mfma_f32_16x16x32_bf16 v[36:39], v[48:51], v[128:131], v[36:39]
    v_mfma_f32_16x16x32_bf16 v[40:43], v[52:55], v[128:131], v[40:43]
    v_mfma_f32_16x16x32_bf16 v[32:35], v[64:67], v[108:111], v[32:35]
    v_mfma_f32_16x16x32_bf16 v[36:39], v[64:67], v[112:115], v[36:39]
    v_mfma_f32_16x16x32_bf16 v[40:43], v[64:67], v[116:119], v[40:43]
    ds_read_b64 v[96:97], v7 offset:2624
    ds_read_b64 v[98:99], v7 offset:2632
    ds_read_b128 v[160:163], v8 offset:1088
    s_waitcnt lgkmcnt(15)
    v_mfma_f32_16x16x32_bf16 v[36:39], v[44:47], v[132:135], v[36:39]
    v_mfma_f32_16x16x32_bf16 v[40:43], v[48:51], v[132:135], v[40:43]
    v_mfma_f32_16x16x32_bf16 v[36:39], v[68:71], v[108:111], v[36:39]
    v_mfma_f32_16x16x32_bf16 v[40:43], v[68:71], v[112:115], v[40:43]
    ds_read_b64 v[100:101], v7 offset:3136
    ds_read_b64 v[102:103], v7 offset:3144
    ds_read_b128 v[164:167], v8 offset:576
    s_waitcnt lgkmcnt(15)
    v_mfma_f32_16x16x32_bf16 v[40:43], v[44:47], v[136:139], v[40:43]
    v_mfma_f32_16x16x32_bf16 v[40:43], v[72:75], v[108:111], v[40:43]
    ds_read_b64 v[104:105], v7 offset:3648
    ds_read_b64 v[106:107], v7 offset:3656
    ds_read_b128 v[168:171], v8 offset:64
    s_waitcnt lgkmcnt(15)
    v_mfma_f32_16x16x32_bf16 v[12:15], v[76:79], v[140:143], v[12:15]
    ds_read_b64 v[44:45], v7 offset:128
    ds_read_b64 v[46:47], v7 offset:136
    ds_read_b128 v[108:111], v8 offset:3712
    s_waitcnt lgkmcnt(15)
    v_mfma_f32_16x16x32_bf16 v[16:19], v[76:79], v[144:147], v[16:19]
    v_mfma_f32_16x16x32_bf16 v[16:19], v[80:83], v[140:143], v[16:19]
    v_mfma_f32_16x16x32_bf16 v[20:23], v[80:83], v[144:147], v[20:23]
    ds_read_b64 v[48:49], v7 offset:640
    ds_read_b64 v[50:51], v7 offset:648
    ds_read_b128 v[112:115], v8 offset:3200
    s_waitcnt lgkmcnt(15)
    v_mfma_f32_16x16x32_bf16 v[20:23], v[76:79], v[148:151], v[20:23]
    v_mfma_f32_16x16x32_bf16 v[24:27], v[80:83], v[148:151], v[24:27]
    v_mfma_f32_16x16x32_bf16 v[20:23], v[84:87], v[140:143], v[20:23]
    v_mfma_f32_16x16x32_bf16 v[24:27], v[84:87], v[144:147], v[24:27]
    v_mfma_f32_16x16x32_bf16 v[28:31], v[84:87], v[148:151], v[28:31]
    ds_read_b64 v[52:53], v7 offset:1152
    ds_read_b64 v[54:55], v7 offset:1160
    ds_read_b128 v[116:119], v8 offset:2688
    s_waitcnt lgkmcnt(15)
    v_mfma_f32_16x16x32_bf16 v[24:27], v[76:79], v[152:155], v[24:27]
    v_mfma_f32_16x16x32_bf16 v[28:31], v[80:83], v[152:155], v[28:31]
    v_mfma_f32_16x16x32_bf16 v[32:35], v[84:87], v[152:155], v[32:35]
    v_mfma_f32_16x16x32_bf16 v[24:27], v[88:91], v[140:143], v[24:27]
    v_mfma_f32_16x16x32_bf16 v[28:31], v[88:91], v[144:147], v[28:31]
    v_mfma_f32_16x16x32_bf16 v[32:35], v[88:91], v[148:151], v[32:35]
    v_mfma_f32_16x16x32_bf16 v[36:39], v[88:91], v[152:155], v[36:39]
    ds_read_b64 v[56:57], v7 offset:1664
    ds_read_b64 v[58:59], v7 offset:1672
    ds_read_b128 v[120:123], v8 offset:2176
    s_waitcnt lgkmcnt(15)
    v_mfma_f32_16x16x32_bf16 v[28:31], v[76:79], v[156:159], v[28:31]
    v_mfma_f32_16x16x32_bf16 v[32:35], v[80:83], v[156:159], v[32:35]
    v_mfma_f32_16x16x32_bf16 v[36:39], v[84:87], v[156:159], v[36:39]
    v_mfma_f32_16x16x32_bf16 v[40:43], v[88:91], v[156:159], v[40:43]
    v_mfma_f32_16x16x32_bf16 v[28:31], v[92:95], v[140:143], v[28:31]
    v_mfma_f32_16x16x32_bf16 v[32:35], v[92:95], v[144:147], v[32:35]
    v_mfma_f32_16x16x32_bf16 v[36:39], v[92:95], v[148:151], v[36:39]
    v_mfma_f32_16x16x32_bf16 v[40:43], v[92:95], v[152:155], v[40:43]
    ds_read_b64 v[60:61], v7 offset:2176
    ds_read_b64 v[62:63], v7 offset:2184
    ds_read_b128 v[124:127], v8 offset:1664
    s_waitcnt lgkmcnt(15)
    v_mfma_f32_16x16x32_bf16 v[32:35], v[76:79], v[160:163], v[32:35]
    v_mfma_f32_16x16x32_bf16 v[36:39], v[80:83], v[160:163], v[36:39]
    v_mfma_f32_16x16x32_bf16 v[40:43], v[84:87], v[160:163], v[40:43]
    v_mfma_f32_16x16x32_bf16 v[32:35], v[96:99], v[140:143], v[32:35]
    v_mfma_f32_16x16x32_bf16 v[36:39], v[96:99], v[144:147], v[36:39]
    v_mfma_f32_16x16x32_bf16 v[40:43], v[96:99], v[148:151], v[40:43]
    ds_read_b64 v[64:65], v7 offset:2688
    ds_read_b64 v[66:67], v7 offset:2696
    ds_read_b128 v[128:131], v8 offset:1152
    s_waitcnt lgkmcnt(15)
    v_mfma_f32_16x16x32_bf16 v[36:39], v[76:79], v[164:167], v[36:39]
    v_mfma_f32_16x16x32_bf16 v[40:43], v[80:83], v[164:167], v[40:43]
    v_mfma_f32_16x16x32_bf16 v[36:39], v[100:103], v[140:143], v[36:39]
    v_mfma_f32_16x16x32_bf16 v[40:43], v[100:103], v[144:147], v[40:43]
    ds_read_b64 v[68:69], v7 offset:3200
    ds_read_b64 v[70:71], v7 offset:3208
    ds_read_b128 v[132:135], v8 offset:640
    s_waitcnt lgkmcnt(15)
    v_mfma_f32_16x16x32_bf16 v[40:43], v[76:79], v[168:171], v[40:43]
    v_mfma_f32_16x16x32_bf16 v[40:43], v[104:107], v[140:143], v[40:43]
    ds_read_b64 v[72:73], v7 offset:3712
    ds_read_b64 v[74:75], v7 offset:3720
    ds_read_b128 v[136:139], v8 offset:128
    s_waitcnt lgkmcnt(15)
    v_mfma_f32_16x16x32_bf16 v[12:15], v[44:47], v[108:111], v[12:15]
    ds_read_b64 v[76:77], v7 offset:192
    ds_read_b64 v[78:79], v7 offset:200
    ds_read_b128 v[140:143], v8 offset:3776
    s_waitcnt lgkmcnt(15)
    v_mfma_f32_16x16x32_bf16 v[16:19], v[44:47], v[112:115], v[16:19]
    v_mfma_f32_16x16x32_bf16 v[16:19], v[48:51], v[108:111], v[16:19]
    v_mfma_f32_16x16x32_bf16 v[20:23], v[48:51], v[112:115], v[20:23]
    ds_read_b64 v[80:81], v7 offset:704
    ds_read_b64 v[82:83], v7 offset:712
    ds_read_b128 v[144:147], v8 offset:3264
    s_waitcnt lgkmcnt(15)
    v_mfma_f32_16x16x32_bf16 v[20:23], v[44:47], v[116:119], v[20:23]
    v_mfma_f32_16x16x32_bf16 v[24:27], v[48:51], v[116:119], v[24:27]
    v_mfma_f32_16x16x32_bf16 v[20:23], v[52:55], v[108:111], v[20:23]
    v_mfma_f32_16x16x32_bf16 v[24:27], v[52:55], v[112:115], v[24:27]
    v_mfma_f32_16x16x32_bf16 v[28:31], v[52:55], v[116:119], v[28:31]
    ds_read_b64 v[84:85], v7 offset:1216
    ds_read_b64 v[86:87], v7 offset:1224
    ds_read_b128 v[148:151], v8 offset:2752
    s_waitcnt lgkmcnt(15)
    v_mfma_f32_16x16x32_bf16 v[24:27], v[44:47], v[120:123], v[24:27]
    v_mfma_f32_16x16x32_bf16 v[28:31], v[48:51], v[120:123], v[28:31]
    v_mfma_f32_16x16x32_bf16 v[32:35], v[52:55], v[120:123], v[32:35]
    v_mfma_f32_16x16x32_bf16 v[24:27], v[56:59], v[108:111], v[24:27]
    v_mfma_f32_16x16x32_bf16 v[28:31], v[56:59], v[112:115], v[28:31]
    v_mfma_f32_16x16x32_bf16 v[32:35], v[56:59], v[116:119], v[32:35]
    v_mfma_f32_16x16x32_bf16 v[36:39], v[56:59], v[120:123], v[36:39]
    ds_read_b64 v[88:89], v7 offset:1728
    ds_read_b64 v[90:91], v7 offset:1736
    ds_read_b128 v[152:155], v8 offset:2240
    s_waitcnt lgkmcnt(15)
    v_mfma_f32_16x16x32_bf16 v[28:31], v[44:47], v[124:127], v[28:31]
    v_mfma_f32_16x16x32_bf16 v[32:35], v[48:51], v[124:127], v[32:35]
    v_mfma_f32_16x16x32_bf16 v[36:39], v[52:55], v[124:127], v[36:39]
    v_mfma_f32_16x16x32_bf16 v[40:43], v[56:59], v[124:127], v[40:43]
    v_mfma_f32_16x16x32_bf16 v[28:31], v[60:63], v[108:111], v[28:31]
    v_mfma_f32_16x16x32_bf16 v[32:35], v[60:63], v[112:115], v[32:35]
    v_mfma_f32_16x16x32_bf16 v[36:39], v[60:63], v[116:119], v[36:39]
    v_mfma_f32_16x16x32_bf16 v[40:43], v[60:63], v[120:123], v[40:43]
    ds_read_b64 v[92:93], v7 offset:2240
    ds_read_b64 v[94:95], v7 offset:2248
    ds_read_b128 v[156:159], v8 offset:1728
    s_waitcnt lgkmcnt(15)
    v_mfma_f32_16x16x32_bf16 v[32:35], v[44:47], v[128:131], v[32:35]
    v_mfma_f32_16x16x32_bf16 v[36:39], v[48:51], v[128:131], v[36:39]
    v_mfma_f32_16x16x32_bf16 v[40:43], v[52:55], v[128:131], v[40:43]
    v_mfma_f32_16x16x32_bf16 v[32:35], v[64:67], v[108:111], v[32:35]
    v_mfma_f32_16x16x32_bf16 v[36:39], v[64:67], v[112:115], v[36:39]
    v_mfma_f32_16x16x32_bf16 v[40:43], v[64:67], v[116:119], v[40:43]
    ds_read_b64 v[96:97], v7 offset:2752
    ds_read_b64 v[98:99], v7 offset:2760
    ds_read_b128 v[160:163], v8 offset:1216
    s_waitcnt lgkmcnt(15)
    v_mfma_f32_16x16x32_bf16 v[36:39], v[44:47], v[132:135], v[36:39]
    v_mfma_f32_16x16x32_bf16 v[40:43], v[48:51], v[132:135], v[40:43]
    v_mfma_f32_16x16x32_bf16 v[36:39], v[68:71], v[108:111], v[36:39]
    v_mfma_f32_16x16x32_bf16 v[40:43], v[68:71], v[112:115], v[40:43]
    ds_read_b64 v[100:101], v7 offset:3264
    ds_read_b64 v[102:103], v7 offset:3272
    ds_read_b128 v[164:167], v8 offset:704
    s_waitcnt lgkmcnt(15)
    v_mfma_f32_16x16x32_bf16 v[40:43], v[44:47], v[136:139], v[40:43]
    v_mfma_f32_16x16x32_bf16 v[40:43], v[72:75], v[108:111], v[40:43]
    ds_read_b64 v[104:105], v7 offset:3776
    ds_read_b64 v[106:107], v7 offset:3784
    ds_read_b128 v[168:171], v8 offset:192
    s_waitcnt lgkmcnt(15)
    v_mfma_f32_16x16x32_bf16 v[12:15], v[76:79], v[140:143], v[12:15]
    s_waitcnt lgkmcnt(15)
    v_mfma_f32_16x16x32_bf16 v[16:19], v[76:79], v[144:147], v[16:19]
    v_mfma_f32_16x16x32_bf16 v[16:19], v[80:83], v[140:143], v[16:19]
    v_mfma_f32_16x16x32_bf16 v[20:23], v[80:83], v[144:147], v[20:23]
    s_waitcnt lgkmcnt(15)
    v_mfma_f32_16x16x32_bf16 v[20:23], v[76:79], v[148:151], v[20:23]
    v_mfma_f32_16x16x32_bf16 v[24:27], v[80:83], v[148:151], v[24:27]
    v_mfma_f32_16x16x32_bf16 v[20:23], v[84:87], v[140:143], v[20:23]
    v_mfma_f32_16x16x32_bf16 v[24:27], v[84:87], v[144:147], v[24:27]
    v_mfma_f32_16x16x32_bf16 v[28:31], v[84:87], v[148:151], v[28:31]
    s_waitcnt lgkmcnt(12)
    v_mfma_f32_16x16x32_bf16 v[24:27], v[76:79], v[152:155], v[24:27]
    v_mfma_f32_16x16x32_bf16 v[28:31], v[80:83], v[152:155], v[28:31]
    v_mfma_f32_16x16x32_bf16 v[32:35], v[84:87], v[152:155], v[32:35]
    v_mfma_f32_16x16x32_bf16 v[24:27], v[88:91], v[140:143], v[24:27]
    v_mfma_f32_16x16x32_bf16 v[28:31], v[88:91], v[144:147], v[28:31]
    v_mfma_f32_16x16x32_bf16 v[32:35], v[88:91], v[148:151], v[32:35]
    v_mfma_f32_16x16x32_bf16 v[36:39], v[88:91], v[152:155], v[36:39]
    s_waitcnt lgkmcnt(9)
    v_mfma_f32_16x16x32_bf16 v[28:31], v[76:79], v[156:159], v[28:31]
    v_mfma_f32_16x16x32_bf16 v[32:35], v[80:83], v[156:159], v[32:35]
    v_mfma_f32_16x16x32_bf16 v[36:39], v[84:87], v[156:159], v[36:39]
    v_mfma_f32_16x16x32_bf16 v[40:43], v[88:91], v[156:159], v[40:43]
    v_mfma_f32_16x16x32_bf16 v[28:31], v[92:95], v[140:143], v[28:31]
    v_mfma_f32_16x16x32_bf16 v[32:35], v[92:95], v[144:147], v[32:35]
    v_mfma_f32_16x16x32_bf16 v[36:39], v[92:95], v[148:151], v[36:39]
    v_mfma_f32_16x16x32_bf16 v[40:43], v[92:95], v[152:155], v[40:43]
    s_waitcnt lgkmcnt(6)
    v_mfma_f32_16x16x32_bf16 v[32:35], v[76:79], v[160:163], v[32:35]
    v_mfma_f32_16x16x32_bf16 v[36:39], v[80:83], v[160:163], v[36:39]
    v_mfma_f32_16x16x32_bf16 v[40:43], v[84:87], v[160:163], v[40:43]
    v_mfma_f32_16x16x32_bf16 v[32:35], v[96:99], v[140:143], v[32:35]
    v_mfma_f32_16x16x32_bf16 v[36:39], v[96:99], v[144:147], v[36:39]
    v_mfma_f32_16x16x32_bf16 v[40:43], v[96:99], v[148:151], v[40:43]
    s_waitcnt lgkmcnt(3)
    v_mfma_f32_16x16x32_bf16 v[36:39], v[76:79], v[164:167], v[36:39]
    v_mfma_f32_16x16x32_bf16 v[40:43], v[80:83], v[164:167], v[40:43]
    v_mfma_f32_16x16x32_bf16 v[36:39], v[100:103], v[140:143], v[36:39]
    v_mfma_f32_16x16x32_bf16 v[40:43], v[100:103], v[144:147], v[40:43]
    s_waitcnt lgkmcnt(0)
    v_mfma_f32_16x16x32_bf16 v[40:43], v[76:79], v[168:171], v[40:43]
    v_mfma_f32_16x16x32_bf16 v[40:43], v[104:107], v[140:143], v[40:43]
    s_cmp_eq_u32 s29, 0
    s_nop 6
    s_cbranch_scc0 K2_FX1
    ds_write_b128 v9, v[28:31] offset:0
    ds_write_b128 v9, v[32:35] offset:1024
    ds_write_b128 v9, v[36:39] offset:2048
    ds_write_b128 v9, v[40:43] offset:3072
    s_branch K2_FXD
K2_FX1:
    ds_write_b128 v9, v[12:15] offset:0
    ds_write_b128 v9, v[16:19] offset:1024
    ds_write_b128 v9, v[20:23] offset:2048
    ds_write_b128 v9, v[24:27] offset:3072
    s_waitcnt lgkmcnt(0)
    v_mov_b32 v12, v28
    v_mov_b32 v13, v29
    v_mov_b32 v14, v30
    v_mov_b32 v15, v31
    v_mov_b32 v16, v32
    v_mov_b32 v17, v33
    v_mov_b32 v18, v34
    v_mov_b32 v19, v35
    v_mov_b32 v20, v36
    v_mov_b32 v21, v37
    v_mov_b32 v22, v38
    v_mov_b32 v23, v39
    v_mov_b32 v24, v40
    v_mov_b32 v25, v41
    v_mov_b32 v26, v42
    v_mov_b32 v27, v43
K2_FXD:
    v_mov_b32 v6, 3
    s_waitcnt lgkmcnt(0)
    ds_write_b32 v4, v6
    v_xor_b32 v5, 4, v4
    s_mov_b32 s27, 0
K2_W57:
    ds_read_b32 v6, v5
    s_waitcnt lgkmcnt(0)
    v_readfirstlane_b32 s26, v6
    s_cmp_ge_u32 s26, 3
    s_cbranch_scc1 K2_G57
    s_sleep 1
    s_add_u32 s27, s27, 1
    s_cmp_lt_u32 s27, 0x200000
    s_cbranch_scc1 K2_W57
K2_G57:
    ds_read_b128 v[44:47], v10 offset:0
    ds_read_b128 v[48:51], v10 offset:1024
    ds_read_b128 v[52:55], v10 offset:2048
    ds_read_b128 v[56:59], v10 offset:3072
    v_lshlrev_b32 v172, 5, v2
    v_lshl_add_u32 v172, v3, 3, v172
    s_lshl_b32 s23, s29, 11
    s_add_u32 s24, s23, s31
    s_add_u32 s24, s24, 12512
    v_add_u32 v173, s24, v172
    ds_read_b64 v[108:109], v173 offset:0
    ds_read_b64 v[110:111], v173 offset:512
    ds_read_b64 v[112:113], v173 offset:1024
    ds_read_b64 v[114:115], v173 offset:1536
    s_lshl_b32 s24, s30, 12
    s_add_u32 s24, s24, s23
    s_add_u32 s24, s24, 13172736
    v_lshlrev_b32 v174, 5, v2
    v_lshrrev_b32 v175, 1, v3
    v_lshl_add_u32 v174, v175, 4, v174
    v_and_b32 v175, 1, v3
    v_lshl_add_u32 v174, v175, 9, v174
    s_waitcnt lgkmcnt(0)
    v_add_f32 v12, v12, v44
    v_add_f32 v13, v13, v45
    v_add_f32 v14, v14, v46
    v_add_f32 v15, v15, v47
    v_lshlrev_b32 v124, 16, v108
    v_and_b32 v125, 0xffff0000, v108
    v_lshlrev_b32 v126, 16, v109
    v_and_b32 v127, 0xffff0000, v109
    v_fma_f32 v12, s34, v124, v12
    v_fma_f32 v13, s34, v125, v13
    v_fma_f32 v14, s34, v126, v14
    v_fma_f32 v15, s34, v127, v15
    v_cvt_pk_bf16_f32 v132, v12, v13
    v_cvt_pk_bf16_f32 v133, v14, v15
    v_add_f32 v16, v16, v48
    v_add_f32 v17, v17, v49
    v_add_f32 v18, v18, v50
    v_add_f32 v19, v19, v51
    v_lshlrev_b32 v124, 16, v110
    v_and_b32 v125, 0xffff0000, v110
    v_lshlrev_b32 v126, 16, v111
    v_and_b32 v127, 0xffff0000, v111
    v_fma_f32 v16, s34, v124, v16
    v_fma_f32 v17, s34, v125, v17
    v_fma_f32 v18, s34, v126, v18
    v_fma_f32 v19, s34, v127, v19
    v_cvt_pk_bf16_f32 v134, v16, v17
    v_cvt_pk_bf16_f32 v135, v18, v19
    s_nop 0
    v_permlane16_swap_b32 v132, v134
    v_permlane16_swap_b32 v133, v135
    buffer_store_dwordx4 v[132:135], v174, s[12:15], s24 offen offset:0 sc1
    v_add_f32 v20, v20, v52
    v_add_f32 v21, v21, v53
    v_add_f32 v22, v22, v54
    v_add_f32 v23, v23, v55
    v_lshlrev_b32 v124, 16, v112
    v_and_b32 v125, 0xffff0000, v112
    v_lshlrev_b32 v126, 16, v113
    v_and_b32 v127, 0xffff0000, v113
    v_fma_f32 v20, s34, v124, v20
    v_fma_f32 v21, s34, v125, v21
    v_fma_f32 v22, s34, v126, v22
    v_fma_f32 v23, s34, v127, v23
    v_cvt_pk_bf16_f32 v136, v20, v21
    v_cvt_pk_bf16_f32 v137, v22, v23
    v_add_f32 v24, v24, v56
    v_add_f32 v25, v25, v57
    v_add_f32 v26, v26, v58
    v_add_f32 v27, v27, v59
    v_lshlrev_b32 v124, 16, v114
    v_and_b32 v125, 0xffff0000, v114
    v_lshlrev_b32 v126, 16, v115
    v_and_b32 v127, 0xffff0000, v115
    v_fma_f32 v24, s34, v124, v24
    v_fma_f32 v25, s34, v125, v25
    v_fma_f32 v26, s34, v126, v26
    v_fma_f32 v27, s34, v127, v27
    v_cvt_pk_bf16_f32 v138, v24, v25
    v_cvt_pk_bf16_f32 v139, v26, v27
    s_nop 0
    v_permlane16_swap_b32 v136, v138
    v_permlane16_swap_b32 v137, v139
    buffer_store_dwordx4 v[136:139], v174, s[12:15], s24 offen offset:1024 sc1
    s_load_dwordx2 s[44:45], s[0:1], 0
    s_load_dwordx4 s[48:51], s[0:1], 104
    s_waitcnt lgkmcnt(0)
    s_mov_b32 s28, s44
    s_and_b32 s29, s45, 0xffff
    s_mov_b32 s30, 0x00200000
    s_mov_b32 s31, 0x00020000
    s_mov_b32 s32, s48
    s_and_b32 s33, s49, 0xffff
    s_mov_b32 s34, 0x000e0000
    s_mov_b32 s35, 0x00020000
    s_mov_b32 s36, s50
    s_and_b32 s37, s51, 0xffff
    s_mov_b32 s38, 0x00200000
    s_mov_b32 s39, 0x00020000
    s_and_b32 s40, s22, 3
    s_lshr_b32 s41, s22, 2
    s_lshl_b32 s23, s20, 2
    s_add_u32 s23, s23, s40
    s_mul_i32 s23, s23, 28
    s_add_u32 s23, s23, s41
    s_lshl_b32 s42, s23, 10
    s_add_u32 s42, s42, 9502720
    s_lshl_b32 s43, s41, 15
    s_lshl_b32 s23, s21, 7
    s_add_u32 s43, s43, s23
    s_lshl_b32 s52, s22, 10
    v_lshlrev_b32 v52, 4, v1
    v_lshrrev_b32 v40, 3, v1
    v_and_b32 v41, 3, v40
    v_and_b32 v42, 4, v40
    v_lshl_add_u32 v41, v42, 1, v41
    s_and_b32 s23, s40, 1
    s_lshl_b32 s23, s23, 2
    s_and_b32 s24, s40, 2
    s_lshl_b32 s24, s24, 3
    s_or_b32 s23, s23, s24
    v_or_b32 v41, s23, v41
    v_lshrrev_b32 v42, 1, v40
    v_lshrrev_b32 v43, 1, v1
    v_xor_b32 v42, v42, v43
    v_and_b32 v42, 3, v42
    v_lshlrev_b32 v42, 5, v42
    v_and_b32 v43, 1, v1
    v_lshl_add_u32 v42, v43, 4, v42
    v_lshl_add_u32 v53, v41, 10, v42
    v_lshl_add_u32 v55, v40, 12, v42
    s_lshl_b32 s23, s21, 6
    s_lshl_b32 s24, s22, 3
    s_add_u32 s23, s23, s24
    s_lshl_b32 s23, s23, 12
    s_lshl_b32 s24, s20, 7
    s_add_u32 s23, s23, s24
    s_add_u32 s54, s23, 13172736
    s_lshl_b32 s53, s20, 16
    s_lshl_b32 s23, s22, 13
    s_add_u32 s53, s53, s23
    s_lshl_b32 s23, s21, 7
    s_add_u32 s53, s53, s23
    v_and_b32 v45, 7, v1
    v_lshlrev_b32 v54, 10, v40
    v_lshl_add_u32 v54, v45, 4, v54
    s_lshl_b32 s23, s22, 3
    v_add_u32 v56, s23, v40
    v_mul_u32_u24 v56, 272, v56
    v_lshl_add_u32 v56, v45, 5, v56
    v_add_u32 v56, 123136, v56
    s_lshl_b32 s23, s22, 4
    v_add_u32 v57, s23, v2
    v_mul_u32_u24 v57, 272, v57
    v_lshl_add_u32 v57, v3, 4, v57
    v_add_u32 v57, 123136, v57
    v_lshrrev_b32 v40, 2, v2
    v_lshl_add_u32 v40, v3, 2, v40
    v_bfe_u32 v41, v40, 1, 2
    v_xor_b32 v41, s40, v41
    v_lshlrev_b32 v58, 7, v40
    v_lshl_add_u32 v58, v41, 5, v58
    v_and_b32 v41, 3, v2
    v_lshl_add_u32 v58, v41, 3, v58
    s_lshl_b32 s23, s41, 12
    s_add_u32 s23, s23, 114944
    v_add_u32 v58, s23, v58
    v_lshrrev_b32 v40, 2, v2
    v_and_b32 v41, 1, v3
    v_lshl_add_u32 v40, v41, 2, v40
    v_lshrrev_b32 v42, 1, v40
    v_lshrrev_b32 v41, 1, v3
    v_lshl_add_u32 v40, v41, 4, v40
    v_lshlrev_b32 v40, 7, v40
    v_and_b32 v41, 3, v2
    v_lshl_add_u32 v40, v41, 3, v40
    s_lshl_b32 s23, s41, 12
    s_add_u32 s23, s23, 256
    v_add_u32 v40, s23, v40
    v_xor_b32 v43, 0, v42
    v_lshl_add_u32 v48, v43, 5, v40
    v_xor_b32 v43, 1, v42
    v_lshl_add_u32 v49, v43, 5, v40
    v_xor_b32 v43, 2, v42
    v_lshl_add_u32 v50, v43, 5, v40
    v_xor_b32 v43, 3, v42
    v_lshl_add_u32 v51, v43, 5, v40
    v_lshlrev_b32 v59, 2, v1
    s_waitcnt vmcnt(0)
    v_mov_b32 v6, 4
    s_waitcnt lgkmcnt(0)
    ds_write_b32 v4, v6
    v_xor_b32 v5, 4, v4
    s_mov_b32 s27, 0
K2_W58:
    ds_read_b32 v6, v5
    s_waitcnt lgkmcnt(0)
    v_readfirstlane_b32 s26, v6
    s_cmp_ge_u32 s26, 4
    s_cbranch_scc1 K2_G58
    s_sleep 1
    s_add_u32 s27, s27, 1
    s_cmp_lt_u32 s27, 0x200000
    s_cbranch_scc1 K2_W58
K2_G58:
    v_xor_b32 v5, 8, v4
    s_mov_b32 s27, 0
K2_W59:
    ds_read_b32 v6, v5
    s_waitcnt lgkmcnt(0)
    v_readfirstlane_b32 s26, v6
    s_cmp_ge_u32 s26, 4
    s_cbranch_scc1 K2_G59
    s_sleep 1
    s_add_u32 s27, s27, 1
    s_cmp_lt_u32 s27, 0x200000
    s_cbranch_scc1 K2_W59
K2_G59:
    v_xor_b32 v5, 12, v4
    s_mov_b32 s27, 0
K2_W60:
    ds_read_b32 v6, v5
    s_waitcnt lgkmcnt(0)
    v_readfirstlane_b32 s26, v6
    s_cmp_ge_u32 s26, 4
    s_cbranch_scc1 K2_G60
    s_sleep 1
    s_add_u32 s27, s27, 1
    s_cmp_lt_u32 s27, 0x200000
    s_cbranch_scc1 K2_W60
K2_G60:
    s_cmp_lg_u32 s22, 4
    s_cbranch_scc1 K2_Q1
    s_lshr_b32 s23, s2, 2
    s_lshl_b32 s23, s23, 7
    s_add_u32 s23, s23, 15572992
    s_and_b32 s24, s2, 3
    s_lshl_b64 exec, 1, s24
    buffer_store_dword v250, v253, s[12:15], s23 offen sc1
    s_mov_b64 exec, -1
K2_Q1:
    s_setprio 0
    s_add_u32 s23, s43, -32768
    s_add_u32 m0, s52, -3840
    s_nop 0
    buffer_load_dwordx4 v53, s[32:35], s23 offen lds
    s_add_u32 s23, s43, 0
    s_add_u32 m0, s52, 256
    s_nop 0
    buffer_load_dwordx4 v53, s[32:35], s23 offen lds
    s_add_u32 s23, s43, 32768
    s_add_u32 m0, s52, 4352
    s_nop 0
    buffer_load_dwordx4 v53, s[32:35], s23 offen lds
    s_add_u32 s23, s43, 65536
    s_add_u32 m0, s52, 8448
    s_nop 0
    buffer_load_dwordx4 v53, s[32:35], s23 offen lds
    s_add_u32 s23, s43, 98304
    s_add_u32 m0, s52, 12544
    s_nop 0
    buffer_load_dwordx4 v53, s[32:35], s23 offen lds
    s_add_u32 s23, s43, 131072
    s_add_u32 m0, s52, 16640
    s_nop 0
    buffer_load_dwordx4 v53, s[32:35], s23 offen lds
    s_add_u32 s23, s43, 163840
    s_add_u32 m0, s52, 20736
    s_nop 0
    buffer_load_dwordx4 v53, s[32:35], s23 offen lds
    s_add_u32 s23, s43, 196608
    s_add_u32 m0, s52, 24832
    s_nop 0
    buffer_load_dwordx4 v53, s[32:35], s23 offen lds
    s_add_u32 s23, s43, 229376
    s_add_u32 m0, s52, 28928
    s_nop 0
    buffer_load_dwordx4 v53, s[32:35], s23 offen lds
    s_add_u32 s23, s43, 262144
    s_add_u32 m0, s52, 33024
    s_nop 0
    buffer_load_dwordx4 v53, s[32:35], s23 offen lds
    s_add_u32 s23, s43, 294912
    s_add_u32 m0, s52, 37120
    s_nop 0
    buffer_load_dwordx4 v53, s[32:35], s23 offen lds
    s_add_u32 s23, s43, 327680
    s_add_u32 m0, s52, 41216
    s_nop 0
    buffer_load_dwordx4 v53, s[32:35], s23 offen lds
    s_add_u32 s23, s43, 360448
    s_add_u32 m0, s52, 45312
    s_nop 0
    buffer_load_dwordx4 v53, s[32:35], s23 offen lds
    s_add_u32 s23, s43, 393216
    s_add_u32 m0, s52, 49408
    s_nop 0
    buffer_load_dwordx4 v53, s[32:35], s23 offen lds
K2_P3:
    s_setprio 0
    s_barrier
    s_add_u32 s23, s43, 458752
    s_add_u32 m0, s52, 57600
    s_nop 0
    buffer_load_dwordx4 v53, s[32:35], s23 offen lds
    s_add_u32 s23, s43, 524288
    s_add_u32 m0, s52, 65792
    s_nop 0
    buffer_load_dwordx4 v53, s[32:35], s23 offen lds
    s_add_u32 s23, s43, 589824
    s_add_u32 m0, s52, 73984
    s_nop 0
    buffer_load_dwordx4 v53, s[32:35], s23 offen lds
    s_add_u32 s23, s43, 655360
    s_add_u32 m0, s52, 82176
    s_nop 0
    buffer_load_dwordx4 v53, s[32:35], s23 offen lds
    s_add_u32 s23, s43, 720896
    s_add_u32 m0, s52, 90368
    s_nop 0
    buffer_load_dwordx4 v53, s[32:35], s23 offen lds
    s_add_u32 s23, s43, 786432
    s_add_u32 m0, s52, 98560
    s_nop 0
    buffer_load_dwordx4 v53, s[32:35], s23 offen lds
    s_add_u32 s23, s43, 851968
    s_add_u32 m0, s52, 106752
    s_nop 0
    buffer_load_dwordx4 v53, s[32:35], s23 offen lds
    buffer_load_dwordx4 v[168:171], v54, s[28:31], s53 offen
    s_waitcnt vmcnt(0)
    s_barrier
    s_lshl_b32 s23, s20, 9
    s_and_b32 s24, s22, 3
    s_lshl_b32 s24, s24, 7
    s_add_u32 s23, s23, s24
    s_add_u32 s23, s23, 15548416
    s_mov_b32 s25, 0
KF_PL61:
    buffer_load_dword v40, v253, s[12:15], s23 offen sc1
    s_waitcnt vmcnt(0)
KF_PC61:
    v_cmp_ne_u32 vcc, v250, v40
    s_and_b64 vcc, vcc, 0xff
    s_cmp_eq_u64 vcc, 0
    s_cbranch_scc1 KF_PG61
    s_sleep 4
    s_add_u32 s25, s25, 1
    s_cmp_lt_u32 s25, 0x40000
    s_cbranch_scc1 KF_PL61
KF_PG61:
    s_lshl_b32 s23, s21, 10
    s_lshl_b32 s24, s22, 7
    s_add_u32 s23, s23, s24
    s_add_u32 s23, s23, 15572992
    buffer_load_dword v41, v253, s[12:15], s23 offen sc1
    s_add_u32 s24, s42, 0
    buffer_load_dwordx4 v[60:63], v52, s[12:15], s24 offen sc1
    s_add_u32 s24, s42, 2048
    buffer_load_dwordx4 v[64:67], v52, s[12:15], s24 offen sc1
    s_add_u32 s24, s42, 4096
    buffer_load_dwordx4 v[68:71], v52, s[12:15], s24 offen sc1
    s_add_u32 s24, s42, 6144
    buffer_load_dwordx4 v[72:75], v52, s[12:15], s24 offen sc1
    s_add_u32 s24, s42, 8192
    buffer_load_dwordx4 v[76:79], v52, s[12:15], s24 offen sc1
    s_add_u32 s24, s42, 10240
    buffer_load_dwordx4 v[80:83], v52, s[12:15], s24 offen sc1
    ds_read_b64_tr_b16 v[116:117], v48 offset:0
    ds_read_b64_tr_b16 v[118:119], v48 offset:1024
    ds_read_b64_tr_b16 v[120:121], v49 offset:0
    ds_read_b64_tr_b16 v[122:123], v49 offset:1024
    ds_read_b64_tr_b16 v[124:125], v50 offset:0
    ds_read_b64_tr_b16 v[126:127], v50 offset:1024
    ds_read_b64_tr_b16 v[128:129], v51 offset:0
    ds_read_b64_tr_b16 v[130:131], v51 offset:1024
    ds_read_b64_tr_b16 v[132:133], v48 offset:8192
    ds_read_b64_tr_b16 v[134:135], v48 offset:9216
    ds_read_b64_tr_b16 v[136:137], v49 offset:8192
    ds_read_b64_tr_b16 v[138:139], v49 offset:9216
    ds_read_b64_tr_b16 v[140:141], v50 offset:8192
    ds_read_b64_tr_b16 v[142:143], v50 offset:9216
    ds_read_b64_tr_b16 v[144:145], v51 offset:8192
    ds_read_b64_tr_b16 v[146:147], v51 offset:9216
    s_add_u32 s24, s42, 12288
    buffer_load_dwordx4 v[84:87], v52, s[12:15], s24 offen sc1
    s_waitcnt vmcnt(6)
    s_waitcnt lgkmcnt(8)
    v_mfma_f32_16x16x32_bf16 v[148:151], v[116:119], v[60:63], 0
    v_mfma_f32_16x16x32_bf16 v[152:155], v[120:123], v[60:63], 0
    v_mfma_f32_16x16x32_bf16 v[156:159], v[124:127], v[60:63], 0
    v_mfma_f32_16x16x32_bf16 v[160:163], v[128:131], v[60:63], 0
    ds_read_b64_tr_b16 v[116:117], v48 offset:16384
    ds_read_b64_tr_b16 v[118:119], v48 offset:17408
    ds_read_b64_tr_b16 v[120:121], v49 offset:16384
    ds_read_b64_tr_b16 v[122:123], v49 offset:17408
    ds_read_b64_tr_b16 v[124:125], v50 offset:16384
    ds_read_b64_tr_b16 v[126:127], v50 offset:17408
    ds_read_b64_tr_b16 v[128:129], v51 offset:16384
    ds_read_b64_tr_b16 v[130:131], v51 offset:17408
    s_add_u32 s24, s42, 14336
    buffer_load_dwordx4 v[88:91], v52, s[12:15], s24 offen sc1
    v_cmp_ne_u32 vcc, v250, v41
    s_and_b64 vcc, vcc, 15
    s_cmp_eq_u64 vcc, 0
    s_cbranch_scc1 KF_YOK
    s_lshl_b32 s23, s21, 10
    s_lshl_b32 s24, s22, 7
    s_add_u32 s23, s23, s24
    s_add_u32 s23, s23, 15572992
    s_mov_b32 s25, 0
KF_PL62:
    buffer_load_dword v40, v253, s[12:15], s23 offen sc1
    s_waitcnt vmcnt(0)
KF_PC62:
    v_cmp_ne_u32 vcc, v250, v40
    s_and_b64 vcc, vcc, 0xf
    s_cmp_eq_u64 vcc, 0
    s_cbranch_scc1 KF_PG62
    s_sleep 4
    s_add_u32 s25, s25, 1
    s_cmp_lt_u32 s25, 0x40000
    s_cbranch_scc1 KF_PL62
KF_PG62:
KF_YOK:
    s_add_u32 m0, s52, 114944
    s_nop 0
    buffer_load_dwordx4 v55, s[12:15], s54 offen sc1 lds
    s_waitcnt vmcnt(7)
    s_waitcnt lgkmcnt(8)
    v_mfma_f32_16x16x32_bf16 v[148:151], v[132:135], v[64:67], v[148:151]
    v_mfma_f32_16x16x32_bf16 v[152:155], v[136:139], v[64:67], v[152:155]
    v_mfma_f32_16x16x32_bf16 v[156:159], v[140:143], v[64:67], v[156:159]
    v_mfma_f32_16x16x32_bf16 v[160:163], v[144:147], v[64:67], v[160:163]
    ds_read_b64_tr_b16 v[132:133], v48 offset:24576
    ds_read_b64_tr_b16 v[134:135], v48 offset:25600
    ds_read_b64_tr_b16 v[136:137], v49 offset:24576
    ds_read_b64_tr_b16 v[138:139], v49 offset:25600
    ds_read_b64_tr_b16 v[140:141], v50 offset:24576
    ds_read_b64_tr_b16 v[142:143], v50 offset:25600
    ds_read_b64_tr_b16 v[144:145], v51 offset:24576
    ds_read_b64_tr_b16 v[146:147], v51 offset:25600
    s_add_u32 s24, s42, 16384
    buffer_load_dwordx4 v[92:95], v52, s[12:15], s24 offen sc1
    s_waitcnt vmcnt(7)
    s_waitcnt lgkmcnt(8)
    v_mfma_f32_16x16x32_bf16 v[148:151], v[116:119], v[68:71], v[148:151]
    v_mfma_f32_16x16x32_bf16 v[152:155], v[120:123], v[68:71], v[152:155]
    v_mfma_f32_16x16x32_bf16 v[156:159], v[124:127], v[68:71], v[156:159]
    v_mfma_f32_16x16x32_bf16 v[160:163], v[128:131], v[68:71], v[160:163]
    ds_read_b64_tr_b16 v[116:117], v48 offset:32768
    ds_read_b64_tr_b16 v[118:119], v48 offset:33792
    ds_read_b64_tr_b16 v[120:121], v49 offset:32768
    ds_read_b64_tr_b16 v[122:123], v49 offset:33792
    ds_read_b64_tr_b16 v[124:125], v50 offset:32768
    ds_read_b64_tr_b16 v[126:127], v50 offset:33792
    ds_read_b64_tr_b16 v[128:129], v51 offset:32768
    ds_read_b64_tr_b16 v[130:131], v51 offset:33792
    s_add_u32 s24, s42, 18432
    buffer_load_dwordx4 v[96:99], v52, s[12:15], s24 offen sc1
    s_waitcnt vmcnt(7)
    s_waitcnt lgkmcnt(8)
    v_mfma_f32_16x16x32_bf16 v[148:151], v[132:135], v[72:75], v[148:151]
    v_mfma_f32_16x16x32_bf16 v[152:155], v[136:139], v[72:75], v[152:155]
    v_mfma_f32_16x16x32_bf16 v[156:159], v[140:143], v[72:75], v[156:159]
    v_mfma_f32_16x16x32_bf16 v[160:163], v[144:147], v[72:75], v[160:163]
    ds_read_b64_tr_b16 v[132:133], v48 offset:40960
    ds_read_b64_tr_b16 v[134:135], v48 offset:41984
    ds_read_b64_tr_b16 v[136:137], v49 offset:40960
    ds_read_b64_tr_b16 v[138:139], v49 offset:41984
    ds_read_b64_tr_b16 v[140:141], v50 offset:40960
    ds_read_b64_tr_b16 v[142:143], v50 offset:41984
    ds_read_b64_tr_b16 v[144:145], v51 offset:40960
    ds_read_b64_tr_b16 v[146:147], v51 offset:41984
    s_add_u32 s24, s42, 20480
    buffer_load_dwordx4 v[100:103], v52, s[12:15], s24 offen sc1
    s_waitcnt vmcnt(7)
    s_waitcnt lgkmcnt(8)
    v_mfma_f32_16x16x32_bf16 v[148:151], v[116:119], v[76:79], v[148:151]
    v_mfma_f32_16x16x32_bf16 v[152:155], v[120:123], v[76:79], v[152:155]
    v_mfma_f32_16x16x32_bf16 v[156:159], v[124:127], v[76:79], v[156:159]
    v_mfma_f32_16x16x32_bf16 v[160:163], v[128:131], v[76:79], v[160:163]
    ds_read_b64_tr_b16 v[116:117], v48 offset:49152
    ds_read_b64_tr_b16 v[118:119], v48 offset:50176
    ds_read_b64_tr_b16 v[120:121], v49 offset:49152
    ds_read_b64_tr_b16 v[122:123], v49 offset:50176
    ds_read_b64_tr_b16 v[124:125], v50 offset:49152
    ds_read_b64_tr_b16 v[126:127], v50 offset:50176
    ds_read_b64_tr_b16 v[128:129], v51 offset:49152
    ds_read_b64_tr_b16 v[130:131], v51 offset:50176
    s_add_u32 s24, s42, 22528
    buffer_load_dwordx4 v[104:107], v52, s[12:15], s24 offen sc1
    s_waitcnt vmcnt(7)
    s_waitcnt lgkmcnt(8)
    v_mfma_f32_16x16x32_bf16 v[148:151], v[132:135], v[80:83], v[148:151]
    v_mfma_f32_16x16x32_bf16 v[152:155], v[136:139], v[80:83], v[152:155]
    v_mfma_f32_16x16x32_bf16 v[156:159], v[140:143], v[80:83], v[156:159]
    v_mfma_f32_16x16x32_bf16 v[160:163], v[144:147], v[80:83], v[160:163]
    ds_read_b64_tr_b16 v[132:133], v48 offset:57344
    ds_read_b64_tr_b16 v[134:135], v48 offset:58368
    ds_read_b64_tr_b16 v[136:137], v49 offset:57344
    ds_read_b64_tr_b16 v[138:139], v49 offset:58368
    ds_read_b64_tr_b16 v[140:141], v50 offset:57344
    ds_read_b64_tr_b16 v[142:143], v50 offset:58368
    ds_read_b64_tr_b16 v[144:145], v51 offset:57344
    ds_read_b64_tr_b16 v[146:147], v51 offset:58368
    s_add_u32 s24, s42, 24576
    buffer_load_dwordx4 v[108:111], v52, s[12:15], s24 offen sc1
    s_waitcnt vmcnt(7)
    s_waitcnt lgkmcnt(8)
    v_mfma_f32_16x16x32_bf16 v[148:151], v[116:119], v[84:87], v[148:151]
    v_mfma_f32_16x16x32_bf16 v[152:155], v[120:123], v[84:87], v[152:155]
    v_mfma_f32_16x16x32_bf16 v[156:159], v[124:127], v[84:87], v[156:159]
    v_mfma_f32_16x16x32_bf16 v[160:163], v[128:131], v[84:87], v[160:163]
    v_add_u32 v48, 0x10000, v48
    v_add_u32 v49, 0x10000, v49
    v_add_u32 v50, 0x10000, v50
    v_add_u32 v51, 0x10000, v51
    ds_read_b64_tr_b16 v[116:117], v48 offset:0
    ds_read_b64_tr_b16 v[118:119], v48 offset:1024
    ds_read_b64_tr_b16 v[120:121], v49 offset:0
    ds_read_b64_tr_b16 v[122:123], v49 offset:1024
    ds_read_b64_tr_b16 v[124:125], v50 offset:0
    ds_read_b64_tr_b16 v[126:127], v50 offset:1024
    ds_read_b64_tr_b16 v[128:129], v51 offset:0
    ds_read_b64_tr_b16 v[130:131], v51 offset:1024
    s_add_u32 s24, s42, 26624
    buffer_load_dwordx4 v[112:115], v52, s[12:15], s24 offen sc1
    s_waitcnt vmcnt(7)
    s_waitcnt lgkmcnt(8)
    v_mfma_f32_16x16x32_bf16 v[148:151], v[132:135], v[88:91], v[148:151]
    v_mfma_f32_16x16x32_bf16 v[152:155], v[136:139], v[88:91], v[152:155]
    v_mfma_f32_16x16x32_bf16 v[156:159], v[140:143], v[88:91], v[156:159]
    v_mfma_f32_16x16x32_bf16 v[160:163], v[144:147], v[88:91], v[160:163]
    ds_read_b64_tr_b16 v[132:133], v48 offset:8192
    ds_read_b64_tr_b16 v[134:135], v48 offset:9216
    ds_read_b64_tr_b16 v[136:137], v49 offset:8192
    ds_read_b64_tr_b16 v[138:139], v49 offset:9216
    ds_read_b64_tr_b16 v[140:141], v50 offset:8192
    ds_read_b64_tr_b16 v[142:143], v50 offset:9216
    ds_read_b64_tr_b16 v[144:145], v51 offset:8192
    ds_read_b64_tr_b16 v[146:147], v51 offset:9216
    s_waitcnt vmcnt(5)
    s_waitcnt lgkmcnt(8)
    v_mfma_f32_16x16x32_bf16 v[148:151], v[116:119], v[92:95], v[148:151]
    v_mfma_f32_16x16x32_bf16 v[152:155], v[120:123], v[92:95], v[152:155]
    v_mfma_f32_16x16x32_bf16 v[156:159], v[124:127], v[92:95], v[156:159]
    v_mfma_f32_16x16x32_bf16 v[160:163], v[128:131], v[92:95], v[160:163]
    ds_read_b64_tr_b16 v[116:117], v48 offset:16384
    ds_read_b64_tr_b16 v[118:119], v48 offset:17408
    ds_read_b64_tr_b16 v[120:121], v49 offset:16384
    ds_read_b64_tr_b16 v[122:123], v49 offset:17408
    ds_read_b64_tr_b16 v[124:125], v50 offset:16384
    ds_read_b64_tr_b16 v[126:127], v50 offset:17408
    ds_read_b64_tr_b16 v[128:129], v51 offset:16384
    ds_read_b64_tr_b16 v[130:131], v51 offset:17408
    s_waitcnt vmcnt(4)
    s_waitcnt lgkmcnt(8)
    v_mfma_f32_16x16x32_bf16 v[148:151], v[132:135], v[96:99], v[148:151]
    v_mfma_f32_16x16x32_bf16 v[152:155], v[136:139], v[96:99], v[152:155]
    v_mfma_f32_16x16x32_bf16 v[156:159], v[140:143], v[96:99], v[156:159]
    v_mfma_f32_16x16x32_bf16 v[160:163], v[144:147], v[96:99], v[160:163]
    ds_read_b64_tr_b16 v[132:133], v48 offset:24576
    ds_read_b64_tr_b16 v[134:135], v48 offset:25600
    ds_read_b64_tr_b16 v[136:137], v49 offset:24576
    ds_read_b64_tr_b16 v[138:139], v49 offset:25600
    ds_read_b64_tr_b16 v[140:141], v50 offset:24576
    ds_read_b64_tr_b16 v[142:143], v50 offset:25600
    ds_read_b64_tr_b16 v[144:145], v51 offset:24576
    ds_read_b64_tr_b16 v[146:147], v51 offset:25600
    s_waitcnt vmcnt(3)
    s_waitcnt lgkmcnt(8)
    v_mfma_f32_16x16x32_bf16 v[148:151], v[116:119], v[100:103], v[148:151]
    v_mfma_f32_16x16x32_bf16 v[152:155], v[120:123], v[100:103], v[152:155]
    v_mfma_f32_16x16x32_bf16 v[156:159], v[124:127], v[100:103], v[156:159]
    v_mfma_f32_16x16x32_bf16 v[160:163], v[128:131], v[100:103], v[160:163]
    ds_read_b64_tr_b16 v[116:117], v48 offset:32768
    ds_read_b64_tr_b16 v[118:119], v48 offset:33792
    ds_read_b64_tr_b16 v[120:121], v49 offset:32768
    ds_read_b64_tr_b16 v[122:123], v49 offset:33792
    ds_read_b64_tr_b16 v[124:125], v50 offset:32768
    ds_read_b64_tr_b16 v[126:127], v50 offset:33792
    ds_read_b64_tr_b16 v[128:129], v51 offset:32768
    ds_read_b64_tr_b16 v[130:131], v51 offset:33792
    s_waitcnt vmcnt(2)
    s_waitcnt lgkmcnt(8)
    v_mfma_f32_16x16x32_bf16 v[148:151], v[132:135], v[104:107], v[148:151]
    v_mfma_f32_16x16x32_bf16 v[152:155], v[136:139], v[104:107], v[152:155]
    v_mfma_f32_16x16x32_bf16 v[156:159], v[140:143], v[104:107], v[156:159]
    v_mfma_f32_16x16x32_bf16 v[160:163], v[144:147], v[104:107], v[160:163]
    ds_read_b64_tr_b16 v[132:133], v48 offset:40960
    ds_read_b64_tr_b16 v[134:135], v48 offset:41984
    ds_read_b64_tr_b16 v[136:137], v49 offset:40960
    ds_read_b64_tr_b16 v[138:139], v49 offset:41984
    ds_read_b64_tr_b16 v[140:141], v50 offset:40960
    ds_read_b64_tr_b16 v[142:143], v50 offset:41984
    ds_read_b64_tr_b16 v[144:145], v51 offset:40960
    ds_read_b64_tr_b16 v[146:147], v51 offset:41984
    s_waitcnt vmcnt(1)
    s_waitcnt lgkmcnt(8)
    v_mfma_f32_16x16x32_bf16 v[148:151], v[116:119], v[108:111], v[148:151]
    v_mfma_f32_16x16x32_bf16 v[152:155], v[120:123], v[108:111], v[152:155]
    v_mfma_f32_16x16x32_bf16 v[156:159], v[124:127], v[108:111], v[156:159]
    v_mfma_f32_16x16x32_bf16 v[160:163], v[128:131], v[108:111], v[160:163]
    s_waitcnt vmcnt(0)
    s_waitcnt lgkmcnt(0)
    v_mfma_f32_16x16x32_bf16 v[148:151], v[132:135], v[112:115], v[148:151]
    v_mfma_f32_16x16x32_bf16 v[152:155], v[136:139], v[112:115], v[152:155]
    v_mfma_f32_16x16x32_bf16 v[156:159], v[140:143], v[112:115], v[156:159]
    v_mfma_f32_16x16x32_bf16 v[160:163], v[144:147], v[112:115], v[160:163]
    s_waitcnt vmcnt(0)
    s_barrier
    ds_read_b64_tr_b16 v[164:165], v58
    ds_read_b64_tr_b16 v[166:167], v58 offset:2048
    s_waitcnt lgkmcnt(0)
    v_lshlrev_b32 v172, 16, v164
    v_and_b32 v173, 0xffff0000, v164
    v_lshlrev_b32 v174, 16, v165
    v_and_b32 v175, 0xffff0000, v165
    v_lshlrev_b32 v176, 16, v166
    v_and_b32 v177, 0xffff0000, v166
    v_lshlrev_b32 v178, 16, v167
    v_and_b32 v179, 0xffff0000, v167
    s_cmp_eq_u32 s41, 0
    s_nop 1
    s_cbranch_scc0 K2_Y1
    v_pk_add_f32 v[148:149], v[172:173], v[148:149]
    v_pk_add_f32 v[150:151], v[174:175], v[150:151]
    v_pk_add_f32 v[152:153], v[176:177], v[152:153]
    v_pk_add_f32 v[154:155], v[178:179], v[154:155]
    s_branch K2_YD
K2_Y1:
    v_pk_add_f32 v[156:157], v[172:173], v[156:157]
    v_pk_add_f32 v[158:159], v[174:175], v[158:159]
    v_pk_add_f32 v[160:161], v[176:177], v[160:161]
    v_pk_add_f32 v[162:163], v[178:179], v[162:163]
K2_YD:
    ds_write_b128 v57, v[148:151] offset:0
    ds_write_b128 v57, v[152:155] offset:64
    ds_write_b128 v57, v[156:159] offset:128
    ds_write_b128 v57, v[160:163] offset:192
    s_waitcnt lgkmcnt(0)
    s_barrier
    ds_read_b128 v[172:175], v56 offset:0
    ds_read_b128 v[176:179], v56 offset:16
    ds_read_b128 v[180:183], v56 offset:17408
    ds_read_b128 v[184:187], v56 offset:17424
    v_lshlrev_b32 v148, 16, v168
    v_and_b32 v149, 0xffff0000, v168
    v_lshlrev_b32 v150, 16, v169
    v_and_b32 v151, 0xffff0000, v169
    v_lshlrev_b32 v152, 16, v170
    v_and_b32 v153, 0xffff0000, v170
    v_lshlrev_b32 v154, 16, v171
    v_and_b32 v155, 0xffff0000, v171
    s_waitcnt lgkmcnt(0)
    v_pk_add_f32 v[172:173], v[172:173], v[180:181]
    v_pk_add_f32 v[174:175], v[174:175], v[182:183]
    v_pk_add_f32 v[176:177], v[176:177], v[184:185]
    v_pk_add_f32 v[178:179], v[178:179], v[186:187]
    v_pk_add_f32 v[172:173], v[172:173], v[148:149]
    v_pk_add_f32 v[174:175], v[174:175], v[150:151]
    v_pk_add_f32 v[176:177], v[176:177], v[152:153]
    v_pk_add_f32 v[178:179], v[178:179], v[154:155]
    v_cvt_pk_bf16_f32 v168, v172, v173
    v_cvt_pk_bf16_f32 v169, v174, v175
    v_cvt_pk_bf16_f32 v170, v176, v177
    v_cvt_pk_bf16_f32 v171, v178, v179
    buffer_store_dwordx4 v[168:171], v54, s[36:39], s53 offen
K2_END:
    s_endpgm
.section .rodata,"a"
.p2align 6
.amdhsa_kernel kf_kernel
  .amdhsa_next_free_vgpr 256
  .amdhsa_next_free_sgpr 102
  .amdhsa_accum_offset 256
  .amdhsa_group_segment_fixed_size 0
  .amdhsa_kernarg_size 136
  .amdhsa_user_sgpr_count 2
  .amdhsa_user_sgpr_kernarg_segment_ptr 1
  .amdhsa_system_sgpr_workgroup_id_x 1
  .amdhsa_float_denorm_mode_32 3
.end_amdhsa_kernel
```
